```python
import torch

def _softmax(x, axis=-1):
    return torch.softmax(x, dim=axis)
def _gelu(x):
    return torch.nn.functional.gelu(x, approximate="tanh")
def _silu(x):
    return torch.nn.functional.silu(x)
def _sigmoid(x):
    return torch.sigmoid(x)
def _layernorm(x, axis=-1, eps=1e-5):
    m = x.mean(dim=axis, keepdim=True)
    v = x.var(dim=axis, keepdim=True, unbiased=False)
    return (x - m) / torch.sqrt(v + eps)
def _scatter_add(tgt, idx, src, axis=0):
    return tgt.clone().index_add_(axis, idx, src)
def _segment_sum(src, seg, n):
    out = torch.zeros((n,) + src.shape[1:], dtype=src.dtype)
    return out.index_add_(0, seg, src)
def _pad(x, pw):
    flat = tuple(v for pair in reversed(pw) for v in pair)
    return torch.nn.functional.pad(x, flat)

kernel_name = 'interleave_layers__sliding_local_dilated__dense_activation_relu__prompt'

def setup_inputs():

    _w = (lambda a: (lambda t: t.to(torch.bfloat16) if t.is_floating_point() else t)(torch.as_tensor(a)))
    def _A_setup():
        B, S, D = 1, 2048, 640
        return {
            "x": _w((lambda *s: torch.randn(*s, dtype=torch.bfloat16) * 0.05)(B, S, D)),
            "wqkv": _w((lambda *s: torch.randn(*s, dtype=torch.bfloat16) * 0.05)(D, 3 * D)),
            "wo": _w((lambda *s: torch.randn(*s, dtype=torch.bfloat16) * 0.05)(D, D)),
        }
    _A_in = _A_setup()

    def _B_setup():
        B, S, D, Dff = 1, 2048, 640, 1728
        return {
            "x": _w((lambda *s: torch.randn(*s, dtype=torch.bfloat16) * 0.05)(B, S, D)),
            "w1": _w((lambda *s: torch.randn(*s, dtype=torch.bfloat16) * 0.05)(D, Dff)),
            "w2": _w((lambda *s: torch.randn(*s, dtype=torch.bfloat16) * 0.05)(Dff, D)),
        }
    _B_in = _B_setup()

    return {
        "A_x": _A_in["x"],
        "A_wqkv": _A_in["wqkv"],
        "A_wo": _A_in["wo"],
        "B_x": _B_in["x"],
        "B_w1": _B_in["w1"],
        "B_w2": _B_in["w2"],
    }

def reference(A_x, A_wqkv, A_wo, B_x, B_w1, B_w2):
    def _A_ref(x, wqkv, wo):
        B, S, D = x.shape
        H = 32; Dh = D // H
        W, dil = 8, 2
        qkv = (lambda x, *d: x.permute(*d))((x @ wqkv).reshape(B, S, 3, H, Dh), 2, 0, 3, 1, 4)
        q, k, v = qkv[0], qkv[1], qkv[2]
        scale = Dh ** -0.5
        pos = torch.arange(S)
        off = torch.arange(W) * dil
        idx = pos[:, None] - off[None, :]
        mask = idx >= 0
        idx_c = torch.where(mask, idx, 0).reshape(-1)
        kg = k[:, :, idx_c, :].reshape(B, H, S, W, Dh)
        vg = v[:, :, idx_c, :].reshape(B, H, S, W, Dh)
        logits = torch.einsum("bhsd,bhswd->bhsw", q, kg) * scale
        logits = torch.where(mask[None, None, :, :], logits, -1e9)
        attn = _softmax(logits, axis=-1)
        o = torch.einsum("bhsw,bhswd->bhsd", attn, vg)
        return (lambda x, *d: x.permute(*d))(o, 0, 2, 1, 3).reshape(B, S, D) @ wo

    def _B_ref(x, w1, w2):
        h = torch.einsum("bsd,df->bsf", x, w1)
        zero = torch.zeros_like(h)
        h = torch.maximum(h, zero)
        return torch.einsum("bsf,fd->bsd", h, w2)

    x = A_x
    x = x + _A_ref(_layernorm(x, axis=-1), A_wqkv, A_wo)
    x = x + _B_ref(_layernorm(x, axis=-1), B_w1, B_w2)
    x = x + _A_ref(_layernorm(x, axis=-1), A_wqkv, A_wo)
    x = x + _B_ref(_layernorm(x, axis=-1), B_w1, B_w2)
    return x
```

```asm
; @launch grid=(256,1,1) block=(512,1,1) lds=163840
.amdgcn_target "amdgcn-amd-amdhsa--gfx950"
.text
.globl interleave_layers__sliding_local_dilated__dense_activation_relu__prompt_kernel
.p2align 8
.type interleave_layers__sliding_local_dilated__dense_activation_relu__prompt_kernel,@function
interleave_layers__sliding_local_dilated__dense_activation_relu__prompt_kernel:
s_cmp_ge_u32 s2, 256
s_cbranch_scc1 END
s_load_dwordx4 s[8:11], s[0:1], 0
s_load_dwordx2 s[16:17], s[0:1], 16
s_load_dwordx4 s[20:23], s[0:1], 32
s_load_dwordx4 s[28:31], s[0:1], 48
s_load_dwordx2 s[32:33], s[0:1], 64
v_lshrrev_b32 v3, 6, v0
v_and_b32 v0, 63, v0
s_nop 0
v_readfirstlane_b32 s69, v3
s_nop 0
s_and_b32 s40, s69, 3
v_and_b32 v1, 15, v0
v_lshrrev_b32 v2, 4, v0
s_and_b32 s48, s2, 7
s_lshr_b32 s55, s2, 3
s_lshr_b32 s56, s55, 4
s_lshl_b32 s41, s48, 1
s_add_u32 s41, s41, s56
s_and_b32 s42, s55, 15
s_waitcnt lgkmcnt(0)
s_mov_b32 s12, s10
s_mov_b32 s13, s11
s_mov_b32 s24, s22
s_mov_b32 s25, s23
s_mov_b32 s60, s30
s_mov_b32 s61, s31
s_mov_b32 s10, 2621440
s_mov_b32 s11, 0x00020000
s_mov_b32 s14, 2457600
s_mov_b32 s15, 0x00020000
s_mov_b32 s18, 819200
s_mov_b32 s19, 0x00020000
s_mov_b32 s22, 2211840
s_mov_b32 s23, 0x00020000
s_mov_b32 s26, 2211840
s_mov_b32 s27, 0x00020000
s_mov_b32 s30, 2621440
s_mov_b32 s31, 0x00020000
s_mov_b32 s34, 50331648
s_mov_b32 s35, 0x00020000
s_mov_b32 s62, 256
s_mov_b32 s63, 0x00020000
s_lshl_b32 s45, s40, 10
s_mov_b32 s43, 0
s_mov_b32 s80, 0
s_getreg_b32 s81, hwreg(HW_REG_XCC_ID, 0, 4)
s_lshl_b32 s81, s81, 3
s_lshl_b32 s57, s41, 7
s_add_u32 s57, s57, 27787264
s_and_b32 s49, s42, 7
s_and_b32 s50, s42, 1
s_lshl_b32 s66, s2, 7
s_add_u32 s66, s66, 28311552
s_mul_i32 s70, s42, 163840
s_add_u32 s71, s70, 36700160
s_add_u32 s70, s70, 33554432
s_mul_i32 s72, s49, 102400
s_add_u32 s72, s72, 39845888
s_mul_i32 s73, s49, 286720
s_add_u32 s73, s73, 40894464
v_lshlrev_b32 v55, 4, v0
v_add_u32 v55, s45, v55
s_cmp_ge_u32 s69, 4
s_cbranch_scc1 LOADER
s_cmp_lg_u32 s69, 0
s_cbranch_scc1 LB1
s_lshr_b32 s48, s81, 3
s_mul_i32 s55, s48, s48
s_lshl_b32 s55, s55, 8
s_add_u32 s55, s55, s48
s_add_u32 s55, s55, 16777216
s_lshl_b32 s48, s41, 2
s_add_u32 s48, s48, 4
v_mov_b32 v8, s48
v_mov_b32 v9, s55
s_mov_b64 exec, 1
buffer_atomic_add v9, v8, s[60:63], 0 offen sc1
s_mov_b64 exec, -1
LB1:
s_cmp_ge_u32 s41, 10
s_cbranch_scc1 LB2
s_lshr_b32 s48, s40, 1
s_xor_b32 s48, s48, s40
s_and_b32 s48, s48, 1
s_lshl_b32 s48, s48, 2
v_or_b32 v3, s48, v2
v_lshrrev_b32 v4, 1, v1
v_xor_b32 v4, v4, v3
v_lshlrev_b32 v4, 1, v4
v_and_b32 v5, 1, v1
v_or_b32 v4, v4, v5
v_min_u32 v4, 14, v4
v_mul_u32_u24 v5, 52, v4
v_lshrrev_b32 v5, 8, v5
v_mul_u32_u24 v5, 600, v5
v_lshlrev_b32 v4, 3, v4
v_add_u32 v4, v4, v5
s_mul_i32 s48, s42, 40
v_add_u32 v4, s48, v4
v_lshlrev_b32 v4, 1, v4
s_lshl_b32 s48, s40, 2
v_add_u32 v5, s48, v2
v_mul_u32_u24 v5, 3840, v5
v_add_u32 v40, v4, v5
s_mul_i32 s48, s41, 245760
s_add_u32 s55, s48, 0
v_add_u32 v56, s55, v40
buffer_load_dwordx4 v[64:67], v56, s[12:15], 0 offen
s_add_u32 s55, s48, 61440
v_add_u32 v57, s55, v40
buffer_load_dwordx4 v[68:71], v57, s[12:15], 0 offen
s_add_u32 s55, s48, 122880
v_add_u32 v58, s55, v40
buffer_load_dwordx4 v[72:75], v58, s[12:15], 0 offen
s_add_u32 s55, s48, 184320
v_add_u32 v59, s55, v40
buffer_load_dwordx4 v[76:79], v59, s[12:15], 0 offen
LB2:
s_cmp_lt_u32 s41, 6
s_cbranch_scc1 LB3
s_lshl_b32 s65, s42, 3
s_mul_i32 s64, s42, 6
s_add_u32 s64, s64, 12
s_cmp_lt_u32 s42, 6
s_cselect_b32 s65, s65, s64
s_lshr_b32 s48, s40, 1
s_xor_b32 s48, s48, s40
s_and_b32 s48, s48, 1
s_lshl_b32 s48, s48, 2
v_or_b32 v3, s48, v2
v_lshrrev_b32 v4, 1, v1
v_xor_b32 v4, v4, v3
v_lshlrev_b32 v4, 1, v4
v_and_b32 v5, 1, v1
v_or_b32 v4, v4, v5
v_lshlrev_b32 v4, 3, v4
s_lshl_b32 s48, s65, 4
v_add_u32 v4, s48, v4
v_min_u32 v4, 1720, v4
v_lshlrev_b32 v4, 1, v4
s_lshl_b32 s48, s40, 2
v_add_u32 v5, s48, v2
v_mul_u32_u24 v5, 3456, v5
v_add_u32 v40, v4, v5
s_sub_u32 s48, s41, 6
s_mul_i32 s48, s48, 221184
s_add_u32 s55, s48, 0
v_add_u32 v60, s55, v40
buffer_load_dwordx4 v[80:83], v60, s[20:23], 0 offen
s_add_u32 s55, s48, 55296
v_add_u32 v61, s55, v40
buffer_load_dwordx4 v[84:87], v61, s[20:23], 0 offen
s_add_u32 s55, s48, 110592
v_add_u32 v62, s55, v40
buffer_load_dwordx4 v[88:91], v62, s[20:23], 0 offen
s_add_u32 s55, s48, 165888
v_add_u32 v63, s55, v40
buffer_load_dwordx4 v[92:95], v63, s[20:23], 0 offen
LB3:
s_lshr_b32 s64, s42, 3
s_sub_u32 s65, s41, 4
s_cmp_lt_u32 s41, 6
s_cselect_b32 s65, s41, s65
s_lshl_b32 s65, s65, 1
s_add_u32 s65, s65, s64
s_sub_u32 s48, s41, 6
s_cmp_lt_u32 s48, 4
s_cselect_b32 s65, 19, s65
s_cmp_ge_u32 s65, 19
s_cbranch_scc1 LB4
s_lshl_b32 s48, s40, 6
s_add_u32 s48, s48, 0
v_add_u32 v3, s48, v0
v_mul_u32_u24 v4, 6554, v3
v_lshrrev_b32 v4, 16, v4
v_mul_u32_u24 v5, 10, v4
v_sub_u32 v5, v3, v5
v_lshrrev_b32 v6, 1, v5
v_add_u32 v6, s50, v6
v_cmp_ne_u32 vcc, 5, v6
v_cndmask_b32 v6, 0, v6, vcc
v_lshlrev_b32 v6, 5, v6
v_and_b32 v5, 1, v5
v_lshlrev_b32 v5, 4, v5
v_add_u32 v6, v6, v5
s_mul_i32 s48, s49, 160
v_add_u32 v6, s48, v6
v_mul_u32_u24 v4, 1280, v4
v_add_u32 v50, v4, v6
s_lshl_b32 s48, s40, 6
s_add_u32 s48, s48, 256
v_add_u32 v3, s48, v0
v_mul_u32_u24 v4, 6554, v3
v_lshrrev_b32 v4, 16, v4
v_mul_u32_u24 v5, 10, v4
v_sub_u32 v5, v3, v5
v_lshrrev_b32 v6, 1, v5
v_add_u32 v6, s50, v6
v_cmp_ne_u32 vcc, 5, v6
v_cndmask_b32 v6, 0, v6, vcc
v_lshlrev_b32 v6, 5, v6
v_and_b32 v5, 1, v5
v_lshlrev_b32 v5, 4, v5
v_add_u32 v6, v6, v5
s_mul_i32 s48, s49, 160
v_add_u32 v6, s48, v6
v_mul_u32_u24 v4, 1280, v4
v_add_u32 v51, v4, v6
s_lshl_b32 s48, s40, 6
s_add_u32 s48, s48, 512
v_add_u32 v3, s48, v0
v_mul_u32_u24 v4, 6554, v3
v_lshrrev_b32 v4, 16, v4
v_mul_u32_u24 v5, 10, v4
v_sub_u32 v5, v3, v5
v_lshrrev_b32 v6, 1, v5
v_add_u32 v6, s50, v6
v_cmp_ne_u32 vcc, 5, v6
v_cndmask_b32 v6, 0, v6, vcc
v_lshlrev_b32 v6, 5, v6
v_and_b32 v5, 1, v5
v_lshlrev_b32 v5, 4, v5
v_add_u32 v6, v6, v5
s_mul_i32 s48, s49, 160
v_add_u32 v6, s48, v6
v_mul_u32_u24 v4, 1280, v4
v_add_u32 v52, v4, v6
s_lshl_b32 s48, s40, 6
s_add_u32 s48, s48, 768
v_add_u32 v3, s48, v0
v_mul_u32_u24 v4, 6554, v3
v_lshrrev_b32 v4, 16, v4
v_mul_u32_u24 v5, 10, v4
v_sub_u32 v5, v3, v5
v_lshrrev_b32 v6, 1, v5
v_add_u32 v6, s50, v6
v_cmp_ne_u32 vcc, 5, v6
v_cndmask_b32 v6, 0, v6, vcc
v_lshlrev_b32 v6, 5, v6
v_and_b32 v5, 1, v5
v_lshlrev_b32 v5, 4, v5
v_add_u32 v6, v6, v5
s_mul_i32 s48, s49, 160
v_add_u32 v6, s48, v6
v_mul_u32_u24 v4, 1280, v4
v_add_u32 v53, v4, v6
s_lshl_b32 s48, s40, 6
s_add_u32 s48, s48, 1024
v_add_u32 v3, s48, v0
v_mul_u32_u24 v4, 6554, v3
v_lshrrev_b32 v4, 16, v4
v_mul_u32_u24 v5, 10, v4
v_sub_u32 v5, v3, v5
v_lshrrev_b32 v6, 1, v5
v_add_u32 v6, s50, v6
v_cmp_ne_u32 vcc, 5, v6
v_cndmask_b32 v6, 0, v6, vcc
v_lshlrev_b32 v6, 5, v6
v_and_b32 v5, 1, v5
v_lshlrev_b32 v5, 4, v5
v_add_u32 v6, v6, v5
s_mul_i32 s48, s49, 160
v_add_u32 v6, s48, v6
v_mul_u32_u24 v4, 1280, v4
v_add_u32 v54, v4, v6
s_cmp_lt_u32 s65, 5
s_cbranch_scc0 LB5
s_mul_i32 s48, s65, 163840
v_add_u32 v50, s48, v50
buffer_load_dwordx4 v[96:99], v50, s[16:19], 0 offen
v_add_u32 v51, s48, v51
buffer_load_dwordx4 v[100:103], v51, s[16:19], 0 offen
v_add_u32 v52, s48, v52
buffer_load_dwordx4 v[104:107], v52, s[16:19], 0 offen
v_add_u32 v53, s48, v53
buffer_load_dwordx4 v[108:111], v53, s[16:19], 0 offen
v_add_u32 v54, s48, v54
buffer_load_dwordx4 v[112:115], v54, s[16:19], 0 offen
s_mul_i32 s64, s65, 20480
s_add_u32 s64, s64, s72
s_branch LB6
LB5:
s_sub_u32 s65, s65, 5
s_mul_i32 s48, s65, 163840
v_add_u32 v50, s48, v50
buffer_load_dwordx4 v[96:99], v50, s[24:27], 0 offen
v_add_u32 v51, s48, v51
buffer_load_dwordx4 v[100:103], v51, s[24:27], 0 offen
v_add_u32 v52, s48, v52
buffer_load_dwordx4 v[104:107], v52, s[24:27], 0 offen
v_add_u32 v53, s48, v53
buffer_load_dwordx4 v[108:111], v53, s[24:27], 0 offen
v_add_u32 v54, s48, v54
buffer_load_dwordx4 v[112:115], v54, s[24:27], 0 offen
s_mul_i32 s64, s65, 20480
s_add_u32 s64, s64, s73
LB6:
s_waitcnt vmcnt(0)
s_add_u32 s48, s64, 0
buffer_store_dwordx4 v[96:99], v55, s[32:35], s48 offen sc0 sc1
s_add_u32 s48, s64, 4096
buffer_store_dwordx4 v[100:103], v55, s[32:35], s48 offen sc0 sc1
s_add_u32 s48, s64, 8192
buffer_store_dwordx4 v[104:107], v55, s[32:35], s48 offen sc0 sc1
s_add_u32 s48, s64, 12288
buffer_store_dwordx4 v[108:111], v55, s[32:35], s48 offen sc0 sc1
s_add_u32 s48, s64, 16384
buffer_store_dwordx4 v[112:115], v55, s[32:35], s48 offen sc0 sc1
s_branch LB7
LB4:
s_waitcnt vmcnt(0)
LB7:
s_cmp_ge_u32 s41, 10
s_cbranch_scc1 LB8
s_lshl_b32 s64, s41, 14
s_add_u32 s64, s64, s70
s_add_u32 s48, s64, 0
buffer_store_dwordx4 v[64:67], v55, s[32:35], s48 offen sc0 sc1
s_add_u32 s48, s64, 4096
buffer_store_dwordx4 v[68:71], v55, s[32:35], s48 offen sc0 sc1
s_add_u32 s48, s64, 8192
buffer_store_dwordx4 v[72:75], v55, s[32:35], s48 offen sc0 sc1
s_add_u32 s48, s64, 12288
buffer_store_dwordx4 v[76:79], v55, s[32:35], s48 offen sc0 sc1
LB8:
s_cmp_lt_u32 s41, 6
s_cbranch_scc1 LB9
s_sub_u32 s64, s41, 6
s_lshl_b32 s64, s64, 14
s_add_u32 s64, s64, s71
s_add_u32 s48, s64, 0
buffer_store_dwordx4 v[80:83], v55, s[32:35], s48 offen sc0 sc1
s_add_u32 s48, s64, 4096
buffer_store_dwordx4 v[84:87], v55, s[32:35], s48 offen sc0 sc1
s_add_u32 s48, s64, 8192
buffer_store_dwordx4 v[88:91], v55, s[32:35], s48 offen sc0 sc1
s_add_u32 s48, s64, 12288
buffer_store_dwordx4 v[92:95], v55, s[32:35], s48 offen sc0 sc1
LB9:
s_add_u32 s48, s2, s69
s_cmp_lg_u32 s48, 0
s_cbranch_scc1 LB10
s_memrealtime s[64:65]
s_waitcnt lgkmcnt(0)
s_lshl_b32 s64, s64, 7
s_or_b32 s64, s64, 0x80000000
v_mov_b32 v3, s64
v_mov_b32 v4, 0
s_mov_b64 s[58:59], exec
s_mov_b64 exec, 1
buffer_store_dword v3, v4, s[60:63], 0 offen sc0 sc1
s_mov_b64 exec, s[58:59]
LB10:
s_lshr_b32 s48, s42, 3
s_lshl_b32 s48, s48, 2
s_lshl_b32 s64, s41, 3
s_add_u32 s64, s64, s48
s_add_u32 s64, s64, s40
s_lshl_b32 s48, s64, 4
v_add_u32 v3, s48, v1
v_mul_u32_u24 v3, 1280, v3
v_lshlrev_b32 v4, 3, v2
v_add_u32 v3, v3, v4
s_mul_i32 s48, s49, 5
s_add_u32 s55, s48, s50
s_lshl_b32 s56, s55, 5
v_add_u32 v20, s56, v3
s_cmp_eq_u32 s50, 0
s_cselect_b32 s56, 4, 0
s_add_u32 s56, s56, s48
s_lshl_b32 s65, s56, 5
v_add_u32 v21, s65, v3
s_mul_i32 s48, s64, 20
s_lshr_b32 s55, s55, 1
s_add_u32 s55, s55, s48
s_lshl_b32 s55, s55, 10
v_lshlrev_b32 v4, 4, v0
v_add_u32 v22, s55, v4
s_lshr_b32 s55, s56, 1
s_add_u32 s55, s55, s48
s_lshl_b32 s55, s55, 10
s_and_b32 s56, s56, 1
s_lshl_b32 s56, s56, 3
s_add_u32 s55, s55, s56
v_add_u32 v23, s55, v4
PAIRLOOP:
s_mul_i32 s51, s43, 14942208
s_add_u32 s52, s51, 2621440
s_add_u32 s53, s51, 5242880
v_lshrrev_b32 v3, 2, v1
v_and_b32 v4, 3, v0
s_cmp_eq_u32 s43, 0
s_cselect_b32 s48, 3, 2
s_cselect_b32 s55, 0, 0
v_lshlrev_b32 v5, s48, v2
v_add_u32 v5, v5, v3
v_add_u32 v5, s55, v5
v_lshrrev_b32 v6, 2, v5
v_lshrrev_b32 v7, 3, v5
v_xor_b32 v6, v6, v7
v_and_b32 v6, 1, v6
v_lshlrev_b32 v6, 2, v6
v_and_b32 v7, 3, v5
v_or_b32 v6, v6, v7
s_lshl_b32 s48, s40, 1
v_xor_b32 v6, s48, v6
v_lshlrev_b32 v6, 5, v6
v_lshlrev_b32 v5, 8, v5
v_add_u32 v5, v5, v6
v_lshlrev_b32 v7, 3, v4
v_add_u32 v24, v5, v7
v_xor_b32 v25, 32, v24
v_xor_b32 v26, 64, v24
v_xor_b32 v27, 96, v24
v_xor_b32 v28, 128, v24
v_xor_b32 v29, 160, v24
v_xor_b32 v30, 192, v24
v_xor_b32 v31, 224, v24
s_cmp_eq_u32 s43, 0
s_cselect_b32 s48, 3, 2
s_cselect_b32 s55, 4, 16
v_lshlrev_b32 v5, s48, v2
v_add_u32 v5, v5, v3
v_add_u32 v5, s55, v5
v_lshrrev_b32 v6, 2, v5
v_lshrrev_b32 v7, 3, v5
v_xor_b32 v6, v6, v7
v_and_b32 v6, 1, v6
v_lshlrev_b32 v6, 2, v6
v_and_b32 v7, 3, v5
v_or_b32 v6, v6, v7
s_lshl_b32 s48, s40, 1
v_xor_b32 v6, s48, v6
v_lshlrev_b32 v6, 5, v6
v_lshlrev_b32 v5, 8, v5
v_add_u32 v5, v5, v6
v_lshlrev_b32 v7, 3, v4
v_add_u32 v32, v5, v7
v_xor_b32 v33, 32, v32
v_xor_b32 v34, 64, v32
v_xor_b32 v35, 96, v32
v_xor_b32 v36, 128, v32
v_xor_b32 v37, 160, v32
v_xor_b32 v38, 192, v32
v_xor_b32 v39, 224, v32
s_lshl_b32 s64, s41, 3
s_lshl_b32 s48, s40, 1
s_add_u32 s65, s64, s48
s_sub_u32 s64, s64, 1
s_max_i32 s64, s64, 0
s_mul_i32 s65, s65, 20480
s_mul_i32 s64, s64, 20480
s_lshl_b32 s56, s40, 14
s_add_u32 s56, s56, 81920
s_cmp_eq_u32 s43, 0
s_cbranch_scc0 LB11
s_mov_b32 s36, s8
s_mov_b32 s37, s9
s_mov_b32 s38, s10
s_mov_b32 s39, s11
s_mov_b32 s46, 128
v_lshrrev_b32 v3, 3, v0
v_lshrrev_b32 v4, 1, v3
v_and_b32 v5, 7, v0
v_xor_b32 v4, v4, v5
v_and_b32 v4, 7, v4
v_lshlrev_b32 v4, 4, v4
v_mul_u32_u24 v3, 1280, v3
v_add_u32 v3, v3, v4
v_add_u32 v41, s65, v3
v_lshrrev_b32 v3, 3, v0
v_add_u32 v3, 8, v3
v_lshrrev_b32 v4, 1, v3
v_and_b32 v5, 7, v0
v_xor_b32 v4, v4, v5
v_and_b32 v4, 7, v4
v_lshlrev_b32 v4, 4, v4
v_mul_u32_u24 v3, 1280, v3
v_add_u32 v3, v3, v4
v_add_u32 v42, s65, v3
v_lshrrev_b32 v3, 3, v0
v_and_b32 v3, 3, v3
s_lshl_b32 s48, s40, 2
v_add_u32 v3, s48, v3
v_lshrrev_b32 v4, 1, v3
v_and_b32 v5, 7, v0
v_xor_b32 v4, v4, v5
v_and_b32 v4, 7, v4
v_lshlrev_b32 v4, 4, v4
v_mul_u32_u24 v3, 1280, v3
v_add_u32 v3, v3, v4
v_add_u32 v43, s64, v3
v_lshrrev_b32 v4, 1, v1
v_add_u32 v5, 0, v2
v_xor_b32 v4, v4, v5
v_lshlrev_b32 v4, 4, v4
v_lshlrev_b32 v3, 7, v1
v_add_u32 v44, v3, v4
v_lshrrev_b32 v4, 1, v1
v_add_u32 v5, 4, v2
v_xor_b32 v4, v4, v5
v_lshlrev_b32 v4, 4, v4
v_lshlrev_b32 v3, 7, v1
v_add_u32 v45, v3, v4
s_branch LB12
LB11:
s_add_u32 s36, s32, 12320768
s_addc_u32 s37, s33, 0
s_mov_b32 s38, 2621440
s_mov_b32 s39, 0x00020000
s_mov_b32 s46, 2048
v_lshlrev_b32 v3, 4, v0
v_add_u32 v41, s65, v3
v_add_u32 v42, 1024, v41
s_lshl_b32 s48, s40, 9
s_add_u32 s64, s64, s48
v_add_u32 v43, s64, v3
v_mov_b32 v44, v3
v_add_u32 v45, 1024, v3
LB12:
v_add_u32 v46, 147456, v44
v_add_u32 v47, 147456, v45
v_add_u32 v44, s56, v44
v_add_u32 v45, s56, v45
s_lshl_b32 s67, s40, 14
s_lshl_b32 s68, s40, 9
s_cmp_eq_u32 s43, 0
s_cbranch_scc1 LB15
s_cmp_lg_u32 s40, 0
s_cbranch_scc1 LB17
s_lshl_b32 s48, s43, 2
s_sub_u32 s48, s48, 1
s_add_u32 s55, s44, s48
s_lshl_b32 s48, s48, 11
s_add_u32 s48, s48, s57
v_lshlrev_b32 v3, 2, v1
v_add_u32 v3, s48, v3
s_cmp_eq_u32 s41, 0
s_cselect_b32 s56, 0, 128
v_and_b32 v5, 1, v2
v_mul_lo_u32 v5, v5, s56
v_sub_u32 v3, v3, v5
s_mov_b32 s56, 0
LB18:
buffer_load_dword v4, v3, s[32:35], 0 offen sc0 sc1
s_waitcnt vmcnt(0)
v_and_b32 v6, 0xffffff87, v4
v_cmp_ne_u32 vcc, s55, v6
s_cbranch_vccz LB17
s_add_u32 s56, s56, 1
s_cmp_lt_u32 s56, 20000
s_cbranch_scc1 LB18
LB17:
s_barrier
LB15:
v_mov_b32 v4, 0x3f803f80
v_mov_b32 v5, 0x3f803f80
v_mov_b32 v6, 0x3f803f80
v_mov_b32 v7, 0x3f803f80
s_cmp_eq_u32 s43, 0
s_cbranch_scc1 LB20
s_lshl_b32 s48, s41, 3
s_lshl_b32 s55, s40, 1
s_add_u32 s55, s55, s48
s_lshl_b32 s55, s55, 10
s_add_u32 s55, s55, 27394048
v_lshlrev_b32 v3, 4, v0
buffer_load_dwordx4 v[222:225], v3, s[32:35], s55 offen offset:0 sc1
buffer_load_dwordx4 v[226:229], v3, s[32:35], s55 offen offset:1024 sc1
s_sub_u32 s48, s48, 1
s_max_i32 s48, s48, 0
s_lshl_b32 s48, s48, 10
s_add_u32 s48, s48, 27394048
buffer_load_dwordx4 v[230:233], v3, s[32:35], s48 offen sc1
LB20:
s_cmp_eq_u32 s43, 0
s_cbranch_scc0 LB21
buffer_load_dwordx2 v[10:11], v20, s[8:11], 0 offen offset:0
buffer_load_dwordx2 v[12:13], v20, s[8:11], 0 offen offset:32
buffer_load_dwordx2 v[14:15], v20, s[8:11], 0 offen offset:64
buffer_load_dwordx2 v[16:17], v20, s[8:11], 0 offen offset:96
buffer_load_dwordx2 v[18:19], v21, s[8:11], 0 offen
LB21:
s_barrier
ds_read_b128 v[192:195], v44 offset:0
ds_read_b128 v[196:199], v44 offset:8192
ds_read_b128 v[200:203], v46 offset:0
ds_read_b64_tr_b16 v[128:129], v24 offset:0
ds_read_b64_tr_b16 v[130:131], v32 offset:0
ds_read_b64_tr_b16 v[132:133], v25 offset:0
ds_read_b64_tr_b16 v[134:135], v33 offset:0
ds_read_b64_tr_b16 v[136:137], v26 offset:0
ds_read_b64_tr_b16 v[138:139], v34 offset:0
ds_read_b64_tr_b16 v[140:141], v27 offset:0
ds_read_b64_tr_b16 v[142:143], v35 offset:0
ds_read_b64_tr_b16 v[144:145], v28 offset:0
ds_read_b64_tr_b16 v[146:147], v36 offset:0
ds_read_b64_tr_b16 v[148:149], v29 offset:0
ds_read_b64_tr_b16 v[150:151], v37 offset:0
ds_read_b64_tr_b16 v[152:153], v30 offset:0
ds_read_b64_tr_b16 v[154:155], v38 offset:0
ds_read_b64_tr_b16 v[156:157], v31 offset:0
ds_read_b64_tr_b16 v[158:159], v39 offset:0
s_waitcnt lgkmcnt(0)
v_mfma_f32_16x16x32_bf16 v[48:51], v[128:131], v[192:195], 0
ds_read_b128 v[204:207], v45 offset:0
ds_read_b128 v[208:211], v45 offset:8192
v_mfma_f32_16x16x32_bf16 v[80:83], v[128:131], v[196:199], 0
ds_read_b128 v[212:215], v47 offset:0
v_mfma_f32_16x16x32_bf16 v[112:115], v[128:131], v[200:203], 0
ds_read_b64_tr_b16 v[160:161], v24 offset:8192
v_mfma_f32_16x16x32_bf16 v[52:55], v[132:135], v[192:195], 0
ds_read_b64_tr_b16 v[162:163], v32 offset:8192
ds_read_b64_tr_b16 v[164:165], v25 offset:8192
v_mfma_f32_16x16x32_bf16 v[84:87], v[132:135], v[196:199], 0
ds_read_b64_tr_b16 v[166:167], v33 offset:8192
v_mfma_f32_16x16x32_bf16 v[116:119], v[132:135], v[200:203], 0
ds_read_b64_tr_b16 v[168:169], v26 offset:8192
v_mfma_f32_16x16x32_bf16 v[56:59], v[136:139], v[192:195], 0
ds_read_b64_tr_b16 v[170:171], v34 offset:8192
ds_read_b64_tr_b16 v[172:173], v27 offset:8192
v_mfma_f32_16x16x32_bf16 v[88:91], v[136:139], v[196:199], 0
ds_read_b64_tr_b16 v[174:175], v35 offset:8192
v_mfma_f32_16x16x32_bf16 v[60:63], v[140:143], v[192:195], 0
ds_read_b64_tr_b16 v[176:177], v28 offset:8192
v_mfma_f32_16x16x32_bf16 v[92:95], v[140:143], v[196:199], 0
ds_read_b64_tr_b16 v[178:179], v36 offset:8192
ds_read_b64_tr_b16 v[180:181], v29 offset:8192
v_mfma_f32_16x16x32_bf16 v[64:67], v[144:147], v[192:195], 0
ds_read_b64_tr_b16 v[182:183], v37 offset:8192
v_mfma_f32_16x16x32_bf16 v[96:99], v[144:147], v[196:199], 0
ds_read_b64_tr_b16 v[184:185], v30 offset:8192
v_mfma_f32_16x16x32_bf16 v[68:71], v[148:151], v[192:195], 0
ds_read_b64_tr_b16 v[186:187], v38 offset:8192
ds_read_b64_tr_b16 v[188:189], v31 offset:8192
v_mfma_f32_16x16x32_bf16 v[100:103], v[148:151], v[196:199], 0
ds_read_b64_tr_b16 v[190:191], v39 offset:8192
v_mfma_f32_16x16x32_bf16 v[72:75], v[152:155], v[192:195], 0
v_mfma_f32_16x16x32_bf16 v[104:107], v[152:155], v[196:199], 0
v_mfma_f32_16x16x32_bf16 v[76:79], v[156:159], v[192:195], 0
v_mfma_f32_16x16x32_bf16 v[108:111], v[156:159], v[196:199], 0
s_cmp_eq_u32 s43, 0
s_cbranch_scc0 LB22
v_mfma_f32_16x16x32_bf16 v[120:123], v[128:131], v[4:7], 0
v_mfma_f32_16x16x32_bf16 v[124:127], v[132:135], v[4:7], 0
v_mfma_f32_16x16x32_bf16 v[222:225], v[4:7], v[192:195], 0
v_mfma_f32_16x16x32_bf16 v[226:229], v[192:195], v[192:195], 0
v_mfma_f32_16x16x32_bf16 v[230:233], v[4:7], v[196:199], 0
v_mfma_f32_16x16x32_bf16 v[234:237], v[196:199], v[196:199], 0
v_mfma_f32_16x16x32_bf16 v[238:241], v[4:7], v[200:203], 0
v_mfma_f32_16x16x32_bf16 v[242:245], v[200:203], v[200:203], 0
LB22:
s_waitcnt lgkmcnt(0)
s_barrier
v_mfma_f32_16x16x32_bf16 v[48:51], v[160:163], v[204:207], v[48:51]
ds_read_b128 v[192:195], v44 offset:2048
ds_read_b128 v[196:199], v44 offset:10240
v_mfma_f32_16x16x32_bf16 v[80:83], v[160:163], v[208:211], v[80:83]
ds_read_b128 v[200:203], v46 offset:2048
v_mfma_f32_16x16x32_bf16 v[112:115], v[160:163], v[212:215], v[112:115]
ds_read_b64_tr_b16 v[128:129], v24 offset:16384
v_mfma_f32_16x16x32_bf16 v[52:55], v[164:167], v[204:207], v[52:55]
ds_read_b64_tr_b16 v[130:131], v32 offset:16384
ds_read_b64_tr_b16 v[132:133], v25 offset:16384
v_mfma_f32_16x16x32_bf16 v[84:87], v[164:167], v[208:211], v[84:87]
ds_read_b64_tr_b16 v[134:135], v33 offset:16384
v_mfma_f32_16x16x32_bf16 v[116:119], v[164:167], v[212:215], v[116:119]
ds_read_b64_tr_b16 v[136:137], v26 offset:16384
v_mfma_f32_16x16x32_bf16 v[56:59], v[168:171], v[204:207], v[56:59]
ds_read_b64_tr_b16 v[138:139], v34 offset:16384
ds_read_b64_tr_b16 v[140:141], v27 offset:16384
v_mfma_f32_16x16x32_bf16 v[88:91], v[168:171], v[208:211], v[88:91]
ds_read_b64_tr_b16 v[142:143], v35 offset:16384
v_mfma_f32_16x16x32_bf16 v[60:63], v[172:175], v[204:207], v[60:63]
ds_read_b64_tr_b16 v[144:145], v28 offset:16384
v_mfma_f32_16x16x32_bf16 v[92:95], v[172:175], v[208:211], v[92:95]
ds_read_b64_tr_b16 v[146:147], v36 offset:16384
ds_read_b64_tr_b16 v[148:149], v29 offset:16384
v_mfma_f32_16x16x32_bf16 v[64:67], v[176:179], v[204:207], v[64:67]
ds_read_b64_tr_b16 v[150:151], v37 offset:16384
v_mfma_f32_16x16x32_bf16 v[96:99], v[176:179], v[208:211], v[96:99]
ds_read_b64_tr_b16 v[152:153], v30 offset:16384
v_mfma_f32_16x16x32_bf16 v[68:71], v[180:183], v[204:207], v[68:71]
ds_read_b64_tr_b16 v[154:155], v38 offset:16384
ds_read_b64_tr_b16 v[156:157], v31 offset:16384
v_mfma_f32_16x16x32_bf16 v[100:103], v[180:183], v[208:211], v[100:103]
ds_read_b64_tr_b16 v[158:159], v39 offset:16384
v_mfma_f32_16x16x32_bf16 v[72:75], v[184:187], v[204:207], v[72:75]
v_mfma_f32_16x16x32_bf16 v[104:107], v[184:187], v[208:211], v[104:107]
v_mfma_f32_16x16x32_bf16 v[76:79], v[188:191], v[204:207], v[76:79]
v_mfma_f32_16x16x32_bf16 v[108:111], v[188:191], v[208:211], v[108:111]
s_cmp_eq_u32 s43, 0
s_cbranch_scc0 LB23
v_mfma_f32_16x16x32_bf16 v[120:123], v[160:163], v[4:7], v[120:123]
v_mfma_f32_16x16x32_bf16 v[124:127], v[164:167], v[4:7], v[124:127]
v_mfma_f32_16x16x32_bf16 v[222:225], v[4:7], v[204:207], v[222:225]
v_mfma_f32_16x16x32_bf16 v[226:229], v[204:207], v[204:207], v[226:229]
v_mfma_f32_16x16x32_bf16 v[230:233], v[4:7], v[208:211], v[230:233]
v_mfma_f32_16x16x32_bf16 v[234:237], v[208:211], v[208:211], v[234:237]
v_mfma_f32_16x16x32_bf16 v[238:241], v[4:7], v[212:215], v[238:241]
v_mfma_f32_16x16x32_bf16 v[242:245], v[212:215], v[212:215], v[242:245]
LB23:
s_waitcnt lgkmcnt(0)
v_mfma_f32_16x16x32_bf16 v[48:51], v[128:131], v[192:195], v[48:51]
ds_read_b128 v[204:207], v45 offset:2048
ds_read_b128 v[208:211], v45 offset:10240
v_mfma_f32_16x16x32_bf16 v[80:83], v[128:131], v[196:199], v[80:83]
ds_read_b128 v[212:215], v47 offset:2048
v_mfma_f32_16x16x32_bf16 v[112:115], v[128:131], v[200:203], v[112:115]
ds_read_b64_tr_b16 v[160:161], v24 offset:24576
v_mfma_f32_16x16x32_bf16 v[52:55], v[132:135], v[192:195], v[52:55]
ds_read_b64_tr_b16 v[162:163], v32 offset:24576
ds_read_b64_tr_b16 v[164:165], v25 offset:24576
v_mfma_f32_16x16x32_bf16 v[84:87], v[132:135], v[196:199], v[84:87]
ds_read_b64_tr_b16 v[166:167], v33 offset:24576
v_mfma_f32_16x16x32_bf16 v[116:119], v[132:135], v[200:203], v[116:119]
ds_read_b64_tr_b16 v[168:169], v26 offset:24576
v_mfma_f32_16x16x32_bf16 v[56:59], v[136:139], v[192:195], v[56:59]
ds_read_b64_tr_b16 v[170:171], v34 offset:24576
ds_read_b64_tr_b16 v[172:173], v27 offset:24576
v_mfma_f32_16x16x32_bf16 v[88:91], v[136:139], v[196:199], v[88:91]
ds_read_b64_tr_b16 v[174:175], v35 offset:24576
v_mfma_f32_16x16x32_bf16 v[60:63], v[140:143], v[192:195], v[60:63]
ds_read_b64_tr_b16 v[176:177], v28 offset:24576
v_mfma_f32_16x16x32_bf16 v[92:95], v[140:143], v[196:199], v[92:95]
ds_read_b64_tr_b16 v[178:179], v36 offset:24576
ds_read_b64_tr_b16 v[180:181], v29 offset:24576
v_mfma_f32_16x16x32_bf16 v[64:67], v[144:147], v[192:195], v[64:67]
ds_read_b64_tr_b16 v[182:183], v37 offset:24576
v_mfma_f32_16x16x32_bf16 v[96:99], v[144:147], v[196:199], v[96:99]
ds_read_b64_tr_b16 v[184:185], v30 offset:24576
v_mfma_f32_16x16x32_bf16 v[68:71], v[148:151], v[192:195], v[68:71]
ds_read_b64_tr_b16 v[186:187], v38 offset:24576
ds_read_b64_tr_b16 v[188:189], v31 offset:24576
v_mfma_f32_16x16x32_bf16 v[100:103], v[148:151], v[196:199], v[100:103]
ds_read_b64_tr_b16 v[190:191], v39 offset:24576
v_mfma_f32_16x16x32_bf16 v[72:75], v[152:155], v[192:195], v[72:75]
v_mfma_f32_16x16x32_bf16 v[104:107], v[152:155], v[196:199], v[104:107]
v_mfma_f32_16x16x32_bf16 v[76:79], v[156:159], v[192:195], v[76:79]
v_mfma_f32_16x16x32_bf16 v[108:111], v[156:159], v[196:199], v[108:111]
s_cmp_eq_u32 s43, 0
s_cbranch_scc0 LB24
v_mfma_f32_16x16x32_bf16 v[120:123], v[128:131], v[4:7], v[120:123]
v_mfma_f32_16x16x32_bf16 v[124:127], v[132:135], v[4:7], v[124:127]
v_mfma_f32_16x16x32_bf16 v[222:225], v[4:7], v[192:195], v[222:225]
v_mfma_f32_16x16x32_bf16 v[226:229], v[192:195], v[192:195], v[226:229]
v_mfma_f32_16x16x32_bf16 v[230:233], v[4:7], v[196:199], v[230:233]
v_mfma_f32_16x16x32_bf16 v[234:237], v[196:199], v[196:199], v[234:237]
v_mfma_f32_16x16x32_bf16 v[238:241], v[4:7], v[200:203], v[238:241]
v_mfma_f32_16x16x32_bf16 v[242:245], v[200:203], v[200:203], v[242:245]
LB24:
s_waitcnt lgkmcnt(0)
s_barrier
v_mfma_f32_16x16x32_bf16 v[48:51], v[160:163], v[204:207], v[48:51]
ds_read_b128 v[192:195], v44 offset:4096
ds_read_b128 v[196:199], v44 offset:12288
v_mfma_f32_16x16x32_bf16 v[80:83], v[160:163], v[208:211], v[80:83]
ds_read_b128 v[200:203], v46 offset:4096
v_mfma_f32_16x16x32_bf16 v[112:115], v[160:163], v[212:215], v[112:115]
ds_read_b64_tr_b16 v[128:129], v24 offset:32768
v_mfma_f32_16x16x32_bf16 v[52:55], v[164:167], v[204:207], v[52:55]
ds_read_b64_tr_b16 v[130:131], v32 offset:32768
ds_read_b64_tr_b16 v[132:133], v25 offset:32768
v_mfma_f32_16x16x32_bf16 v[84:87], v[164:167], v[208:211], v[84:87]
ds_read_b64_tr_b16 v[134:135], v33 offset:32768
v_mfma_f32_16x16x32_bf16 v[116:119], v[164:167], v[212:215], v[116:119]
ds_read_b64_tr_b16 v[136:137], v26 offset:32768
v_mfma_f32_16x16x32_bf16 v[56:59], v[168:171], v[204:207], v[56:59]
ds_read_b64_tr_b16 v[138:139], v34 offset:32768
ds_read_b64_tr_b16 v[140:141], v27 offset:32768
v_mfma_f32_16x16x32_bf16 v[88:91], v[168:171], v[208:211], v[88:91]
ds_read_b64_tr_b16 v[142:143], v35 offset:32768
v_mfma_f32_16x16x32_bf16 v[60:63], v[172:175], v[204:207], v[60:63]
ds_read_b64_tr_b16 v[144:145], v28 offset:32768
v_mfma_f32_16x16x32_bf16 v[92:95], v[172:175], v[208:211], v[92:95]
ds_read_b64_tr_b16 v[146:147], v36 offset:32768
ds_read_b64_tr_b16 v[148:149], v29 offset:32768
v_mfma_f32_16x16x32_bf16 v[64:67], v[176:179], v[204:207], v[64:67]
ds_read_b64_tr_b16 v[150:151], v37 offset:32768
v_mfma_f32_16x16x32_bf16 v[96:99], v[176:179], v[208:211], v[96:99]
ds_read_b64_tr_b16 v[152:153], v30 offset:32768
v_mfma_f32_16x16x32_bf16 v[68:71], v[180:183], v[204:207], v[68:71]
ds_read_b64_tr_b16 v[154:155], v38 offset:32768
ds_read_b64_tr_b16 v[156:157], v31 offset:32768
v_mfma_f32_16x16x32_bf16 v[100:103], v[180:183], v[208:211], v[100:103]
ds_read_b64_tr_b16 v[158:159], v39 offset:32768
v_mfma_f32_16x16x32_bf16 v[72:75], v[184:187], v[204:207], v[72:75]
v_mfma_f32_16x16x32_bf16 v[104:107], v[184:187], v[208:211], v[104:107]
v_mfma_f32_16x16x32_bf16 v[76:79], v[188:191], v[204:207], v[76:79]
v_mfma_f32_16x16x32_bf16 v[108:111], v[188:191], v[208:211], v[108:111]
s_cmp_eq_u32 s43, 0
s_cbranch_scc0 LB25
v_mfma_f32_16x16x32_bf16 v[120:123], v[160:163], v[4:7], v[120:123]
v_mfma_f32_16x16x32_bf16 v[124:127], v[164:167], v[4:7], v[124:127]
v_mfma_f32_16x16x32_bf16 v[222:225], v[4:7], v[204:207], v[222:225]
v_mfma_f32_16x16x32_bf16 v[226:229], v[204:207], v[204:207], v[226:229]
v_mfma_f32_16x16x32_bf16 v[230:233], v[4:7], v[208:211], v[230:233]
v_mfma_f32_16x16x32_bf16 v[234:237], v[208:211], v[208:211], v[234:237]
v_mfma_f32_16x16x32_bf16 v[238:241], v[4:7], v[212:215], v[238:241]
v_mfma_f32_16x16x32_bf16 v[242:245], v[212:215], v[212:215], v[242:245]
LB25:
s_waitcnt lgkmcnt(0)
v_mfma_f32_16x16x32_bf16 v[48:51], v[128:131], v[192:195], v[48:51]
ds_read_b128 v[204:207], v45 offset:4096
ds_read_b128 v[208:211], v45 offset:12288
v_mfma_f32_16x16x32_bf16 v[80:83], v[128:131], v[196:199], v[80:83]
ds_read_b128 v[212:215], v47 offset:4096
v_mfma_f32_16x16x32_bf16 v[112:115], v[128:131], v[200:203], v[112:115]
ds_read_b64_tr_b16 v[160:161], v24 offset:40960
v_mfma_f32_16x16x32_bf16 v[52:55], v[132:135], v[192:195], v[52:55]
ds_read_b64_tr_b16 v[162:163], v32 offset:40960
ds_read_b64_tr_b16 v[164:165], v25 offset:40960
v_mfma_f32_16x16x32_bf16 v[84:87], v[132:135], v[196:199], v[84:87]
ds_read_b64_tr_b16 v[166:167], v33 offset:40960
v_mfma_f32_16x16x32_bf16 v[116:119], v[132:135], v[200:203], v[116:119]
ds_read_b64_tr_b16 v[168:169], v26 offset:40960
v_mfma_f32_16x16x32_bf16 v[56:59], v[136:139], v[192:195], v[56:59]
ds_read_b64_tr_b16 v[170:171], v34 offset:40960
ds_read_b64_tr_b16 v[172:173], v27 offset:40960
v_mfma_f32_16x16x32_bf16 v[88:91], v[136:139], v[196:199], v[88:91]
ds_read_b64_tr_b16 v[174:175], v35 offset:40960
v_mfma_f32_16x16x32_bf16 v[60:63], v[140:143], v[192:195], v[60:63]
ds_read_b64_tr_b16 v[176:177], v28 offset:40960
v_mfma_f32_16x16x32_bf16 v[92:95], v[140:143], v[196:199], v[92:95]
ds_read_b64_tr_b16 v[178:179], v36 offset:40960
ds_read_b64_tr_b16 v[180:181], v29 offset:40960
v_mfma_f32_16x16x32_bf16 v[64:67], v[144:147], v[192:195], v[64:67]
ds_read_b64_tr_b16 v[182:183], v37 offset:40960
v_mfma_f32_16x16x32_bf16 v[96:99], v[144:147], v[196:199], v[96:99]
ds_read_b64_tr_b16 v[184:185], v30 offset:40960
v_mfma_f32_16x16x32_bf16 v[68:71], v[148:151], v[192:195], v[68:71]
ds_read_b64_tr_b16 v[186:187], v38 offset:40960
ds_read_b64_tr_b16 v[188:189], v31 offset:40960
v_mfma_f32_16x16x32_bf16 v[100:103], v[148:151], v[196:199], v[100:103]
ds_read_b64_tr_b16 v[190:191], v39 offset:40960
v_mfma_f32_16x16x32_bf16 v[72:75], v[152:155], v[192:195], v[72:75]
v_mfma_f32_16x16x32_bf16 v[104:107], v[152:155], v[196:199], v[104:107]
v_mfma_f32_16x16x32_bf16 v[76:79], v[156:159], v[192:195], v[76:79]
v_mfma_f32_16x16x32_bf16 v[108:111], v[156:159], v[196:199], v[108:111]
s_cmp_eq_u32 s43, 0
s_cbranch_scc0 LB26
v_mfma_f32_16x16x32_bf16 v[120:123], v[128:131], v[4:7], v[120:123]
v_mfma_f32_16x16x32_bf16 v[124:127], v[132:135], v[4:7], v[124:127]
v_mfma_f32_16x16x32_bf16 v[222:225], v[4:7], v[192:195], v[222:225]
v_mfma_f32_16x16x32_bf16 v[226:229], v[192:195], v[192:195], v[226:229]
v_mfma_f32_16x16x32_bf16 v[230:233], v[4:7], v[196:199], v[230:233]
v_mfma_f32_16x16x32_bf16 v[234:237], v[196:199], v[196:199], v[234:237]
v_mfma_f32_16x16x32_bf16 v[238:241], v[4:7], v[200:203], v[238:241]
v_mfma_f32_16x16x32_bf16 v[242:245], v[200:203], v[200:203], v[242:245]
LB26:
s_waitcnt lgkmcnt(0)
s_barrier
v_mfma_f32_16x16x32_bf16 v[48:51], v[160:163], v[204:207], v[48:51]
ds_read_b128 v[192:195], v44 offset:6144
ds_read_b128 v[196:199], v44 offset:14336
v_mfma_f32_16x16x32_bf16 v[80:83], v[160:163], v[208:211], v[80:83]
ds_read_b128 v[200:203], v46 offset:6144
v_mfma_f32_16x16x32_bf16 v[112:115], v[160:163], v[212:215], v[112:115]
ds_read_b64_tr_b16 v[128:129], v24 offset:49152
v_mfma_f32_16x16x32_bf16 v[52:55], v[164:167], v[204:207], v[52:55]
ds_read_b64_tr_b16 v[130:131], v32 offset:49152
ds_read_b64_tr_b16 v[132:133], v25 offset:49152
v_mfma_f32_16x16x32_bf16 v[84:87], v[164:167], v[208:211], v[84:87]
ds_read_b64_tr_b16 v[134:135], v33 offset:49152
v_mfma_f32_16x16x32_bf16 v[116:119], v[164:167], v[212:215], v[116:119]
ds_read_b64_tr_b16 v[136:137], v26 offset:49152
v_mfma_f32_16x16x32_bf16 v[56:59], v[168:171], v[204:207], v[56:59]
ds_read_b64_tr_b16 v[138:139], v34 offset:49152
ds_read_b64_tr_b16 v[140:141], v27 offset:49152
v_mfma_f32_16x16x32_bf16 v[88:91], v[168:171], v[208:211], v[88:91]
ds_read_b64_tr_b16 v[142:143], v35 offset:49152
v_mfma_f32_16x16x32_bf16 v[60:63], v[172:175], v[204:207], v[60:63]
ds_read_b64_tr_b16 v[144:145], v28 offset:49152
v_mfma_f32_16x16x32_bf16 v[92:95], v[172:175], v[208:211], v[92:95]
ds_read_b64_tr_b16 v[146:147], v36 offset:49152
ds_read_b64_tr_b16 v[148:149], v29 offset:49152
v_mfma_f32_16x16x32_bf16 v[64:67], v[176:179], v[204:207], v[64:67]
ds_read_b64_tr_b16 v[150:151], v37 offset:49152
v_mfma_f32_16x16x32_bf16 v[96:99], v[176:179], v[208:211], v[96:99]
ds_read_b64_tr_b16 v[152:153], v30 offset:49152
v_mfma_f32_16x16x32_bf16 v[68:71], v[180:183], v[204:207], v[68:71]
ds_read_b64_tr_b16 v[154:155], v38 offset:49152
ds_read_b64_tr_b16 v[156:157], v31 offset:49152
v_mfma_f32_16x16x32_bf16 v[100:103], v[180:183], v[208:211], v[100:103]
ds_read_b64_tr_b16 v[158:159], v39 offset:49152
v_mfma_f32_16x16x32_bf16 v[72:75], v[184:187], v[204:207], v[72:75]
v_mfma_f32_16x16x32_bf16 v[104:107], v[184:187], v[208:211], v[104:107]
v_mfma_f32_16x16x32_bf16 v[76:79], v[188:191], v[204:207], v[76:79]
v_mfma_f32_16x16x32_bf16 v[108:111], v[188:191], v[208:211], v[108:111]
s_cmp_eq_u32 s43, 0
s_cbranch_scc0 LB27
v_mfma_f32_16x16x32_bf16 v[120:123], v[160:163], v[4:7], v[120:123]
v_mfma_f32_16x16x32_bf16 v[124:127], v[164:167], v[4:7], v[124:127]
v_mfma_f32_16x16x32_bf16 v[222:225], v[4:7], v[204:207], v[222:225]
v_mfma_f32_16x16x32_bf16 v[226:229], v[204:207], v[204:207], v[226:229]
v_mfma_f32_16x16x32_bf16 v[230:233], v[4:7], v[208:211], v[230:233]
v_mfma_f32_16x16x32_bf16 v[234:237], v[208:211], v[208:211], v[234:237]
v_mfma_f32_16x16x32_bf16 v[238:241], v[4:7], v[212:215], v[238:241]
v_mfma_f32_16x16x32_bf16 v[242:245], v[212:215], v[212:215], v[242:245]
LB27:
s_waitcnt lgkmcnt(0)
s_cmp_eq_u32 s43, 0
s_cbranch_scc0 LB28
s_waitcnt vmcnt(0)
LB28:
v_mfma_f32_16x16x32_bf16 v[48:51], v[128:131], v[192:195], v[48:51]
ds_read_b128 v[204:207], v45 offset:6144
ds_read_b128 v[208:211], v45 offset:14336
v_mfma_f32_16x16x32_bf16 v[80:83], v[128:131], v[196:199], v[80:83]
ds_read_b128 v[212:215], v47 offset:6144
v_mfma_f32_16x16x32_bf16 v[112:115], v[128:131], v[200:203], v[112:115]
ds_read_b64_tr_b16 v[160:161], v24 offset:57344
v_mfma_f32_16x16x32_bf16 v[52:55], v[132:135], v[192:195], v[52:55]
ds_read_b64_tr_b16 v[162:163], v32 offset:57344
ds_read_b64_tr_b16 v[164:165], v25 offset:57344
v_mfma_f32_16x16x32_bf16 v[84:87], v[132:135], v[196:199], v[84:87]
ds_read_b64_tr_b16 v[166:167], v33 offset:57344
v_mfma_f32_16x16x32_bf16 v[116:119], v[132:135], v[200:203], v[116:119]
ds_read_b64_tr_b16 v[168:169], v26 offset:57344
v_mfma_f32_16x16x32_bf16 v[56:59], v[136:139], v[192:195], v[56:59]
ds_read_b64_tr_b16 v[170:171], v34 offset:57344
ds_read_b64_tr_b16 v[172:173], v27 offset:57344
v_mfma_f32_16x16x32_bf16 v[88:91], v[136:139], v[196:199], v[88:91]
ds_read_b64_tr_b16 v[174:175], v35 offset:57344
v_mfma_f32_16x16x32_bf16 v[60:63], v[140:143], v[192:195], v[60:63]
ds_read_b64_tr_b16 v[176:177], v28 offset:57344
v_mfma_f32_16x16x32_bf16 v[92:95], v[140:143], v[196:199], v[92:95]
ds_read_b64_tr_b16 v[178:179], v36 offset:57344
ds_read_b64_tr_b16 v[180:181], v29 offset:57344
v_mfma_f32_16x16x32_bf16 v[64:67], v[144:147], v[192:195], v[64:67]
ds_read_b64_tr_b16 v[182:183], v37 offset:57344
v_mfma_f32_16x16x32_bf16 v[96:99], v[144:147], v[196:199], v[96:99]
ds_read_b64_tr_b16 v[184:185], v30 offset:57344
v_mfma_f32_16x16x32_bf16 v[68:71], v[148:151], v[192:195], v[68:71]
ds_read_b64_tr_b16 v[186:187], v38 offset:57344
ds_read_b64_tr_b16 v[188:189], v31 offset:57344
v_mfma_f32_16x16x32_bf16 v[100:103], v[148:151], v[196:199], v[100:103]
ds_read_b64_tr_b16 v[190:191], v39 offset:57344
v_mfma_f32_16x16x32_bf16 v[72:75], v[152:155], v[192:195], v[72:75]
v_mfma_f32_16x16x32_bf16 v[104:107], v[152:155], v[196:199], v[104:107]
v_mfma_f32_16x16x32_bf16 v[76:79], v[156:159], v[192:195], v[76:79]
v_mfma_f32_16x16x32_bf16 v[108:111], v[156:159], v[196:199], v[108:111]
s_cmp_eq_u32 s43, 0
s_cbranch_scc0 LB29
v_mfma_f32_16x16x32_bf16 v[120:123], v[128:131], v[4:7], v[120:123]
v_mfma_f32_16x16x32_bf16 v[124:127], v[132:135], v[4:7], v[124:127]
v_mfma_f32_16x16x32_bf16 v[222:225], v[4:7], v[192:195], v[222:225]
v_mfma_f32_16x16x32_bf16 v[226:229], v[192:195], v[192:195], v[226:229]
v_mfma_f32_16x16x32_bf16 v[230:233], v[4:7], v[196:199], v[230:233]
v_mfma_f32_16x16x32_bf16 v[234:237], v[196:199], v[196:199], v[234:237]
v_mfma_f32_16x16x32_bf16 v[238:241], v[4:7], v[200:203], v[238:241]
v_mfma_f32_16x16x32_bf16 v[242:245], v[200:203], v[200:203], v[242:245]
LB29:
s_waitcnt lgkmcnt(0)
s_barrier
v_mfma_f32_16x16x32_bf16 v[48:51], v[160:163], v[204:207], v[48:51]
ds_read_b128 v[192:195], v44 offset:0
ds_read_b128 v[196:199], v44 offset:8192
v_mfma_f32_16x16x32_bf16 v[80:83], v[160:163], v[208:211], v[80:83]
ds_read_b128 v[200:203], v46 offset:0
v_mfma_f32_16x16x32_bf16 v[112:115], v[160:163], v[212:215], v[112:115]
ds_read_b64_tr_b16 v[128:129], v24 offset:0
v_mfma_f32_16x16x32_bf16 v[52:55], v[164:167], v[204:207], v[52:55]
ds_read_b64_tr_b16 v[130:131], v32 offset:0
ds_read_b64_tr_b16 v[132:133], v25 offset:0
v_mfma_f32_16x16x32_bf16 v[84:87], v[164:167], v[208:211], v[84:87]
ds_read_b64_tr_b16 v[134:135], v33 offset:0
v_mfma_f32_16x16x32_bf16 v[116:119], v[164:167], v[212:215], v[116:119]
ds_read_b64_tr_b16 v[136:137], v26 offset:0
v_mfma_f32_16x16x32_bf16 v[56:59], v[168:171], v[204:207], v[56:59]
ds_read_b64_tr_b16 v[138:139], v34 offset:0
ds_read_b64_tr_b16 v[140:141], v27 offset:0
v_mfma_f32_16x16x32_bf16 v[88:91], v[168:171], v[208:211], v[88:91]
ds_read_b64_tr_b16 v[142:143], v35 offset:0
v_mfma_f32_16x16x32_bf16 v[60:63], v[172:175], v[204:207], v[60:63]
ds_read_b64_tr_b16 v[144:145], v28 offset:0
v_mfma_f32_16x16x32_bf16 v[92:95], v[172:175], v[208:211], v[92:95]
ds_read_b64_tr_b16 v[146:147], v36 offset:0
ds_read_b64_tr_b16 v[148:149], v29 offset:0
v_mfma_f32_16x16x32_bf16 v[64:67], v[176:179], v[204:207], v[64:67]
ds_read_b64_tr_b16 v[150:151], v37 offset:0
v_mfma_f32_16x16x32_bf16 v[96:99], v[176:179], v[208:211], v[96:99]
ds_read_b64_tr_b16 v[152:153], v30 offset:0
v_mfma_f32_16x16x32_bf16 v[68:71], v[180:183], v[204:207], v[68:71]
ds_read_b64_tr_b16 v[154:155], v38 offset:0
ds_read_b64_tr_b16 v[156:157], v31 offset:0
v_mfma_f32_16x16x32_bf16 v[100:103], v[180:183], v[208:211], v[100:103]
ds_read_b64_tr_b16 v[158:159], v39 offset:0
v_mfma_f32_16x16x32_bf16 v[72:75], v[184:187], v[204:207], v[72:75]
v_mfma_f32_16x16x32_bf16 v[104:107], v[184:187], v[208:211], v[104:107]
v_mfma_f32_16x16x32_bf16 v[76:79], v[188:191], v[204:207], v[76:79]
v_mfma_f32_16x16x32_bf16 v[108:111], v[188:191], v[208:211], v[108:111]
s_cmp_eq_u32 s43, 0
s_cbranch_scc0 LB30
v_mfma_f32_16x16x32_bf16 v[120:123], v[160:163], v[4:7], v[120:123]
v_mfma_f32_16x16x32_bf16 v[124:127], v[164:167], v[4:7], v[124:127]
v_mfma_f32_16x16x32_bf16 v[222:225], v[4:7], v[204:207], v[222:225]
v_mfma_f32_16x16x32_bf16 v[226:229], v[204:207], v[204:207], v[226:229]
v_mfma_f32_16x16x32_bf16 v[230:233], v[4:7], v[208:211], v[230:233]
v_mfma_f32_16x16x32_bf16 v[234:237], v[208:211], v[208:211], v[234:237]
v_mfma_f32_16x16x32_bf16 v[238:241], v[4:7], v[212:215], v[238:241]
v_mfma_f32_16x16x32_bf16 v[242:245], v[212:215], v[212:215], v[242:245]
LB30:
s_waitcnt lgkmcnt(0)
s_add_u32 s48, s43, s40
s_cmp_eq_u32 s48, 0
s_cbranch_scc0 LB31
s_and_b32 s48, s2, 31
s_lshl_b32 s48, s48, 2
s_add_u32 s48, s48, 128
v_mov_b32 v8, s48
v_mov_b32 v9, 1
s_mov_b64 exec, 1
buffer_atomic_add v9, v8, s[60:63], 0 offen sc1
s_mov_b64 exec, -1
LB31:
v_mfma_f32_16x16x32_bf16 v[48:51], v[128:131], v[192:195], v[48:51]
ds_read_b128 v[204:207], v45 offset:0
ds_read_b128 v[208:211], v45 offset:8192
v_mfma_f32_16x16x32_bf16 v[80:83], v[128:131], v[196:199], v[80:83]
ds_read_b128 v[212:215], v47 offset:0
v_mfma_f32_16x16x32_bf16 v[112:115], v[128:131], v[200:203], v[112:115]
ds_read_b64_tr_b16 v[160:161], v24 offset:8192
v_mfma_f32_16x16x32_bf16 v[52:55], v[132:135], v[192:195], v[52:55]
ds_read_b64_tr_b16 v[162:163], v32 offset:8192
ds_read_b64_tr_b16 v[164:165], v25 offset:8192
v_mfma_f32_16x16x32_bf16 v[84:87], v[132:135], v[196:199], v[84:87]
ds_read_b64_tr_b16 v[166:167], v33 offset:8192
v_mfma_f32_16x16x32_bf16 v[116:119], v[132:135], v[200:203], v[116:119]
ds_read_b64_tr_b16 v[168:169], v26 offset:8192
v_mfma_f32_16x16x32_bf16 v[56:59], v[136:139], v[192:195], v[56:59]
ds_read_b64_tr_b16 v[170:171], v34 offset:8192
ds_read_b64_tr_b16 v[172:173], v27 offset:8192
v_mfma_f32_16x16x32_bf16 v[88:91], v[136:139], v[196:199], v[88:91]
ds_read_b64_tr_b16 v[174:175], v35 offset:8192
v_mfma_f32_16x16x32_bf16 v[60:63], v[140:143], v[192:195], v[60:63]
ds_read_b64_tr_b16 v[176:177], v28 offset:8192
v_mfma_f32_16x16x32_bf16 v[92:95], v[140:143], v[196:199], v[92:95]
ds_read_b64_tr_b16 v[178:179], v36 offset:8192
ds_read_b64_tr_b16 v[180:181], v29 offset:8192
v_mfma_f32_16x16x32_bf16 v[64:67], v[144:147], v[192:195], v[64:67]
ds_read_b64_tr_b16 v[182:183], v37 offset:8192
v_mfma_f32_16x16x32_bf16 v[96:99], v[144:147], v[196:199], v[96:99]
ds_read_b64_tr_b16 v[184:185], v30 offset:8192
v_mfma_f32_16x16x32_bf16 v[68:71], v[148:151], v[192:195], v[68:71]
ds_read_b64_tr_b16 v[186:187], v38 offset:8192
ds_read_b64_tr_b16 v[188:189], v31 offset:8192
v_mfma_f32_16x16x32_bf16 v[100:103], v[148:151], v[196:199], v[100:103]
ds_read_b64_tr_b16 v[190:191], v39 offset:8192
v_mfma_f32_16x16x32_bf16 v[72:75], v[152:155], v[192:195], v[72:75]
v_mfma_f32_16x16x32_bf16 v[104:107], v[152:155], v[196:199], v[104:107]
v_mfma_f32_16x16x32_bf16 v[76:79], v[156:159], v[192:195], v[76:79]
v_mfma_f32_16x16x32_bf16 v[108:111], v[156:159], v[196:199], v[108:111]
s_cmp_eq_u32 s43, 0
s_cbranch_scc0 LB32
v_mfma_f32_16x16x32_bf16 v[120:123], v[128:131], v[4:7], v[120:123]
v_mfma_f32_16x16x32_bf16 v[124:127], v[132:135], v[4:7], v[124:127]
v_mfma_f32_16x16x32_bf16 v[222:225], v[4:7], v[192:195], v[222:225]
v_mfma_f32_16x16x32_bf16 v[226:229], v[192:195], v[192:195], v[226:229]
v_mfma_f32_16x16x32_bf16 v[230:233], v[4:7], v[196:199], v[230:233]
v_mfma_f32_16x16x32_bf16 v[234:237], v[196:199], v[196:199], v[234:237]
v_mfma_f32_16x16x32_bf16 v[238:241], v[4:7], v[200:203], v[238:241]
v_mfma_f32_16x16x32_bf16 v[242:245], v[200:203], v[200:203], v[242:245]
LB32:
s_waitcnt lgkmcnt(0)
s_barrier
v_mfma_f32_16x16x32_bf16 v[48:51], v[160:163], v[204:207], v[48:51]
ds_read_b128 v[192:195], v44 offset:2048
ds_read_b128 v[196:199], v44 offset:10240
v_mfma_f32_16x16x32_bf16 v[80:83], v[160:163], v[208:211], v[80:83]
ds_read_b128 v[200:203], v46 offset:2048
v_mfma_f32_16x16x32_bf16 v[112:115], v[160:163], v[212:215], v[112:115]
ds_read_b64_tr_b16 v[128:129], v24 offset:16384
v_mfma_f32_16x16x32_bf16 v[52:55], v[164:167], v[204:207], v[52:55]
ds_read_b64_tr_b16 v[130:131], v32 offset:16384
ds_read_b64_tr_b16 v[132:133], v25 offset:16384
v_mfma_f32_16x16x32_bf16 v[84:87], v[164:167], v[208:211], v[84:87]
ds_read_b64_tr_b16 v[134:135], v33 offset:16384
v_mfma_f32_16x16x32_bf16 v[116:119], v[164:167], v[212:215], v[116:119]
ds_read_b64_tr_b16 v[136:137], v26 offset:16384
v_mfma_f32_16x16x32_bf16 v[56:59], v[168:171], v[204:207], v[56:59]
ds_read_b64_tr_b16 v[138:139], v34 offset:16384
ds_read_b64_tr_b16 v[140:141], v27 offset:16384
v_mfma_f32_16x16x32_bf16 v[88:91], v[168:171], v[208:211], v[88:91]
ds_read_b64_tr_b16 v[142:143], v35 offset:16384
v_mfma_f32_16x16x32_bf16 v[60:63], v[172:175], v[204:207], v[60:63]
ds_read_b64_tr_b16 v[144:145], v28 offset:16384
v_mfma_f32_16x16x32_bf16 v[92:95], v[172:175], v[208:211], v[92:95]
ds_read_b64_tr_b16 v[146:147], v36 offset:16384
ds_read_b64_tr_b16 v[148:149], v29 offset:16384
v_mfma_f32_16x16x32_bf16 v[64:67], v[176:179], v[204:207], v[64:67]
ds_read_b64_tr_b16 v[150:151], v37 offset:16384
v_mfma_f32_16x16x32_bf16 v[96:99], v[176:179], v[208:211], v[96:99]
ds_read_b64_tr_b16 v[152:153], v30 offset:16384
v_mfma_f32_16x16x32_bf16 v[68:71], v[180:183], v[204:207], v[68:71]
ds_read_b64_tr_b16 v[154:155], v38 offset:16384
ds_read_b64_tr_b16 v[156:157], v31 offset:16384
v_mfma_f32_16x16x32_bf16 v[100:103], v[180:183], v[208:211], v[100:103]
ds_read_b64_tr_b16 v[158:159], v39 offset:16384
v_mfma_f32_16x16x32_bf16 v[72:75], v[184:187], v[204:207], v[72:75]
v_mfma_f32_16x16x32_bf16 v[104:107], v[184:187], v[208:211], v[104:107]
v_mfma_f32_16x16x32_bf16 v[76:79], v[188:191], v[204:207], v[76:79]
v_mfma_f32_16x16x32_bf16 v[108:111], v[188:191], v[208:211], v[108:111]
s_cmp_eq_u32 s43, 0
s_cbranch_scc0 LB33
v_mfma_f32_16x16x32_bf16 v[120:123], v[160:163], v[4:7], v[120:123]
v_mfma_f32_16x16x32_bf16 v[124:127], v[164:167], v[4:7], v[124:127]
v_mfma_f32_16x16x32_bf16 v[222:225], v[4:7], v[204:207], v[222:225]
v_mfma_f32_16x16x32_bf16 v[226:229], v[204:207], v[204:207], v[226:229]
v_mfma_f32_16x16x32_bf16 v[230:233], v[4:7], v[208:211], v[230:233]
v_mfma_f32_16x16x32_bf16 v[234:237], v[208:211], v[208:211], v[234:237]
v_mfma_f32_16x16x32_bf16 v[238:241], v[4:7], v[212:215], v[238:241]
v_mfma_f32_16x16x32_bf16 v[242:245], v[212:215], v[212:215], v[242:245]
LB33:
s_waitcnt lgkmcnt(0)
v_mfma_f32_16x16x32_bf16 v[48:51], v[128:131], v[192:195], v[48:51]
ds_read_b128 v[204:207], v45 offset:2048
ds_read_b128 v[208:211], v45 offset:10240
v_mfma_f32_16x16x32_bf16 v[80:83], v[128:131], v[196:199], v[80:83]
ds_read_b128 v[212:215], v47 offset:2048
v_mfma_f32_16x16x32_bf16 v[112:115], v[128:131], v[200:203], v[112:115]
ds_read_b64_tr_b16 v[160:161], v24 offset:24576
v_mfma_f32_16x16x32_bf16 v[52:55], v[132:135], v[192:195], v[52:55]
ds_read_b64_tr_b16 v[162:163], v32 offset:24576
ds_read_b64_tr_b16 v[164:165], v25 offset:24576
v_mfma_f32_16x16x32_bf16 v[84:87], v[132:135], v[196:199], v[84:87]
ds_read_b64_tr_b16 v[166:167], v33 offset:24576
v_mfma_f32_16x16x32_bf16 v[116:119], v[132:135], v[200:203], v[116:119]
ds_read_b64_tr_b16 v[168:169], v26 offset:24576
v_mfma_f32_16x16x32_bf16 v[56:59], v[136:139], v[192:195], v[56:59]
ds_read_b64_tr_b16 v[170:171], v34 offset:24576
ds_read_b64_tr_b16 v[172:173], v27 offset:24576
v_mfma_f32_16x16x32_bf16 v[88:91], v[136:139], v[196:199], v[88:91]
ds_read_b64_tr_b16 v[174:175], v35 offset:24576
v_mfma_f32_16x16x32_bf16 v[60:63], v[140:143], v[192:195], v[60:63]
ds_read_b64_tr_b16 v[176:177], v28 offset:24576
v_mfma_f32_16x16x32_bf16 v[92:95], v[140:143], v[196:199], v[92:95]
ds_read_b64_tr_b16 v[178:179], v36 offset:24576
ds_read_b64_tr_b16 v[180:181], v29 offset:24576
v_mfma_f32_16x16x32_bf16 v[64:67], v[144:147], v[192:195], v[64:67]
ds_read_b64_tr_b16 v[182:183], v37 offset:24576
v_mfma_f32_16x16x32_bf16 v[96:99], v[144:147], v[196:199], v[96:99]
ds_read_b64_tr_b16 v[184:185], v30 offset:24576
v_mfma_f32_16x16x32_bf16 v[68:71], v[148:151], v[192:195], v[68:71]
ds_read_b64_tr_b16 v[186:187], v38 offset:24576
ds_read_b64_tr_b16 v[188:189], v31 offset:24576
v_mfma_f32_16x16x32_bf16 v[100:103], v[148:151], v[196:199], v[100:103]
ds_read_b64_tr_b16 v[190:191], v39 offset:24576
v_mfma_f32_16x16x32_bf16 v[72:75], v[152:155], v[192:195], v[72:75]
v_mfma_f32_16x16x32_bf16 v[104:107], v[152:155], v[196:199], v[104:107]
v_mfma_f32_16x16x32_bf16 v[76:79], v[156:159], v[192:195], v[76:79]
v_mfma_f32_16x16x32_bf16 v[108:111], v[156:159], v[196:199], v[108:111]
s_cmp_eq_u32 s43, 0
s_cbranch_scc0 LB34
v_mfma_f32_16x16x32_bf16 v[120:123], v[128:131], v[4:7], v[120:123]
v_mfma_f32_16x16x32_bf16 v[124:127], v[132:135], v[4:7], v[124:127]
v_mfma_f32_16x16x32_bf16 v[222:225], v[4:7], v[192:195], v[222:225]
v_mfma_f32_16x16x32_bf16 v[226:229], v[192:195], v[192:195], v[226:229]
v_mfma_f32_16x16x32_bf16 v[230:233], v[4:7], v[196:199], v[230:233]
v_mfma_f32_16x16x32_bf16 v[234:237], v[196:199], v[196:199], v[234:237]
v_mfma_f32_16x16x32_bf16 v[238:241], v[4:7], v[200:203], v[238:241]
v_mfma_f32_16x16x32_bf16 v[242:245], v[200:203], v[200:203], v[242:245]
LB34:
s_waitcnt lgkmcnt(0)
s_barrier
v_mfma_f32_16x16x32_bf16 v[48:51], v[160:163], v[204:207], v[48:51]
ds_read_b128 v[192:195], v44 offset:4096
ds_read_b128 v[196:199], v44 offset:12288
v_mfma_f32_16x16x32_bf16 v[80:83], v[160:163], v[208:211], v[80:83]
ds_read_b128 v[200:203], v46 offset:4096
v_mfma_f32_16x16x32_bf16 v[112:115], v[160:163], v[212:215], v[112:115]
ds_read_b64_tr_b16 v[128:129], v24 offset:32768
v_mfma_f32_16x16x32_bf16 v[52:55], v[164:167], v[204:207], v[52:55]
ds_read_b64_tr_b16 v[130:131], v32 offset:32768
ds_read_b64_tr_b16 v[132:133], v25 offset:32768
v_mfma_f32_16x16x32_bf16 v[84:87], v[164:167], v[208:211], v[84:87]
ds_read_b64_tr_b16 v[134:135], v33 offset:32768
v_mfma_f32_16x16x32_bf16 v[116:119], v[164:167], v[212:215], v[116:119]
ds_read_b64_tr_b16 v[136:137], v26 offset:32768
v_mfma_f32_16x16x32_bf16 v[56:59], v[168:171], v[204:207], v[56:59]
ds_read_b64_tr_b16 v[138:139], v34 offset:32768
ds_read_b64_tr_b16 v[140:141], v27 offset:32768
v_mfma_f32_16x16x32_bf16 v[88:91], v[168:171], v[208:211], v[88:91]
ds_read_b64_tr_b16 v[142:143], v35 offset:32768
v_mfma_f32_16x16x32_bf16 v[60:63], v[172:175], v[204:207], v[60:63]
ds_read_b64_tr_b16 v[144:145], v28 offset:32768
v_mfma_f32_16x16x32_bf16 v[92:95], v[172:175], v[208:211], v[92:95]
ds_read_b64_tr_b16 v[146:147], v36 offset:32768
ds_read_b64_tr_b16 v[148:149], v29 offset:32768
v_mfma_f32_16x16x32_bf16 v[64:67], v[176:179], v[204:207], v[64:67]
ds_read_b64_tr_b16 v[150:151], v37 offset:32768
v_mfma_f32_16x16x32_bf16 v[96:99], v[176:179], v[208:211], v[96:99]
ds_read_b64_tr_b16 v[152:153], v30 offset:32768
v_mfma_f32_16x16x32_bf16 v[68:71], v[180:183], v[204:207], v[68:71]
ds_read_b64_tr_b16 v[154:155], v38 offset:32768
ds_read_b64_tr_b16 v[156:157], v31 offset:32768
v_mfma_f32_16x16x32_bf16 v[100:103], v[180:183], v[208:211], v[100:103]
ds_read_b64_tr_b16 v[158:159], v39 offset:32768
v_mfma_f32_16x16x32_bf16 v[72:75], v[184:187], v[204:207], v[72:75]
v_mfma_f32_16x16x32_bf16 v[104:107], v[184:187], v[208:211], v[104:107]
v_mfma_f32_16x16x32_bf16 v[76:79], v[188:191], v[204:207], v[76:79]
v_mfma_f32_16x16x32_bf16 v[108:111], v[188:191], v[208:211], v[108:111]
s_cmp_eq_u32 s43, 0
s_cbranch_scc0 LB35
v_mfma_f32_16x16x32_bf16 v[120:123], v[160:163], v[4:7], v[120:123]
v_mfma_f32_16x16x32_bf16 v[124:127], v[164:167], v[4:7], v[124:127]
v_mfma_f32_16x16x32_bf16 v[222:225], v[4:7], v[204:207], v[222:225]
v_mfma_f32_16x16x32_bf16 v[226:229], v[204:207], v[204:207], v[226:229]
v_mfma_f32_16x16x32_bf16 v[230:233], v[4:7], v[208:211], v[230:233]
v_mfma_f32_16x16x32_bf16 v[234:237], v[208:211], v[208:211], v[234:237]
v_mfma_f32_16x16x32_bf16 v[238:241], v[4:7], v[212:215], v[238:241]
v_mfma_f32_16x16x32_bf16 v[242:245], v[212:215], v[212:215], v[242:245]
LB35:
s_waitcnt lgkmcnt(0)
v_mfma_f32_16x16x32_bf16 v[48:51], v[128:131], v[192:195], v[48:51]
ds_read_b128 v[204:207], v45 offset:4096
ds_read_b128 v[208:211], v45 offset:12288
v_mfma_f32_16x16x32_bf16 v[80:83], v[128:131], v[196:199], v[80:83]
ds_read_b128 v[212:215], v47 offset:4096
v_mfma_f32_16x16x32_bf16 v[112:115], v[128:131], v[200:203], v[112:115]
ds_read_b64_tr_b16 v[160:161], v24 offset:40960
ds_read_b64_tr_b16 v[162:163], v32 offset:40960
v_mfma_f32_16x16x32_bf16 v[52:55], v[132:135], v[192:195], v[52:55]
ds_read_b64_tr_b16 v[164:165], v25 offset:40960
v_mfma_f32_16x16x32_bf16 v[84:87], v[132:135], v[196:199], v[84:87]
ds_read_b64_tr_b16 v[166:167], v33 offset:40960
v_mfma_f32_16x16x32_bf16 v[116:119], v[132:135], v[200:203], v[116:119]
ds_read_b64_tr_b16 v[168:169], v26 offset:40960
ds_read_b64_tr_b16 v[170:171], v34 offset:40960
v_mfma_f32_16x16x32_bf16 v[56:59], v[136:139], v[192:195], v[56:59]
ds_read_b64_tr_b16 v[172:173], v27 offset:40960
v_mfma_f32_16x16x32_bf16 v[88:91], v[136:139], v[196:199], v[88:91]
ds_read_b64_tr_b16 v[174:175], v35 offset:40960
ds_read_b64_tr_b16 v[176:177], v28 offset:40960
v_mfma_f32_16x16x32_bf16 v[60:63], v[140:143], v[192:195], v[60:63]
ds_read_b64_tr_b16 v[178:179], v36 offset:40960
v_mfma_f32_16x16x32_bf16 v[92:95], v[140:143], v[196:199], v[92:95]
ds_read_b64_tr_b16 v[180:181], v29 offset:40960
v_mfma_f32_16x16x32_bf16 v[64:67], v[144:147], v[192:195], v[64:67]
ds_read_b64_tr_b16 v[182:183], v37 offset:40960
ds_read_b64_tr_b16 v[184:185], v30 offset:40960
v_mfma_f32_16x16x32_bf16 v[96:99], v[144:147], v[196:199], v[96:99]
ds_read_b64_tr_b16 v[186:187], v38 offset:40960
v_mfma_f32_16x16x32_bf16 v[68:71], v[148:151], v[192:195], v[68:71]
ds_read_b64_tr_b16 v[188:189], v31 offset:40960
ds_read_b64_tr_b16 v[190:191], v39 offset:40960
v_mfma_f32_16x16x32_bf16 v[100:103], v[148:151], v[196:199], v[100:103]
v_mov_b32 v3, 0
buffer_load_dword v42, v3, s[60:63], 0 offen sc0 sc1
v_mfma_f32_16x16x32_bf16 v[72:75], v[152:155], v[192:195], v[72:75]
v_mfma_f32_16x16x32_bf16 v[104:107], v[152:155], v[196:199], v[104:107]
v_mfma_f32_16x16x32_bf16 v[76:79], v[156:159], v[192:195], v[76:79]
v_mfma_f32_16x16x32_bf16 v[108:111], v[156:159], v[196:199], v[108:111]
s_cmp_eq_u32 s43, 0
s_cbranch_scc0 LB36
v_mfma_f32_16x16x32_bf16 v[120:123], v[128:131], v[4:7], v[120:123]
v_mfma_f32_16x16x32_bf16 v[124:127], v[132:135], v[4:7], v[124:127]
v_mfma_f32_16x16x32_bf16 v[222:225], v[4:7], v[192:195], v[222:225]
v_mfma_f32_16x16x32_bf16 v[226:229], v[192:195], v[192:195], v[226:229]
v_mfma_f32_16x16x32_bf16 v[230:233], v[4:7], v[196:199], v[230:233]
v_mfma_f32_16x16x32_bf16 v[234:237], v[196:199], v[196:199], v[234:237]
v_mfma_f32_16x16x32_bf16 v[238:241], v[4:7], v[200:203], v[238:241]
v_mfma_f32_16x16x32_bf16 v[242:245], v[200:203], v[200:203], v[242:245]
LB36:
s_waitcnt lgkmcnt(0)
s_barrier
v_mfma_f32_16x16x32_bf16 v[48:51], v[160:163], v[204:207], v[48:51]
ds_read_b128 v[192:195], v44 offset:6144
ds_read_b128 v[196:199], v44 offset:14336
v_mfma_f32_16x16x32_bf16 v[80:83], v[160:163], v[208:211], v[80:83]
ds_read_b128 v[200:203], v46 offset:6144
v_mfma_f32_16x16x32_bf16 v[112:115], v[160:163], v[212:215], v[112:115]
ds_read_b64_tr_b16 v[128:129], v24 offset:49152
ds_read_b64_tr_b16 v[130:131], v32 offset:49152
v_mfma_f32_16x16x32_bf16 v[52:55], v[164:167], v[204:207], v[52:55]
ds_read_b64_tr_b16 v[132:133], v25 offset:49152
v_mfma_f32_16x16x32_bf16 v[84:87], v[164:167], v[208:211], v[84:87]
ds_read_b64_tr_b16 v[134:135], v33 offset:49152
v_mfma_f32_16x16x32_bf16 v[116:119], v[164:167], v[212:215], v[116:119]
ds_read_b64_tr_b16 v[136:137], v26 offset:49152
ds_read_b64_tr_b16 v[138:139], v34 offset:49152
v_mfma_f32_16x16x32_bf16 v[56:59], v[168:171], v[204:207], v[56:59]
ds_read_b64_tr_b16 v[140:141], v27 offset:49152
v_mfma_f32_16x16x32_bf16 v[88:91], v[168:171], v[208:211], v[88:91]
ds_read_b64_tr_b16 v[142:143], v35 offset:49152
ds_read_b64_tr_b16 v[144:145], v28 offset:49152
v_mfma_f32_16x16x32_bf16 v[60:63], v[172:175], v[204:207], v[60:63]
ds_read_b64_tr_b16 v[146:147], v36 offset:49152
v_mfma_f32_16x16x32_bf16 v[92:95], v[172:175], v[208:211], v[92:95]
ds_read_b64_tr_b16 v[148:149], v29 offset:49152
v_mfma_f32_16x16x32_bf16 v[64:67], v[176:179], v[204:207], v[64:67]
ds_read_b64_tr_b16 v[150:151], v37 offset:49152
ds_read_b64_tr_b16 v[152:153], v30 offset:49152
v_mfma_f32_16x16x32_bf16 v[96:99], v[176:179], v[208:211], v[96:99]
ds_read_b64_tr_b16 v[154:155], v38 offset:49152
v_mfma_f32_16x16x32_bf16 v[68:71], v[180:183], v[204:207], v[68:71]
ds_read_b64_tr_b16 v[156:157], v31 offset:49152
ds_read_b64_tr_b16 v[158:159], v39 offset:49152
v_mfma_f32_16x16x32_bf16 v[100:103], v[180:183], v[208:211], v[100:103]
v_mov_b32 v8, s41
v_lshlrev_b32 v8, 2, v8
buffer_load_dword v8, v8, s[60:63], 0 offen offset:4 sc0 sc1
v_mfma_f32_16x16x32_bf16 v[72:75], v[184:187], v[204:207], v[72:75]
v_mfma_f32_16x16x32_bf16 v[104:107], v[184:187], v[208:211], v[104:107]
v_mfma_f32_16x16x32_bf16 v[76:79], v[188:191], v[204:207], v[76:79]
v_mfma_f32_16x16x32_bf16 v[108:111], v[188:191], v[208:211], v[108:111]
s_cmp_eq_u32 s43, 0
s_cbranch_scc0 LB37
v_mfma_f32_16x16x32_bf16 v[120:123], v[160:163], v[4:7], v[120:123]
v_mfma_f32_16x16x32_bf16 v[124:127], v[164:167], v[4:7], v[124:127]
v_mfma_f32_16x16x32_bf16 v[222:225], v[4:7], v[204:207], v[222:225]
v_mfma_f32_16x16x32_bf16 v[226:229], v[204:207], v[204:207], v[226:229]
v_mfma_f32_16x16x32_bf16 v[230:233], v[4:7], v[208:211], v[230:233]
v_mfma_f32_16x16x32_bf16 v[234:237], v[208:211], v[208:211], v[234:237]
v_mfma_f32_16x16x32_bf16 v[238:241], v[4:7], v[212:215], v[238:241]
v_mfma_f32_16x16x32_bf16 v[242:245], v[212:215], v[212:215], v[242:245]
LB37:
s_waitcnt lgkmcnt(0)
v_mfma_f32_16x16x32_bf16 v[48:51], v[128:131], v[192:195], v[48:51]
ds_read_b128 v[204:207], v45 offset:6144
ds_read_b128 v[208:211], v45 offset:14336
v_mfma_f32_16x16x32_bf16 v[80:83], v[128:131], v[196:199], v[80:83]
ds_read_b128 v[212:215], v47 offset:6144
v_mfma_f32_16x16x32_bf16 v[112:115], v[128:131], v[200:203], v[112:115]
ds_read_b64_tr_b16 v[160:161], v24 offset:57344
v_mfma_f32_16x16x32_bf16 v[52:55], v[132:135], v[192:195], v[52:55]
ds_read_b64_tr_b16 v[162:163], v32 offset:57344
ds_read_b64_tr_b16 v[164:165], v25 offset:57344
v_mfma_f32_16x16x32_bf16 v[84:87], v[132:135], v[196:199], v[84:87]
ds_read_b64_tr_b16 v[166:167], v33 offset:57344
v_mfma_f32_16x16x32_bf16 v[116:119], v[132:135], v[200:203], v[116:119]
ds_read_b64_tr_b16 v[168:169], v26 offset:57344
v_mfma_f32_16x16x32_bf16 v[56:59], v[136:139], v[192:195], v[56:59]
ds_read_b64_tr_b16 v[170:171], v34 offset:57344
ds_read_b64_tr_b16 v[172:173], v27 offset:57344
v_mfma_f32_16x16x32_bf16 v[88:91], v[136:139], v[196:199], v[88:91]
ds_read_b64_tr_b16 v[174:175], v35 offset:57344
v_mfma_f32_16x16x32_bf16 v[60:63], v[140:143], v[192:195], v[60:63]
ds_read_b64_tr_b16 v[176:177], v28 offset:57344
v_mfma_f32_16x16x32_bf16 v[92:95], v[140:143], v[196:199], v[92:95]
ds_read_b64_tr_b16 v[178:179], v36 offset:57344
ds_read_b64_tr_b16 v[180:181], v29 offset:57344
v_mfma_f32_16x16x32_bf16 v[64:67], v[144:147], v[192:195], v[64:67]
ds_read_b64_tr_b16 v[182:183], v37 offset:57344
v_mfma_f32_16x16x32_bf16 v[96:99], v[144:147], v[196:199], v[96:99]
ds_read_b64_tr_b16 v[184:185], v30 offset:57344
v_mfma_f32_16x16x32_bf16 v[68:71], v[148:151], v[192:195], v[68:71]
ds_read_b64_tr_b16 v[186:187], v38 offset:57344
ds_read_b64_tr_b16 v[188:189], v31 offset:57344
v_mfma_f32_16x16x32_bf16 v[100:103], v[148:151], v[196:199], v[100:103]
ds_read_b64_tr_b16 v[190:191], v39 offset:57344
v_mfma_f32_16x16x32_bf16 v[72:75], v[152:155], v[192:195], v[72:75]
v_mfma_f32_16x16x32_bf16 v[104:107], v[152:155], v[196:199], v[104:107]
v_mfma_f32_16x16x32_bf16 v[76:79], v[156:159], v[192:195], v[76:79]
v_mfma_f32_16x16x32_bf16 v[108:111], v[156:159], v[196:199], v[108:111]
s_cmp_eq_u32 s43, 0
s_cbranch_scc0 LB38
v_mfma_f32_16x16x32_bf16 v[120:123], v[128:131], v[4:7], v[120:123]
v_mfma_f32_16x16x32_bf16 v[124:127], v[132:135], v[4:7], v[124:127]
v_mfma_f32_16x16x32_bf16 v[222:225], v[4:7], v[192:195], v[222:225]
v_mfma_f32_16x16x32_bf16 v[226:229], v[192:195], v[192:195], v[226:229]
v_mfma_f32_16x16x32_bf16 v[230:233], v[4:7], v[196:199], v[230:233]
v_mfma_f32_16x16x32_bf16 v[234:237], v[196:199], v[196:199], v[234:237]
v_mfma_f32_16x16x32_bf16 v[238:241], v[4:7], v[200:203], v[238:241]
v_mfma_f32_16x16x32_bf16 v[242:245], v[200:203], v[200:203], v[242:245]
LB38:
s_waitcnt lgkmcnt(0)
s_barrier
v_mfma_f32_16x16x32_bf16 v[48:51], v[160:163], v[204:207], v[48:51]
ds_read_b128 v[192:195], v44 offset:0
ds_read_b128 v[196:199], v44 offset:8192
v_mfma_f32_16x16x32_bf16 v[80:83], v[160:163], v[208:211], v[80:83]
ds_read_b128 v[200:203], v46 offset:0
v_mfma_f32_16x16x32_bf16 v[112:115], v[160:163], v[212:215], v[112:115]
ds_read_b64_tr_b16 v[128:129], v24 offset:0
v_mfma_f32_16x16x32_bf16 v[52:55], v[164:167], v[204:207], v[52:55]
ds_read_b64_tr_b16 v[130:131], v32 offset:0
ds_read_b64_tr_b16 v[132:133], v25 offset:0
v_mfma_f32_16x16x32_bf16 v[84:87], v[164:167], v[208:211], v[84:87]
ds_read_b64_tr_b16 v[134:135], v33 offset:0
v_mfma_f32_16x16x32_bf16 v[116:119], v[164:167], v[212:215], v[116:119]
ds_read_b64_tr_b16 v[136:137], v26 offset:0
v_mfma_f32_16x16x32_bf16 v[56:59], v[168:171], v[204:207], v[56:59]
ds_read_b64_tr_b16 v[138:139], v34 offset:0
ds_read_b64_tr_b16 v[140:141], v27 offset:0
v_mfma_f32_16x16x32_bf16 v[88:91], v[168:171], v[208:211], v[88:91]
ds_read_b64_tr_b16 v[142:143], v35 offset:0
v_mfma_f32_16x16x32_bf16 v[60:63], v[172:175], v[204:207], v[60:63]
ds_read_b64_tr_b16 v[144:145], v28 offset:0
v_mfma_f32_16x16x32_bf16 v[92:95], v[172:175], v[208:211], v[92:95]
ds_read_b64_tr_b16 v[146:147], v36 offset:0
ds_read_b64_tr_b16 v[148:149], v29 offset:0
v_mfma_f32_16x16x32_bf16 v[64:67], v[176:179], v[204:207], v[64:67]
ds_read_b64_tr_b16 v[150:151], v37 offset:0
v_mfma_f32_16x16x32_bf16 v[96:99], v[176:179], v[208:211], v[96:99]
ds_read_b64_tr_b16 v[152:153], v30 offset:0
v_mfma_f32_16x16x32_bf16 v[68:71], v[180:183], v[204:207], v[68:71]
ds_read_b64_tr_b16 v[154:155], v38 offset:0
ds_read_b64_tr_b16 v[156:157], v31 offset:0
v_mfma_f32_16x16x32_bf16 v[100:103], v[180:183], v[208:211], v[100:103]
ds_read_b64_tr_b16 v[158:159], v39 offset:0
v_mfma_f32_16x16x32_bf16 v[72:75], v[184:187], v[204:207], v[72:75]
v_mfma_f32_16x16x32_bf16 v[104:107], v[184:187], v[208:211], v[104:107]
v_mfma_f32_16x16x32_bf16 v[76:79], v[188:191], v[204:207], v[76:79]
v_mfma_f32_16x16x32_bf16 v[108:111], v[188:191], v[208:211], v[108:111]
s_cmp_eq_u32 s43, 0
s_cbranch_scc0 LB39
v_mfma_f32_16x16x32_bf16 v[120:123], v[160:163], v[4:7], v[120:123]
v_mfma_f32_16x16x32_bf16 v[124:127], v[164:167], v[4:7], v[124:127]
v_mfma_f32_16x16x32_bf16 v[222:225], v[4:7], v[204:207], v[222:225]
v_mfma_f32_16x16x32_bf16 v[226:229], v[204:207], v[204:207], v[226:229]
v_mfma_f32_16x16x32_bf16 v[230:233], v[4:7], v[208:211], v[230:233]
v_mfma_f32_16x16x32_bf16 v[234:237], v[208:211], v[208:211], v[234:237]
v_mfma_f32_16x16x32_bf16 v[238:241], v[4:7], v[212:215], v[238:241]
v_mfma_f32_16x16x32_bf16 v[242:245], v[212:215], v[212:215], v[242:245]
LB39:
s_waitcnt lgkmcnt(0)
v_mfma_f32_16x16x32_bf16 v[48:51], v[128:131], v[192:195], v[48:51]
ds_read_b128 v[204:207], v45 offset:0
ds_read_b128 v[208:211], v45 offset:8192
v_mfma_f32_16x16x32_bf16 v[80:83], v[128:131], v[196:199], v[80:83]
ds_read_b128 v[212:215], v47 offset:0
v_mfma_f32_16x16x32_bf16 v[112:115], v[128:131], v[200:203], v[112:115]
ds_read_b64_tr_b16 v[160:161], v24 offset:8192
v_mfma_f32_16x16x32_bf16 v[52:55], v[132:135], v[192:195], v[52:55]
ds_read_b64_tr_b16 v[162:163], v32 offset:8192
ds_read_b64_tr_b16 v[164:165], v25 offset:8192
v_mfma_f32_16x16x32_bf16 v[84:87], v[132:135], v[196:199], v[84:87]
ds_read_b64_tr_b16 v[166:167], v33 offset:8192
v_mfma_f32_16x16x32_bf16 v[116:119], v[132:135], v[200:203], v[116:119]
ds_read_b64_tr_b16 v[168:169], v26 offset:8192
v_mfma_f32_16x16x32_bf16 v[56:59], v[136:139], v[192:195], v[56:59]
ds_read_b64_tr_b16 v[170:171], v34 offset:8192
ds_read_b64_tr_b16 v[172:173], v27 offset:8192
v_mfma_f32_16x16x32_bf16 v[88:91], v[136:139], v[196:199], v[88:91]
ds_read_b64_tr_b16 v[174:175], v35 offset:8192
v_mfma_f32_16x16x32_bf16 v[60:63], v[140:143], v[192:195], v[60:63]
ds_read_b64_tr_b16 v[176:177], v28 offset:8192
v_mfma_f32_16x16x32_bf16 v[92:95], v[140:143], v[196:199], v[92:95]
ds_read_b64_tr_b16 v[178:179], v36 offset:8192
ds_read_b64_tr_b16 v[180:181], v29 offset:8192
v_mfma_f32_16x16x32_bf16 v[64:67], v[144:147], v[192:195], v[64:67]
ds_read_b64_tr_b16 v[182:183], v37 offset:8192
v_mfma_f32_16x16x32_bf16 v[96:99], v[144:147], v[196:199], v[96:99]
ds_read_b64_tr_b16 v[184:185], v30 offset:8192
v_mfma_f32_16x16x32_bf16 v[68:71], v[148:151], v[192:195], v[68:71]
ds_read_b64_tr_b16 v[186:187], v38 offset:8192
ds_read_b64_tr_b16 v[188:189], v31 offset:8192
v_mfma_f32_16x16x32_bf16 v[100:103], v[148:151], v[196:199], v[100:103]
ds_read_b64_tr_b16 v[190:191], v39 offset:8192
v_mfma_f32_16x16x32_bf16 v[72:75], v[152:155], v[192:195], v[72:75]
v_mfma_f32_16x16x32_bf16 v[104:107], v[152:155], v[196:199], v[104:107]
v_mfma_f32_16x16x32_bf16 v[76:79], v[156:159], v[192:195], v[76:79]
v_mfma_f32_16x16x32_bf16 v[108:111], v[156:159], v[196:199], v[108:111]
s_cmp_eq_u32 s43, 0
s_cbranch_scc0 LB40
v_mfma_f32_16x16x32_bf16 v[120:123], v[128:131], v[4:7], v[120:123]
v_mfma_f32_16x16x32_bf16 v[124:127], v[132:135], v[4:7], v[124:127]
v_mfma_f32_16x16x32_bf16 v[222:225], v[4:7], v[192:195], v[222:225]
v_mfma_f32_16x16x32_bf16 v[226:229], v[192:195], v[192:195], v[226:229]
v_mfma_f32_16x16x32_bf16 v[230:233], v[4:7], v[196:199], v[230:233]
v_mfma_f32_16x16x32_bf16 v[234:237], v[196:199], v[196:199], v[234:237]
v_mfma_f32_16x16x32_bf16 v[238:241], v[4:7], v[200:203], v[238:241]
v_mfma_f32_16x16x32_bf16 v[242:245], v[200:203], v[200:203], v[242:245]
LB40:
s_waitcnt lgkmcnt(0)
s_barrier
v_mfma_f32_16x16x32_bf16 v[48:51], v[160:163], v[204:207], v[48:51]
ds_read_b128 v[192:195], v44 offset:2048
ds_read_b128 v[196:199], v44 offset:10240
v_mfma_f32_16x16x32_bf16 v[80:83], v[160:163], v[208:211], v[80:83]
ds_read_b128 v[200:203], v46 offset:2048
v_mfma_f32_16x16x32_bf16 v[112:115], v[160:163], v[212:215], v[112:115]
ds_read_b64_tr_b16 v[128:129], v24 offset:16384
v_mfma_f32_16x16x32_bf16 v[52:55], v[164:167], v[204:207], v[52:55]
ds_read_b64_tr_b16 v[130:131], v32 offset:16384
ds_read_b64_tr_b16 v[132:133], v25 offset:16384
v_mfma_f32_16x16x32_bf16 v[84:87], v[164:167], v[208:211], v[84:87]
ds_read_b64_tr_b16 v[134:135], v33 offset:16384
v_mfma_f32_16x16x32_bf16 v[116:119], v[164:167], v[212:215], v[116:119]
ds_read_b64_tr_b16 v[136:137], v26 offset:16384
v_mfma_f32_16x16x32_bf16 v[56:59], v[168:171], v[204:207], v[56:59]
ds_read_b64_tr_b16 v[138:139], v34 offset:16384
ds_read_b64_tr_b16 v[140:141], v27 offset:16384
v_mfma_f32_16x16x32_bf16 v[88:91], v[168:171], v[208:211], v[88:91]
ds_read_b64_tr_b16 v[142:143], v35 offset:16384
v_mfma_f32_16x16x32_bf16 v[60:63], v[172:175], v[204:207], v[60:63]
ds_read_b64_tr_b16 v[144:145], v28 offset:16384
v_mfma_f32_16x16x32_bf16 v[92:95], v[172:175], v[208:211], v[92:95]
ds_read_b64_tr_b16 v[146:147], v36 offset:16384
ds_read_b64_tr_b16 v[148:149], v29 offset:16384
v_mfma_f32_16x16x32_bf16 v[64:67], v[176:179], v[204:207], v[64:67]
ds_read_b64_tr_b16 v[150:151], v37 offset:16384
v_mfma_f32_16x16x32_bf16 v[96:99], v[176:179], v[208:211], v[96:99]
ds_read_b64_tr_b16 v[152:153], v30 offset:16384
v_mfma_f32_16x16x32_bf16 v[68:71], v[180:183], v[204:207], v[68:71]
ds_read_b64_tr_b16 v[154:155], v38 offset:16384
ds_read_b64_tr_b16 v[156:157], v31 offset:16384
v_mfma_f32_16x16x32_bf16 v[100:103], v[180:183], v[208:211], v[100:103]
ds_read_b64_tr_b16 v[158:159], v39 offset:16384
v_mfma_f32_16x16x32_bf16 v[72:75], v[184:187], v[204:207], v[72:75]
v_mfma_f32_16x16x32_bf16 v[104:107], v[184:187], v[208:211], v[104:107]
v_mfma_f32_16x16x32_bf16 v[76:79], v[188:191], v[204:207], v[76:79]
v_mfma_f32_16x16x32_bf16 v[108:111], v[188:191], v[208:211], v[108:111]
s_cmp_eq_u32 s43, 0
s_cbranch_scc0 LB41
v_mfma_f32_16x16x32_bf16 v[120:123], v[160:163], v[4:7], v[120:123]
v_mfma_f32_16x16x32_bf16 v[124:127], v[164:167], v[4:7], v[124:127]
v_mfma_f32_16x16x32_bf16 v[222:225], v[4:7], v[204:207], v[222:225]
v_mfma_f32_16x16x32_bf16 v[226:229], v[204:207], v[204:207], v[226:229]
v_mfma_f32_16x16x32_bf16 v[230:233], v[4:7], v[208:211], v[230:233]
v_mfma_f32_16x16x32_bf16 v[234:237], v[208:211], v[208:211], v[234:237]
v_mfma_f32_16x16x32_bf16 v[238:241], v[4:7], v[212:215], v[238:241]
v_mfma_f32_16x16x32_bf16 v[242:245], v[212:215], v[212:215], v[242:245]
LB41:
s_waitcnt lgkmcnt(0)
v_mfma_f32_16x16x32_bf16 v[48:51], v[128:131], v[192:195], v[48:51]
ds_read_b128 v[204:207], v45 offset:2048
ds_read_b128 v[208:211], v45 offset:10240
v_mfma_f32_16x16x32_bf16 v[80:83], v[128:131], v[196:199], v[80:83]
ds_read_b128 v[212:215], v47 offset:2048
v_mfma_f32_16x16x32_bf16 v[112:115], v[128:131], v[200:203], v[112:115]
ds_read_b64_tr_b16 v[160:161], v24 offset:24576
v_mfma_f32_16x16x32_bf16 v[52:55], v[132:135], v[192:195], v[52:55]
ds_read_b64_tr_b16 v[162:163], v32 offset:24576
ds_read_b64_tr_b16 v[164:165], v25 offset:24576
v_mfma_f32_16x16x32_bf16 v[84:87], v[132:135], v[196:199], v[84:87]
ds_read_b64_tr_b16 v[166:167], v33 offset:24576
v_mfma_f32_16x16x32_bf16 v[116:119], v[132:135], v[200:203], v[116:119]
ds_read_b64_tr_b16 v[168:169], v26 offset:24576
v_mfma_f32_16x16x32_bf16 v[56:59], v[136:139], v[192:195], v[56:59]
ds_read_b64_tr_b16 v[170:171], v34 offset:24576
ds_read_b64_tr_b16 v[172:173], v27 offset:24576
v_mfma_f32_16x16x32_bf16 v[88:91], v[136:139], v[196:199], v[88:91]
ds_read_b64_tr_b16 v[174:175], v35 offset:24576
v_mfma_f32_16x16x32_bf16 v[60:63], v[140:143], v[192:195], v[60:63]
ds_read_b64_tr_b16 v[176:177], v28 offset:24576
v_mfma_f32_16x16x32_bf16 v[92:95], v[140:143], v[196:199], v[92:95]
ds_read_b64_tr_b16 v[178:179], v36 offset:24576
ds_read_b64_tr_b16 v[180:181], v29 offset:24576
v_mfma_f32_16x16x32_bf16 v[64:67], v[144:147], v[192:195], v[64:67]
ds_read_b64_tr_b16 v[182:183], v37 offset:24576
v_mfma_f32_16x16x32_bf16 v[96:99], v[144:147], v[196:199], v[96:99]
ds_read_b64_tr_b16 v[184:185], v30 offset:24576
v_mfma_f32_16x16x32_bf16 v[68:71], v[148:151], v[192:195], v[68:71]
ds_read_b64_tr_b16 v[186:187], v38 offset:24576
ds_read_b64_tr_b16 v[188:189], v31 offset:24576
v_mfma_f32_16x16x32_bf16 v[100:103], v[148:151], v[196:199], v[100:103]
ds_read_b64_tr_b16 v[190:191], v39 offset:24576
v_mfma_f32_16x16x32_bf16 v[72:75], v[152:155], v[192:195], v[72:75]
v_mfma_f32_16x16x32_bf16 v[104:107], v[152:155], v[196:199], v[104:107]
v_mfma_f32_16x16x32_bf16 v[76:79], v[156:159], v[192:195], v[76:79]
v_mfma_f32_16x16x32_bf16 v[108:111], v[156:159], v[196:199], v[108:111]
s_cmp_eq_u32 s43, 0
s_cbranch_scc0 LB42
v_mfma_f32_16x16x32_bf16 v[120:123], v[128:131], v[4:7], v[120:123]
v_mfma_f32_16x16x32_bf16 v[124:127], v[132:135], v[4:7], v[124:127]
v_mfma_f32_16x16x32_bf16 v[222:225], v[4:7], v[192:195], v[222:225]
v_mfma_f32_16x16x32_bf16 v[226:229], v[192:195], v[192:195], v[226:229]
v_mfma_f32_16x16x32_bf16 v[230:233], v[4:7], v[196:199], v[230:233]
v_mfma_f32_16x16x32_bf16 v[234:237], v[196:199], v[196:199], v[234:237]
v_mfma_f32_16x16x32_bf16 v[238:241], v[4:7], v[200:203], v[238:241]
v_mfma_f32_16x16x32_bf16 v[242:245], v[200:203], v[200:203], v[242:245]
LB42:
s_waitcnt lgkmcnt(0)
v_mfma_f32_16x16x32_bf16 v[48:51], v[160:163], v[204:207], v[48:51]
v_mfma_f32_16x16x32_bf16 v[80:83], v[160:163], v[208:211], v[80:83]
v_mfma_f32_16x16x32_bf16 v[112:115], v[160:163], v[212:215], v[112:115]
v_mfma_f32_16x16x32_bf16 v[52:55], v[164:167], v[204:207], v[52:55]
v_mfma_f32_16x16x32_bf16 v[84:87], v[164:167], v[208:211], v[84:87]
v_mfma_f32_16x16x32_bf16 v[116:119], v[164:167], v[212:215], v[116:119]
v_mfma_f32_16x16x32_bf16 v[56:59], v[168:171], v[204:207], v[56:59]
v_mfma_f32_16x16x32_bf16 v[88:91], v[168:171], v[208:211], v[88:91]
v_mfma_f32_16x16x32_bf16 v[60:63], v[172:175], v[204:207], v[60:63]
v_mfma_f32_16x16x32_bf16 v[92:95], v[172:175], v[208:211], v[92:95]
v_mfma_f32_16x16x32_bf16 v[64:67], v[176:179], v[204:207], v[64:67]
v_mfma_f32_16x16x32_bf16 v[96:99], v[176:179], v[208:211], v[96:99]
v_mfma_f32_16x16x32_bf16 v[68:71], v[180:183], v[204:207], v[68:71]
v_mfma_f32_16x16x32_bf16 v[100:103], v[180:183], v[208:211], v[100:103]
v_mfma_f32_16x16x32_bf16 v[72:75], v[184:187], v[204:207], v[72:75]
v_mfma_f32_16x16x32_bf16 v[104:107], v[184:187], v[208:211], v[104:107]
v_mfma_f32_16x16x32_bf16 v[76:79], v[188:191], v[204:207], v[76:79]
v_mfma_f32_16x16x32_bf16 v[108:111], v[188:191], v[208:211], v[108:111]
s_cmp_eq_u32 s43, 0
s_cbranch_scc0 LB43
v_mfma_f32_16x16x32_bf16 v[120:123], v[160:163], v[4:7], v[120:123]
v_mfma_f32_16x16x32_bf16 v[124:127], v[164:167], v[4:7], v[124:127]
v_mfma_f32_16x16x32_bf16 v[222:225], v[4:7], v[204:207], v[222:225]
v_mfma_f32_16x16x32_bf16 v[226:229], v[204:207], v[204:207], v[226:229]
v_mfma_f32_16x16x32_bf16 v[230:233], v[4:7], v[208:211], v[230:233]
v_mfma_f32_16x16x32_bf16 v[234:237], v[208:211], v[208:211], v[234:237]
v_mfma_f32_16x16x32_bf16 v[238:241], v[4:7], v[212:215], v[238:241]
v_mfma_f32_16x16x32_bf16 v[242:245], v[212:215], v[212:215], v[242:245]
LB43:
s_barrier
s_nop 7
s_nop 7
s_waitcnt vmcnt(2)
s_waitcnt vmcnt(1)
v_readfirstlane_b32 s44, v42
s_cmp_lg_u32 s44, 0
s_cbranch_scc1 LB45
v_mov_b32 v3, 0
s_mov_b32 s56, 0
LB44:
buffer_load_dword v42, v3, s[60:63], 0 offen sc0 sc1
s_waitcnt vmcnt(0)
v_readfirstlane_b32 s44, v42
s_cmp_lg_u32 s44, 0
s_cbranch_scc1 LB45
s_add_u32 s56, s56, 1
s_cmp_lt_u32 s56, 20000
s_cbranch_scc1 LB44
LB45:
s_waitcnt vmcnt(0)
s_mov_b32 s56, 0
LB46:
v_readfirstlane_b32 s64, v8
s_lshr_b32 s65, s64, 24
s_cmp_ge_u32 s65, 16
s_cbranch_scc1 LB47
v_mov_b32 v3, s41
v_lshlrev_b32 v3, 2, v3
buffer_load_dword v8, v3, s[60:63], 0 offen offset:4 sc0 sc1
s_waitcnt vmcnt(0)
s_add_u32 s56, s56, 1
s_cmp_lt_u32 s56, 20000
s_cbranch_scc1 LB46
LB47:
s_lshr_b32 s48, s81, 3
s_mul_i32 s55, s48, s48
s_lshl_b32 s55, s55, 8
s_add_u32 s55, s55, s48
s_lshl_b32 s55, s55, 4
s_add_u32 s55, s55, 268435456
s_cmp_eq_u32 s55, s64
s_cselect_b32 s80, 1, 0
s_cmp_eq_u32 s43, 0
s_cselect_b32 s82, s80, 0
s_lshl_b32 s48, s40, 7
s_add_u32 s48, s48, 162816
v_lshlrev_b32 v3, 4, v2
v_add_u32 v4, s48, v3
s_cmp_eq_u32 s43, 0
s_cbranch_scc0 LB48
ds_write_b128 v4, v[120:123]
ds_write_b128 v4, v[124:127] offset:64
s_waitcnt lgkmcnt(0)
s_barrier
LB48:
s_xor_b32 s48, s40, 0
s_lshl_b32 s48, s48, 7
s_add_u32 s48, s48, 162816
v_add_u32 v4, s48, v3
ds_read_b128 v[128:131], v4
ds_read_b128 v[132:135], v4 offset:64
s_xor_b32 s48, s40, 1
s_lshl_b32 s48, s48, 7
s_add_u32 s48, s48, 162816
v_add_u32 v4, s48, v3
ds_read_b128 v[136:139], v4
ds_read_b128 v[140:143], v4 offset:64
s_xor_b32 s48, s40, 2
s_lshl_b32 s48, s48, 7
s_add_u32 s48, s48, 162816
v_add_u32 v4, s48, v3
ds_read_b128 v[144:147], v4
ds_read_b128 v[148:151], v4 offset:64
s_xor_b32 s48, s40, 3
s_lshl_b32 s48, s48, 7
s_add_u32 s48, s48, 162816
v_add_u32 v4, s48, v3
ds_read_b128 v[152:155], v4
ds_read_b128 v[156:159], v4 offset:64
s_cmp_eq_u32 s43, 0
s_cbranch_scc0 LB52
v_and_b32 v5, 3, v1
v_lshrrev_b32 v6, 2, v1
v_mul_f32 v216, 0.5, v222
v_mul_f32 v216, 0.5, v216
v_mov_b32 v217, v226
v_cmp_eq_u32 vcc, 1, v5
v_cndmask_b32 v217, v217, v227, vcc
v_cmp_eq_u32 vcc, 2, v5
v_cndmask_b32 v217, v217, v228, vcc
v_cmp_eq_u32 vcc, 3, v5
v_cndmask_b32 v217, v217, v229, vcc
v_cmp_eq_u32 vcc, v6, v2
v_cndmask_b32 v217, 0, v217, vcc
v_mul_f32 v218, 0.5, v230
v_mul_f32 v218, 0.5, v218
v_mov_b32 v219, v234
v_cmp_eq_u32 vcc, 1, v5
v_cndmask_b32 v219, v219, v235, vcc
v_cmp_eq_u32 vcc, 2, v5
v_cndmask_b32 v219, v219, v236, vcc
v_cmp_eq_u32 vcc, 3, v5
v_cndmask_b32 v219, v219, v237, vcc
v_cmp_eq_u32 vcc, v6, v2
v_cndmask_b32 v219, 0, v219, vcc
v_mul_f32 v220, 0.5, v238
v_mul_f32 v220, 0.5, v220
v_mov_b32 v221, v242
v_cmp_eq_u32 vcc, 1, v5
v_cndmask_b32 v221, v221, v243, vcc
v_cmp_eq_u32 vcc, 2, v5
v_cndmask_b32 v221, v221, v244, vcc
v_cmp_eq_u32 vcc, 3, v5
v_cndmask_b32 v221, v221, v245, vcc
v_cmp_eq_u32 vcc, v6, v2
v_cndmask_b32 v221, 0, v221, vcc
s_branch LB53
LB52:
v_add_f32 v216, v222, v224
v_add_f32 v217, v223, v225
v_add_f32 v218, v226, v228
v_add_f32 v219, v227, v229
v_add_f32 v220, v230, v232
v_add_f32 v221, v231, v233
LB53:
v_mov_b32 v5, v216
s_nop 1
v_permlane32_swap_b32 v216, v5
s_nop 1
v_add_f32 v216, v216, v5
v_mov_b32 v5, v216
s_nop 1
v_permlane16_swap_b32 v216, v5
s_nop 1
v_add_f32 v216, v216, v5
v_mov_b32 v5, v217
s_nop 1
v_permlane32_swap_b32 v217, v5
s_nop 1
v_add_f32 v217, v217, v5
v_mov_b32 v5, v217
s_nop 1
v_permlane16_swap_b32 v217, v5
s_nop 1
v_add_f32 v217, v217, v5
s_mov_b32 s48, 0x3acccccd
v_mul_f32 v216, s48, v216
v_mul_f32 v217, s48, v217
v_fma_f32 v217, -v216, v216, v217
v_max_f32 v217, 0, v217
v_add_f32 v217, 0x3727c5ac, v217
v_rsq_f32 v217, v217
s_nop 0
v_mov_b32 v5, v218
s_nop 1
v_permlane32_swap_b32 v218, v5
s_nop 1
v_add_f32 v218, v218, v5
v_mov_b32 v5, v218
s_nop 1
v_permlane16_swap_b32 v218, v5
s_nop 1
v_add_f32 v218, v218, v5
v_mov_b32 v5, v219
s_nop 1
v_permlane32_swap_b32 v219, v5
s_nop 1
v_add_f32 v219, v219, v5
v_mov_b32 v5, v219
s_nop 1
v_permlane16_swap_b32 v219, v5
s_nop 1
v_add_f32 v219, v219, v5
s_mov_b32 s48, 0x3acccccd
v_mul_f32 v218, s48, v218
v_mul_f32 v219, s48, v219
v_fma_f32 v219, -v218, v218, v219
v_max_f32 v219, 0, v219
v_add_f32 v219, 0x3727c5ac, v219
v_rsq_f32 v219, v219
s_nop 0
v_mov_b32 v5, v220
s_nop 1
v_permlane32_swap_b32 v220, v5
s_nop 1
v_add_f32 v220, v220, v5
v_mov_b32 v5, v220
s_nop 1
v_permlane16_swap_b32 v220, v5
s_nop 1
v_add_f32 v220, v220, v5
v_mov_b32 v5, v221
s_nop 1
v_permlane32_swap_b32 v221, v5
s_nop 1
v_add_f32 v221, v221, v5
v_mov_b32 v5, v221
s_nop 1
v_permlane16_swap_b32 v221, v5
s_nop 1
v_add_f32 v221, v221, v5
s_mov_b32 s48, 0x3acccccd
v_mul_f32 v220, s48, v220
v_mul_f32 v221, s48, v221
v_fma_f32 v221, -v220, v220, v221
v_max_f32 v221, 0, v221
v_add_f32 v221, 0x3727c5ac, v221
v_rsq_f32 v221, v221
s_nop 0
s_waitcnt lgkmcnt(0)
s_lshl_b32 s48, s40, 5
s_add_u32 s48, s48, 16
v_add_u32 v3, s48, v1
v_mul_u32_u24 v3, 264, v3
v_lshlrev_b32 v4, 3, v2
v_add_u32 v3, v3, v4
v_mul_u32_u24 v5, 264, v1
v_add_u32 v5, v5, v4
s_xor_b32 s48, s40, 0
s_lshl_b32 s48, s48, 6
v_add_u32 v6, s48, v3
v_pk_fma_f32 v[160:161], v[128:129], v[216:217], v[48:49] op_sel:[0,0,0] op_sel_hi:[1,0,1] neg_lo:[0,1,0] neg_hi:[0,1,0]
v_pk_fma_f32 v[162:163], v[130:131], v[216:217], v[50:51] op_sel:[0,0,0] op_sel_hi:[1,0,1] neg_lo:[0,1,0] neg_hi:[0,1,0]
v_pk_mul_f32 v[160:161], v[160:161], v[216:217] op_sel:[0,1] op_sel_hi:[1,1]
v_pk_mul_f32 v[162:163], v[162:163], v[216:217] op_sel:[0,1] op_sel_hi:[1,1]
v_cvt_pk_bf16_f32 v160, v160, v161
v_cvt_pk_bf16_f32 v161, v162, v163
ds_write_b64 v6, v[160:161] offset:0
v_pk_fma_f32 v[164:165], v[128:129], v[218:219], v[80:81] op_sel:[0,0,0] op_sel_hi:[1,0,1] neg_lo:[0,1,0] neg_hi:[0,1,0]
v_pk_fma_f32 v[166:167], v[130:131], v[218:219], v[82:83] op_sel:[0,0,0] op_sel_hi:[1,0,1] neg_lo:[0,1,0] neg_hi:[0,1,0]
v_pk_mul_f32 v[164:165], v[164:165], v[218:219] op_sel:[0,1] op_sel_hi:[1,1]
v_pk_mul_f32 v[166:167], v[166:167], v[218:219] op_sel:[0,1] op_sel_hi:[1,1]
v_cvt_pk_bf16_f32 v164, v164, v165
v_cvt_pk_bf16_f32 v165, v166, v167
ds_write_b64 v6, v[164:165] offset:4224
v_pk_fma_f32 v[176:177], v[128:129], v[220:221], v[112:113] op_sel:[0,0,0] op_sel_hi:[1,0,1] neg_lo:[0,1,0] neg_hi:[0,1,0]
v_pk_fma_f32 v[178:179], v[130:131], v[220:221], v[114:115] op_sel:[0,0,0] op_sel_hi:[1,0,1] neg_lo:[0,1,0] neg_hi:[0,1,0]
v_pk_mul_f32 v[176:177], v[176:177], v[220:221] op_sel:[0,1] op_sel_hi:[1,1]
v_pk_mul_f32 v[178:179], v[178:179], v[220:221] op_sel:[0,1] op_sel_hi:[1,1]
v_cvt_pk_bf16_f32 v176, v176, v177
v_cvt_pk_bf16_f32 v177, v178, v179
s_lshl_b32 s48, s40, 6
v_add_u32 v7, s48, v5
ds_write_b64 v7, v[176:177] offset:0
v_pk_fma_f32 v[168:169], v[132:133], v[216:217], v[52:53] op_sel:[0,0,0] op_sel_hi:[1,0,1] neg_lo:[0,1,0] neg_hi:[0,1,0]
v_pk_fma_f32 v[170:171], v[134:135], v[216:217], v[54:55] op_sel:[0,0,0] op_sel_hi:[1,0,1] neg_lo:[0,1,0] neg_hi:[0,1,0]
v_pk_mul_f32 v[168:169], v[168:169], v[216:217] op_sel:[0,1] op_sel_hi:[1,1]
v_pk_mul_f32 v[170:171], v[170:171], v[216:217] op_sel:[0,1] op_sel_hi:[1,1]
v_cvt_pk_bf16_f32 v168, v168, v169
v_cvt_pk_bf16_f32 v169, v170, v171
ds_write_b64 v6, v[168:169] offset:32
v_pk_fma_f32 v[172:173], v[132:133], v[218:219], v[84:85] op_sel:[0,0,0] op_sel_hi:[1,0,1] neg_lo:[0,1,0] neg_hi:[0,1,0]
v_pk_fma_f32 v[174:175], v[134:135], v[218:219], v[86:87] op_sel:[0,0,0] op_sel_hi:[1,0,1] neg_lo:[0,1,0] neg_hi:[0,1,0]
v_pk_mul_f32 v[172:173], v[172:173], v[218:219] op_sel:[0,1] op_sel_hi:[1,1]
v_pk_mul_f32 v[174:175], v[174:175], v[218:219] op_sel:[0,1] op_sel_hi:[1,1]
v_cvt_pk_bf16_f32 v172, v172, v173
v_cvt_pk_bf16_f32 v173, v174, v175
ds_write_b64 v6, v[172:173] offset:4256
v_pk_fma_f32 v[176:177], v[132:133], v[220:221], v[116:117] op_sel:[0,0,0] op_sel_hi:[1,0,1] neg_lo:[0,1,0] neg_hi:[0,1,0]
v_pk_fma_f32 v[178:179], v[134:135], v[220:221], v[118:119] op_sel:[0,0,0] op_sel_hi:[1,0,1] neg_lo:[0,1,0] neg_hi:[0,1,0]
v_pk_mul_f32 v[176:177], v[176:177], v[220:221] op_sel:[0,1] op_sel_hi:[1,1]
v_pk_mul_f32 v[178:179], v[178:179], v[220:221] op_sel:[0,1] op_sel_hi:[1,1]
v_cvt_pk_bf16_f32 v176, v176, v177
v_cvt_pk_bf16_f32 v177, v178, v179
s_lshl_b32 s48, s40, 6
v_add_u32 v7, s48, v5
ds_write_b64 v7, v[176:177] offset:32
s_xor_b32 s48, s40, 1
s_lshl_b32 s48, s48, 6
v_add_u32 v6, s48, v3
v_pk_fma_f32 v[160:161], v[136:137], v[216:217], v[56:57] op_sel:[0,0,0] op_sel_hi:[1,0,1] neg_lo:[0,1,0] neg_hi:[0,1,0]
v_pk_fma_f32 v[162:163], v[138:139], v[216:217], v[58:59] op_sel:[0,0,0] op_sel_hi:[1,0,1] neg_lo:[0,1,0] neg_hi:[0,1,0]
v_pk_mul_f32 v[160:161], v[160:161], v[216:217] op_sel:[0,1] op_sel_hi:[1,1]
v_pk_mul_f32 v[162:163], v[162:163], v[216:217] op_sel:[0,1] op_sel_hi:[1,1]
v_cvt_pk_bf16_f32 v160, v160, v161
v_cvt_pk_bf16_f32 v161, v162, v163
ds_write_b64 v6, v[160:161] offset:0
v_pk_fma_f32 v[164:165], v[136:137], v[218:219], v[88:89] op_sel:[0,0,0] op_sel_hi:[1,0,1] neg_lo:[0,1,0] neg_hi:[0,1,0]
v_pk_fma_f32 v[166:167], v[138:139], v[218:219], v[90:91] op_sel:[0,0,0] op_sel_hi:[1,0,1] neg_lo:[0,1,0] neg_hi:[0,1,0]
v_pk_mul_f32 v[164:165], v[164:165], v[218:219] op_sel:[0,1] op_sel_hi:[1,1]
v_pk_mul_f32 v[166:167], v[166:167], v[218:219] op_sel:[0,1] op_sel_hi:[1,1]
v_cvt_pk_bf16_f32 v164, v164, v165
v_cvt_pk_bf16_f32 v165, v166, v167
ds_write_b64 v6, v[164:165] offset:4224
v_pk_fma_f32 v[168:169], v[140:141], v[216:217], v[60:61] op_sel:[0,0,0] op_sel_hi:[1,0,1] neg_lo:[0,1,0] neg_hi:[0,1,0]
v_pk_fma_f32 v[170:171], v[142:143], v[216:217], v[62:63] op_sel:[0,0,0] op_sel_hi:[1,0,1] neg_lo:[0,1,0] neg_hi:[0,1,0]
v_pk_mul_f32 v[168:169], v[168:169], v[216:217] op_sel:[0,1] op_sel_hi:[1,1]
v_pk_mul_f32 v[170:171], v[170:171], v[216:217] op_sel:[0,1] op_sel_hi:[1,1]
v_cvt_pk_bf16_f32 v168, v168, v169
v_cvt_pk_bf16_f32 v169, v170, v171
ds_write_b64 v6, v[168:169] offset:32
v_pk_fma_f32 v[172:173], v[140:141], v[218:219], v[92:93] op_sel:[0,0,0] op_sel_hi:[1,0,1] neg_lo:[0,1,0] neg_hi:[0,1,0]
v_pk_fma_f32 v[174:175], v[142:143], v[218:219], v[94:95] op_sel:[0,0,0] op_sel_hi:[1,0,1] neg_lo:[0,1,0] neg_hi:[0,1,0]
v_pk_mul_f32 v[172:173], v[172:173], v[218:219] op_sel:[0,1] op_sel_hi:[1,1]
v_pk_mul_f32 v[174:175], v[174:175], v[218:219] op_sel:[0,1] op_sel_hi:[1,1]
v_cvt_pk_bf16_f32 v172, v172, v173
v_cvt_pk_bf16_f32 v173, v174, v175
ds_write_b64 v6, v[172:173] offset:4256
s_xor_b32 s48, s40, 2
s_lshl_b32 s48, s48, 6
v_add_u32 v6, s48, v3
v_pk_fma_f32 v[160:161], v[144:145], v[216:217], v[64:65] op_sel:[0,0,0] op_sel_hi:[1,0,1] neg_lo:[0,1,0] neg_hi:[0,1,0]
v_pk_fma_f32 v[162:163], v[146:147], v[216:217], v[66:67] op_sel:[0,0,0] op_sel_hi:[1,0,1] neg_lo:[0,1,0] neg_hi:[0,1,0]
v_pk_mul_f32 v[160:161], v[160:161], v[216:217] op_sel:[0,1] op_sel_hi:[1,1]
v_pk_mul_f32 v[162:163], v[162:163], v[216:217] op_sel:[0,1] op_sel_hi:[1,1]
v_cvt_pk_bf16_f32 v160, v160, v161
v_cvt_pk_bf16_f32 v161, v162, v163
ds_write_b64 v6, v[160:161] offset:0
v_pk_fma_f32 v[164:165], v[144:145], v[218:219], v[96:97] op_sel:[0,0,0] op_sel_hi:[1,0,1] neg_lo:[0,1,0] neg_hi:[0,1,0]
v_pk_fma_f32 v[166:167], v[146:147], v[218:219], v[98:99] op_sel:[0,0,0] op_sel_hi:[1,0,1] neg_lo:[0,1,0] neg_hi:[0,1,0]
v_pk_mul_f32 v[164:165], v[164:165], v[218:219] op_sel:[0,1] op_sel_hi:[1,1]
v_pk_mul_f32 v[166:167], v[166:167], v[218:219] op_sel:[0,1] op_sel_hi:[1,1]
v_cvt_pk_bf16_f32 v164, v164, v165
v_cvt_pk_bf16_f32 v165, v166, v167
ds_write_b64 v6, v[164:165] offset:4224
v_pk_fma_f32 v[168:169], v[148:149], v[216:217], v[68:69] op_sel:[0,0,0] op_sel_hi:[1,0,1] neg_lo:[0,1,0] neg_hi:[0,1,0]
v_pk_fma_f32 v[170:171], v[150:151], v[216:217], v[70:71] op_sel:[0,0,0] op_sel_hi:[1,0,1] neg_lo:[0,1,0] neg_hi:[0,1,0]
v_pk_mul_f32 v[168:169], v[168:169], v[216:217] op_sel:[0,1] op_sel_hi:[1,1]
v_pk_mul_f32 v[170:171], v[170:171], v[216:217] op_sel:[0,1] op_sel_hi:[1,1]
v_cvt_pk_bf16_f32 v168, v168, v169
v_cvt_pk_bf16_f32 v169, v170, v171
ds_write_b64 v6, v[168:169] offset:32
v_pk_fma_f32 v[172:173], v[148:149], v[218:219], v[100:101] op_sel:[0,0,0] op_sel_hi:[1,0,1] neg_lo:[0,1,0] neg_hi:[0,1,0]
v_pk_fma_f32 v[174:175], v[150:151], v[218:219], v[102:103] op_sel:[0,0,0] op_sel_hi:[1,0,1] neg_lo:[0,1,0] neg_hi:[0,1,0]
v_pk_mul_f32 v[172:173], v[172:173], v[218:219] op_sel:[0,1] op_sel_hi:[1,1]
v_pk_mul_f32 v[174:175], v[174:175], v[218:219] op_sel:[0,1] op_sel_hi:[1,1]
v_cvt_pk_bf16_f32 v172, v172, v173
v_cvt_pk_bf16_f32 v173, v174, v175
ds_write_b64 v6, v[172:173] offset:4256
s_xor_b32 s48, s40, 3
s_lshl_b32 s48, s48, 6
v_add_u32 v6, s48, v3
v_pk_fma_f32 v[160:161], v[152:153], v[216:217], v[72:73] op_sel:[0,0,0] op_sel_hi:[1,0,1] neg_lo:[0,1,0] neg_hi:[0,1,0]
v_pk_fma_f32 v[162:163], v[154:155], v[216:217], v[74:75] op_sel:[0,0,0] op_sel_hi:[1,0,1] neg_lo:[0,1,0] neg_hi:[0,1,0]
v_pk_mul_f32 v[160:161], v[160:161], v[216:217] op_sel:[0,1] op_sel_hi:[1,1]
v_pk_mul_f32 v[162:163], v[162:163], v[216:217] op_sel:[0,1] op_sel_hi:[1,1]
v_cvt_pk_bf16_f32 v160, v160, v161
v_cvt_pk_bf16_f32 v161, v162, v163
ds_write_b64 v6, v[160:161] offset:0
v_pk_fma_f32 v[164:165], v[152:153], v[218:219], v[104:105] op_sel:[0,0,0] op_sel_hi:[1,0,1] neg_lo:[0,1,0] neg_hi:[0,1,0]
v_pk_fma_f32 v[166:167], v[154:155], v[218:219], v[106:107] op_sel:[0,0,0] op_sel_hi:[1,0,1] neg_lo:[0,1,0] neg_hi:[0,1,0]
v_pk_mul_f32 v[164:165], v[164:165], v[218:219] op_sel:[0,1] op_sel_hi:[1,1]
v_pk_mul_f32 v[166:167], v[166:167], v[218:219] op_sel:[0,1] op_sel_hi:[1,1]
v_cvt_pk_bf16_f32 v164, v164, v165
v_cvt_pk_bf16_f32 v165, v166, v167
ds_write_b64 v6, v[164:165] offset:4224
v_pk_fma_f32 v[168:169], v[156:157], v[216:217], v[76:77] op_sel:[0,0,0] op_sel_hi:[1,0,1] neg_lo:[0,1,0] neg_hi:[0,1,0]
v_pk_fma_f32 v[170:171], v[158:159], v[216:217], v[78:79] op_sel:[0,0,0] op_sel_hi:[1,0,1] neg_lo:[0,1,0] neg_hi:[0,1,0]
v_pk_mul_f32 v[168:169], v[168:169], v[216:217] op_sel:[0,1] op_sel_hi:[1,1]
v_pk_mul_f32 v[170:171], v[170:171], v[216:217] op_sel:[0,1] op_sel_hi:[1,1]
v_cvt_pk_bf16_f32 v168, v168, v169
v_cvt_pk_bf16_f32 v169, v170, v171
ds_write_b64 v6, v[168:169] offset:32
v_pk_fma_f32 v[172:173], v[156:157], v[218:219], v[108:109] op_sel:[0,0,0] op_sel_hi:[1,0,1] neg_lo:[0,1,0] neg_hi:[0,1,0]
v_pk_fma_f32 v[174:175], v[158:159], v[218:219], v[110:111] op_sel:[0,0,0] op_sel_hi:[1,0,1] neg_lo:[0,1,0] neg_hi:[0,1,0]
v_pk_mul_f32 v[172:173], v[172:173], v[218:219] op_sel:[0,1] op_sel_hi:[1,1]
v_pk_mul_f32 v[174:175], v[174:175], v[218:219] op_sel:[0,1] op_sel_hi:[1,1]
v_cvt_pk_bf16_f32 v172, v172, v173
v_cvt_pk_bf16_f32 v173, v174, v175
ds_write_b64 v6, v[172:173] offset:4256
s_waitcnt lgkmcnt(0)
s_barrier
v_and_b32 v3, 31, v0
s_lshl_b32 s48, s40, 5
v_add_u32 v3, s48, v3
v_lshrrev_b32 v4, 5, v0
v_mul_u32_u24 v4, 40, v4
v_add_u32 v5, 2, v3
v_mul_u32_u24 v5, 264, v5
v_add_u32 v212, v5, v4
ds_read_b64 v[128:129], v212 offset:3696
ds_read_b64 v[130:131], v212 offset:3704
ds_read_b64 v[132:133], v212 offset:3712
ds_read_b64 v[134:135], v212 offset:3720
ds_read_b64 v[136:137], v212 offset:3728
ds_read_b64 v[138:139], v212 offset:3776
ds_read_b64 v[140:141], v212 offset:3784
ds_read_b64 v[142:143], v212 offset:3792
ds_read_b64 v[144:145], v212 offset:3800
ds_read_b64 v[146:147], v212 offset:3808
ds_read_b64 v[148:149], v212 offset:3248
ds_read_b64 v[150:151], v212 offset:3256
ds_read_b64 v[152:153], v212 offset:3264
ds_read_b64 v[154:155], v212 offset:3272
ds_read_b64 v[156:157], v212 offset:3280
s_waitcnt lgkmcnt(5)
v_dot2_f32_bf16 v158, v128, v138, 0
v_dot2_f32_bf16 v158, v129, v139, v158
v_dot2_f32_bf16 v158, v130, v140, v158
v_dot2_f32_bf16 v158, v131, v141, v158
v_dot2_f32_bf16 v158, v132, v142, v158
v_dot2_f32_bf16 v158, v133, v143, v158
v_dot2_f32_bf16 v158, v134, v144, v158
v_dot2_f32_bf16 v158, v135, v145, v158
v_dot2_f32_bf16 v158, v136, v146, v158
v_dot2_f32_bf16 v158, v137, v147, v158
ds_read_b64 v[138:139], v212 offset:2720
ds_read_b64 v[140:141], v212 offset:2728
ds_read_b64 v[142:143], v212 offset:2736
ds_read_b64 v[144:145], v212 offset:2744
ds_read_b64 v[146:147], v212 offset:2752
s_waitcnt lgkmcnt(5)
v_dot2_f32_bf16 v159, v128, v148, 0
v_dot2_f32_bf16 v159, v129, v149, v159
v_dot2_f32_bf16 v159, v130, v150, v159
v_dot2_f32_bf16 v159, v131, v151, v159
v_dot2_f32_bf16 v159, v132, v152, v159
v_dot2_f32_bf16 v159, v133, v153, v159
v_dot2_f32_bf16 v159, v134, v154, v159
v_dot2_f32_bf16 v159, v135, v155, v159
v_dot2_f32_bf16 v159, v136, v156, v159
v_dot2_f32_bf16 v159, v137, v157, v159
ds_read_b64 v[148:149], v212 offset:2192
ds_read_b64 v[150:151], v212 offset:2200
ds_read_b64 v[152:153], v212 offset:2208
ds_read_b64 v[154:155], v212 offset:2216
ds_read_b64 v[156:157], v212 offset:2224
s_waitcnt lgkmcnt(5)
v_dot2_f32_bf16 v160, v128, v138, 0
v_dot2_f32_bf16 v160, v129, v139, v160
v_dot2_f32_bf16 v160, v130, v140, v160
v_dot2_f32_bf16 v160, v131, v141, v160
v_dot2_f32_bf16 v160, v132, v142, v160
v_dot2_f32_bf16 v160, v133, v143, v160
v_dot2_f32_bf16 v160, v134, v144, v160
v_dot2_f32_bf16 v160, v135, v145, v160
v_dot2_f32_bf16 v160, v136, v146, v160
v_dot2_f32_bf16 v160, v137, v147, v160
ds_read_b64 v[138:139], v212 offset:1664
ds_read_b64 v[140:141], v212 offset:1672
ds_read_b64 v[142:143], v212 offset:1680
ds_read_b64 v[144:145], v212 offset:1688
ds_read_b64 v[146:147], v212 offset:1696
s_waitcnt lgkmcnt(5)
v_dot2_f32_bf16 v161, v128, v148, 0
v_dot2_f32_bf16 v161, v129, v149, v161
v_dot2_f32_bf16 v161, v130, v150, v161
v_dot2_f32_bf16 v161, v131, v151, v161
v_dot2_f32_bf16 v161, v132, v152, v161
v_dot2_f32_bf16 v161, v133, v153, v161
v_dot2_f32_bf16 v161, v134, v154, v161
v_dot2_f32_bf16 v161, v135, v155, v161
v_dot2_f32_bf16 v161, v136, v156, v161
v_dot2_f32_bf16 v161, v137, v157, v161
ds_read_b64 v[148:149], v212 offset:1136
ds_read_b64 v[150:151], v212 offset:1144
ds_read_b64 v[152:153], v212 offset:1152
ds_read_b64 v[154:155], v212 offset:1160
ds_read_b64 v[156:157], v212 offset:1168
s_waitcnt lgkmcnt(5)
v_dot2_f32_bf16 v162, v128, v138, 0
v_dot2_f32_bf16 v162, v129, v139, v162
v_dot2_f32_bf16 v162, v130, v140, v162
v_dot2_f32_bf16 v162, v131, v141, v162
v_dot2_f32_bf16 v162, v132, v142, v162
v_dot2_f32_bf16 v162, v133, v143, v162
v_dot2_f32_bf16 v162, v134, v144, v162
v_dot2_f32_bf16 v162, v135, v145, v162
v_dot2_f32_bf16 v162, v136, v146, v162
v_dot2_f32_bf16 v162, v137, v147, v162
ds_read_b64 v[138:139], v212 offset:608
ds_read_b64 v[140:141], v212 offset:616
ds_read_b64 v[142:143], v212 offset:624
ds_read_b64 v[144:145], v212 offset:632
ds_read_b64 v[146:147], v212 offset:640
s_waitcnt lgkmcnt(5)
v_dot2_f32_bf16 v163, v128, v148, 0
v_dot2_f32_bf16 v163, v129, v149, v163
v_dot2_f32_bf16 v163, v130, v150, v163
v_dot2_f32_bf16 v163, v131, v151, v163
v_dot2_f32_bf16 v163, v132, v152, v163
v_dot2_f32_bf16 v163, v133, v153, v163
v_dot2_f32_bf16 v163, v134, v154, v163
v_dot2_f32_bf16 v163, v135, v155, v163
v_dot2_f32_bf16 v163, v136, v156, v163
v_dot2_f32_bf16 v163, v137, v157, v163
ds_read_b64 v[148:149], v212 offset:80
ds_read_b64 v[150:151], v212 offset:88
ds_read_b64 v[152:153], v212 offset:96
ds_read_b64 v[154:155], v212 offset:104
ds_read_b64 v[156:157], v212 offset:112
s_waitcnt lgkmcnt(5)
v_dot2_f32_bf16 v164, v128, v138, 0
v_dot2_f32_bf16 v164, v129, v139, v164
v_dot2_f32_bf16 v164, v130, v140, v164
v_dot2_f32_bf16 v164, v131, v141, v164
v_dot2_f32_bf16 v164, v132, v142, v164
v_dot2_f32_bf16 v164, v133, v143, v164
v_dot2_f32_bf16 v164, v134, v144, v164
v_dot2_f32_bf16 v164, v135, v145, v164
v_dot2_f32_bf16 v164, v136, v146, v164
v_dot2_f32_bf16 v164, v137, v147, v164
s_waitcnt lgkmcnt(0)
v_dot2_f32_bf16 v165, v128, v148, 0
v_dot2_f32_bf16 v165, v129, v149, v165
v_dot2_f32_bf16 v165, v130, v150, v165
v_dot2_f32_bf16 v165, v131, v151, v165
v_dot2_f32_bf16 v165, v132, v152, v165
v_dot2_f32_bf16 v165, v133, v153, v165
v_dot2_f32_bf16 v165, v134, v154, v165
v_dot2_f32_bf16 v165, v135, v155, v165
v_dot2_f32_bf16 v165, v136, v156, v165
v_dot2_f32_bf16 v165, v137, v157, v165
ds_read_b64 v[138:139], v212 offset:3856
ds_read_b64 v[140:141], v212 offset:3864
ds_read_b64 v[142:143], v212 offset:3872
ds_read_b64 v[144:145], v212 offset:3880
ds_read_b64 v[146:147], v212 offset:3888
s_lshl_b32 s48, s41, 7
v_add_u32 v5, s48, v3
s_mov_b32 s55, 0x3ea52b5c
v_mov_b32 v6, 0xceaaaaaa
v_cmp_le_u32 vcc, 2, v5
v_cndmask_b32 v159, v6, v159, vcc
v_cmp_le_u32 vcc, 4, v5
v_cndmask_b32 v160, v6, v160, vcc
v_cmp_le_u32 vcc, 6, v5
v_cndmask_b32 v161, v6, v161, vcc
v_cmp_le_u32 vcc, 8, v5
v_cndmask_b32 v162, v6, v162, vcc
v_cmp_le_u32 vcc, 10, v5
v_cndmask_b32 v163, v6, v163, vcc
v_cmp_le_u32 vcc, 12, v5
v_cndmask_b32 v164, v6, v164, vcc
v_cmp_le_u32 vcc, 14, v5
v_cndmask_b32 v165, v6, v165, vcc
v_max3_f32 v6, v158, v159, v160
v_max3_f32 v6, v6, v161, v162
v_max3_f32 v6, v6, v163, v164
v_max_f32 v6, v6, v165
v_mul_f32 v6, s55, v6
v_fma_f32 v158, v158, s55, -v6
v_fma_f32 v159, v159, s55, -v6
v_fma_f32 v160, v160, s55, -v6
v_fma_f32 v161, v161, s55, -v6
v_fma_f32 v162, v162, s55, -v6
v_fma_f32 v163, v163, s55, -v6
v_fma_f32 v164, v164, s55, -v6
v_fma_f32 v165, v165, s55, -v6
v_exp_f32 v158, v158
v_exp_f32 v159, v159
v_exp_f32 v160, v160
v_exp_f32 v161, v161
v_exp_f32 v162, v162
v_exp_f32 v163, v163
v_exp_f32 v164, v164
v_exp_f32 v165, v165
s_nop 0
v_add_f32 v6, v158, v159
v_add_f32 v6, v6, v160
v_add_f32 v6, v6, v161
v_add_f32 v6, v6, v162
v_add_f32 v6, v6, v163
v_add_f32 v6, v6, v164
v_add_f32 v6, v6, v165
v_rcp_f32 v6, v6
s_nop 0
v_mul_f32 v158, v6, v158
v_mul_f32 v159, v6, v159
v_mul_f32 v160, v6, v160
v_mul_f32 v161, v6, v161
v_mul_f32 v162, v6, v162
v_mul_f32 v163, v6, v163
v_mul_f32 v164, v6, v164
v_mul_f32 v165, v6, v165
v_cvt_pk_bf16_f32 v196, v158, 0
v_lshlrev_b32 v204, 16, v196
v_cvt_pk_bf16_f32 v197, v159, 0
v_lshlrev_b32 v205, 16, v197
v_cvt_pk_bf16_f32 v198, v160, 0
v_lshlrev_b32 v206, 16, v198
v_cvt_pk_bf16_f32 v199, v161, 0
v_lshlrev_b32 v207, 16, v199
v_cvt_pk_bf16_f32 v200, v162, 0
v_lshlrev_b32 v208, 16, v200
v_cvt_pk_bf16_f32 v201, v163, 0
v_lshlrev_b32 v209, 16, v201
v_cvt_pk_bf16_f32 v202, v164, 0
v_lshlrev_b32 v210, 16, v202
v_cvt_pk_bf16_f32 v203, v165, 0
v_lshlrev_b32 v211, 16, v203
ds_read_b64 v[148:149], v212 offset:3328
ds_read_b64 v[150:151], v212 offset:3336
ds_read_b64 v[152:153], v212 offset:3344
ds_read_b64 v[154:155], v212 offset:3352
ds_read_b64 v[156:157], v212 offset:3360
s_waitcnt lgkmcnt(5)
v_dot2_f32_bf16 v168, v138, v196, 0
v_dot2_f32_bf16 v169, v138, v204, 0
v_dot2_f32_bf16 v170, v139, v196, 0
v_dot2_f32_bf16 v171, v139, v204, 0
v_dot2_f32_bf16 v172, v140, v196, 0
v_dot2_f32_bf16 v173, v140, v204, 0
v_dot2_f32_bf16 v174, v141, v196, 0
v_dot2_f32_bf16 v175, v141, v204, 0
v_dot2_f32_bf16 v176, v142, v196, 0
v_dot2_f32_bf16 v177, v142, v204, 0
v_dot2_f32_bf16 v178, v143, v196, 0
v_dot2_f32_bf16 v179, v143, v204, 0
v_dot2_f32_bf16 v180, v144, v196, 0
v_dot2_f32_bf16 v181, v144, v204, 0
v_dot2_f32_bf16 v182, v145, v196, 0
v_dot2_f32_bf16 v183, v145, v204, 0
v_dot2_f32_bf16 v184, v146, v196, 0
v_dot2_f32_bf16 v185, v146, v204, 0
v_dot2_f32_bf16 v186, v147, v196, 0
v_dot2_f32_bf16 v187, v147, v204, 0
ds_read_b64 v[138:139], v212 offset:2800
ds_read_b64 v[140:141], v212 offset:2808
ds_read_b64 v[142:143], v212 offset:2816
ds_read_b64 v[144:145], v212 offset:2824
ds_read_b64 v[146:147], v212 offset:2832
s_waitcnt lgkmcnt(5)
v_dot2_f32_bf16 v168, v148, v197, v168
v_dot2_f32_bf16 v169, v148, v205, v169
v_dot2_f32_bf16 v170, v149, v197, v170
v_dot2_f32_bf16 v171, v149, v205, v171
v_dot2_f32_bf16 v172, v150, v197, v172
v_dot2_f32_bf16 v173, v150, v205, v173
v_dot2_f32_bf16 v174, v151, v197, v174
v_dot2_f32_bf16 v175, v151, v205, v175
v_dot2_f32_bf16 v176, v152, v197, v176
v_dot2_f32_bf16 v177, v152, v205, v177
v_dot2_f32_bf16 v178, v153, v197, v178
v_dot2_f32_bf16 v179, v153, v205, v179
v_dot2_f32_bf16 v180, v154, v197, v180
v_dot2_f32_bf16 v181, v154, v205, v181
v_dot2_f32_bf16 v182, v155, v197, v182
v_dot2_f32_bf16 v183, v155, v205, v183
v_dot2_f32_bf16 v184, v156, v197, v184
v_dot2_f32_bf16 v185, v156, v205, v185
v_dot2_f32_bf16 v186, v157, v197, v186
v_dot2_f32_bf16 v187, v157, v205, v187
ds_read_b64 v[148:149], v212 offset:2272
ds_read_b64 v[150:151], v212 offset:2280
ds_read_b64 v[152:153], v212 offset:2288
ds_read_b64 v[154:155], v212 offset:2296
ds_read_b64 v[156:157], v212 offset:2304
s_waitcnt lgkmcnt(5)
v_dot2_f32_bf16 v168, v138, v198, v168
v_dot2_f32_bf16 v169, v138, v206, v169
v_dot2_f32_bf16 v170, v139, v198, v170
v_dot2_f32_bf16 v171, v139, v206, v171
v_dot2_f32_bf16 v172, v140, v198, v172
v_dot2_f32_bf16 v173, v140, v206, v173
v_dot2_f32_bf16 v174, v141, v198, v174
v_dot2_f32_bf16 v175, v141, v206, v175
v_dot2_f32_bf16 v176, v142, v198, v176
v_dot2_f32_bf16 v177, v142, v206, v177
v_dot2_f32_bf16 v178, v143, v198, v178
v_dot2_f32_bf16 v179, v143, v206, v179
v_dot2_f32_bf16 v180, v144, v198, v180
v_dot2_f32_bf16 v181, v144, v206, v181
v_dot2_f32_bf16 v182, v145, v198, v182
v_dot2_f32_bf16 v183, v145, v206, v183
v_dot2_f32_bf16 v184, v146, v198, v184
v_dot2_f32_bf16 v185, v146, v206, v185
v_dot2_f32_bf16 v186, v147, v198, v186
v_dot2_f32_bf16 v187, v147, v206, v187
ds_read_b64 v[138:139], v212 offset:1744
ds_read_b64 v[140:141], v212 offset:1752
ds_read_b64 v[142:143], v212 offset:1760
ds_read_b64 v[144:145], v212 offset:1768
ds_read_b64 v[146:147], v212 offset:1776
s_waitcnt lgkmcnt(5)
v_dot2_f32_bf16 v168, v148, v199, v168
v_dot2_f32_bf16 v169, v148, v207, v169
v_dot2_f32_bf16 v170, v149, v199, v170
v_dot2_f32_bf16 v171, v149, v207, v171
v_dot2_f32_bf16 v172, v150, v199, v172
v_dot2_f32_bf16 v173, v150, v207, v173
v_dot2_f32_bf16 v174, v151, v199, v174
v_dot2_f32_bf16 v175, v151, v207, v175
v_dot2_f32_bf16 v176, v152, v199, v176
v_dot2_f32_bf16 v177, v152, v207, v177
v_dot2_f32_bf16 v178, v153, v199, v178
v_dot2_f32_bf16 v179, v153, v207, v179
v_dot2_f32_bf16 v180, v154, v199, v180
v_dot2_f32_bf16 v181, v154, v207, v181
v_dot2_f32_bf16 v182, v155, v199, v182
v_dot2_f32_bf16 v183, v155, v207, v183
v_dot2_f32_bf16 v184, v156, v199, v184
v_dot2_f32_bf16 v185, v156, v207, v185
v_dot2_f32_bf16 v186, v157, v199, v186
v_dot2_f32_bf16 v187, v157, v207, v187
ds_read_b64 v[148:149], v212 offset:1216
ds_read_b64 v[150:151], v212 offset:1224
ds_read_b64 v[152:153], v212 offset:1232
ds_read_b64 v[154:155], v212 offset:1240
ds_read_b64 v[156:157], v212 offset:1248
s_waitcnt lgkmcnt(5)
v_dot2_f32_bf16 v168, v138, v200, v168
v_dot2_f32_bf16 v169, v138, v208, v169
v_dot2_f32_bf16 v170, v139, v200, v170
v_dot2_f32_bf16 v171, v139, v208, v171
v_dot2_f32_bf16 v172, v140, v200, v172
v_dot2_f32_bf16 v173, v140, v208, v173
v_dot2_f32_bf16 v174, v141, v200, v174
v_dot2_f32_bf16 v175, v141, v208, v175
v_dot2_f32_bf16 v176, v142, v200, v176
v_dot2_f32_bf16 v177, v142, v208, v177
v_dot2_f32_bf16 v178, v143, v200, v178
v_dot2_f32_bf16 v179, v143, v208, v179
v_dot2_f32_bf16 v180, v144, v200, v180
v_dot2_f32_bf16 v181, v144, v208, v181
v_dot2_f32_bf16 v182, v145, v200, v182
v_dot2_f32_bf16 v183, v145, v208, v183
v_dot2_f32_bf16 v184, v146, v200, v184
v_dot2_f32_bf16 v185, v146, v208, v185
v_dot2_f32_bf16 v186, v147, v200, v186
v_dot2_f32_bf16 v187, v147, v208, v187
ds_read_b64 v[138:139], v212 offset:688
ds_read_b64 v[140:141], v212 offset:696
ds_read_b64 v[142:143], v212 offset:704
ds_read_b64 v[144:145], v212 offset:712
ds_read_b64 v[146:147], v212 offset:720
s_waitcnt lgkmcnt(5)
v_dot2_f32_bf16 v168, v148, v201, v168
v_dot2_f32_bf16 v169, v148, v209, v169
v_dot2_f32_bf16 v170, v149, v201, v170
v_dot2_f32_bf16 v171, v149, v209, v171
v_dot2_f32_bf16 v172, v150, v201, v172
v_dot2_f32_bf16 v173, v150, v209, v173
v_dot2_f32_bf16 v174, v151, v201, v174
v_dot2_f32_bf16 v175, v151, v209, v175
v_dot2_f32_bf16 v176, v152, v201, v176
v_dot2_f32_bf16 v177, v152, v209, v177
v_dot2_f32_bf16 v178, v153, v201, v178
v_dot2_f32_bf16 v179, v153, v209, v179
v_dot2_f32_bf16 v180, v154, v201, v180
v_dot2_f32_bf16 v181, v154, v209, v181
v_dot2_f32_bf16 v182, v155, v201, v182
v_dot2_f32_bf16 v183, v155, v209, v183
v_dot2_f32_bf16 v184, v156, v201, v184
v_dot2_f32_bf16 v185, v156, v209, v185
v_dot2_f32_bf16 v186, v157, v201, v186
v_dot2_f32_bf16 v187, v157, v209, v187
ds_read_b64 v[148:149], v212 offset:160
ds_read_b64 v[150:151], v212 offset:168
ds_read_b64 v[152:153], v212 offset:176
ds_read_b64 v[154:155], v212 offset:184
ds_read_b64 v[156:157], v212 offset:192
s_waitcnt lgkmcnt(5)
v_dot2_f32_bf16 v168, v138, v202, v168
v_dot2_f32_bf16 v169, v138, v210, v169
v_dot2_f32_bf16 v170, v139, v202, v170
v_dot2_f32_bf16 v171, v139, v210, v171
v_dot2_f32_bf16 v172, v140, v202, v172
v_dot2_f32_bf16 v173, v140, v210, v173
v_dot2_f32_bf16 v174, v141, v202, v174
v_dot2_f32_bf16 v175, v141, v210, v175
v_dot2_f32_bf16 v176, v142, v202, v176
v_dot2_f32_bf16 v177, v142, v210, v177
v_dot2_f32_bf16 v178, v143, v202, v178
v_dot2_f32_bf16 v179, v143, v210, v179
v_dot2_f32_bf16 v180, v144, v202, v180
v_dot2_f32_bf16 v181, v144, v210, v181
v_dot2_f32_bf16 v182, v145, v202, v182
v_dot2_f32_bf16 v183, v145, v210, v183
v_dot2_f32_bf16 v184, v146, v202, v184
v_dot2_f32_bf16 v185, v146, v210, v185
v_dot2_f32_bf16 v186, v147, v202, v186
v_dot2_f32_bf16 v187, v147, v210, v187
s_waitcnt lgkmcnt(0)
v_dot2_f32_bf16 v168, v148, v203, v168
v_dot2_f32_bf16 v169, v148, v211, v169
v_dot2_f32_bf16 v170, v149, v203, v170
v_dot2_f32_bf16 v171, v149, v211, v171
v_dot2_f32_bf16 v172, v150, v203, v172
v_dot2_f32_bf16 v173, v150, v211, v173
v_dot2_f32_bf16 v174, v151, v203, v174
v_dot2_f32_bf16 v175, v151, v211, v175
v_dot2_f32_bf16 v176, v152, v203, v176
v_dot2_f32_bf16 v177, v152, v211, v177
v_dot2_f32_bf16 v178, v153, v203, v178
v_dot2_f32_bf16 v179, v153, v211, v179
v_dot2_f32_bf16 v180, v154, v203, v180
v_dot2_f32_bf16 v181, v154, v211, v181
v_dot2_f32_bf16 v182, v155, v203, v182
v_dot2_f32_bf16 v183, v155, v211, v183
v_dot2_f32_bf16 v184, v156, v203, v184
v_dot2_f32_bf16 v185, v156, v211, v185
v_dot2_f32_bf16 v186, v157, v203, v186
v_dot2_f32_bf16 v187, v157, v211, v187
v_cvt_pk_bf16_f32 v128, v168, v169
v_cvt_pk_bf16_f32 v129, v170, v171
v_cvt_pk_bf16_f32 v130, v172, v173
v_cvt_pk_bf16_f32 v131, v174, v175
v_cvt_pk_bf16_f32 v132, v176, v177
v_cvt_pk_bf16_f32 v133, v178, v179
v_cvt_pk_bf16_f32 v134, v180, v181
v_cvt_pk_bf16_f32 v135, v182, v183
v_cvt_pk_bf16_f32 v136, v184, v185
v_cvt_pk_bf16_f32 v137, v186, v187
v_mul_u32_u24 v5, 80, v3
v_add_u32 v5, v5, v4
ds_write_b64 v5, v[128:129] offset:38912
ds_write_b64 v5, v[130:131] offset:38920
ds_write_b64 v5, v[132:133] offset:38928
ds_write_b64 v5, v[134:135] offset:38936
ds_write_b64 v5, v[136:137] offset:38944
s_waitcnt lgkmcnt(0)
v_lshrrev_b32 v4, 5, v0
v_add_u32 v4, 0, v4
s_mul_i32 s48, s42, 5
v_add_u32 v5, s48, v4
v_mul_u32_u24 v6, 80, v3
v_lshlrev_b32 v4, 4, v4
v_add_u32 v6, v6, v4
v_and_b32 v4, 1, v5
v_lshlrev_b32 v4, 3, v4
v_add_u32 v212, v6, v4
v_xor_b32 v4, 8, v4
v_add_u32 v213, v6, v4
ds_read_b64 v[168:169], v212 offset:38912
ds_read_b64 v[170:171], v213 offset:38912
v_lshrrev_b32 v4, 4, v3
s_lshl_b32 s48, s41, 3
v_add_u32 v4, s48, v4
v_mul_u32_u24 v4, 20, v4
v_lshrrev_b32 v6, 2, v5
v_add_u32 v4, v4, v6
v_lshlrev_b32 v4, 10, v4
v_and_b32 v5, 3, v5
v_lshlrev_b32 v5, 8, v5
v_add_u32 v4, v4, v5
v_lshlrev_b32 v5, 4, v1
v_add_u32 v188, v4, v5
v_lshrrev_b32 v4, 5, v0
v_add_u32 v4, 2, v4
s_mul_i32 s48, s42, 5
v_add_u32 v5, s48, v4
v_mul_u32_u24 v6, 80, v3
v_lshlrev_b32 v4, 4, v4
v_add_u32 v6, v6, v4
v_and_b32 v4, 1, v5
v_lshlrev_b32 v4, 3, v4
v_add_u32 v212, v6, v4
v_xor_b32 v4, 8, v4
v_add_u32 v213, v6, v4
ds_read_b64 v[172:173], v212 offset:38912
ds_read_b64 v[174:175], v213 offset:38912
v_lshrrev_b32 v4, 4, v3
s_lshl_b32 s48, s41, 3
v_add_u32 v4, s48, v4
v_mul_u32_u24 v4, 20, v4
v_lshrrev_b32 v6, 2, v5
v_add_u32 v4, v4, v6
v_lshlrev_b32 v4, 10, v4
v_and_b32 v5, 3, v5
v_lshlrev_b32 v5, 8, v5
v_add_u32 v4, v4, v5
v_lshlrev_b32 v5, 4, v1
v_add_u32 v189, v4, v5
v_lshrrev_b32 v4, 5, v0
v_add_u32 v4, 4, v4
s_mul_i32 s48, s42, 5
v_add_u32 v5, s48, v4
v_mul_u32_u24 v6, 80, v3
v_lshlrev_b32 v4, 4, v4
v_add_u32 v6, v6, v4
v_and_b32 v4, 1, v5
v_lshlrev_b32 v4, 3, v4
v_add_u32 v212, v6, v4
v_xor_b32 v4, 8, v4
v_add_u32 v213, v6, v4
ds_read_b64 v[176:177], v212 offset:38912
ds_read_b64 v[178:179], v213 offset:38912
v_lshrrev_b32 v4, 4, v3
s_lshl_b32 s48, s41, 3
v_add_u32 v4, s48, v4
v_mul_u32_u24 v4, 20, v4
v_lshrrev_b32 v6, 2, v5
v_add_u32 v4, v4, v6
v_lshlrev_b32 v4, 10, v4
v_and_b32 v5, 3, v5
v_lshlrev_b32 v5, 8, v5
v_add_u32 v4, v4, v5
v_lshlrev_b32 v5, 4, v1
v_add_u32 v190, v4, v5
s_waitcnt lgkmcnt(0)
s_cmp_eq_u32 s80, 0
s_cbranch_scc1 LB54
buffer_store_dwordx4 v[168:171], v188, s[32:35], s51 offen sc0 sc1
s_branch LB55
LB54:
buffer_store_dwordx4 v[168:171], v188, s[32:35], s51 offen sc0 sc1
LB55:
s_cmp_eq_u32 s80, 0
s_cbranch_scc1 LB56
buffer_store_dwordx4 v[172:175], v189, s[32:35], s51 offen sc0 sc1
s_branch LB57
LB56:
buffer_store_dwordx4 v[172:175], v189, s[32:35], s51 offen sc0 sc1
LB57:
s_mov_b32 exec_hi, 0
s_cmp_eq_u32 s80, 0
s_cbranch_scc1 LB58
buffer_store_dwordx4 v[176:179], v190, s[32:35], s51 offen sc0 sc1
s_branch LB59
LB58:
buffer_store_dwordx4 v[176:179], v190, s[32:35], s51 offen sc0 sc1
LB59:
s_mov_b32 exec_hi, -1
s_waitcnt vmcnt(0)
s_barrier
s_cmp_lg_u32 s40, 0
s_cbranch_scc1 LB60
s_lshl_b32 s48, s43, 2
s_add_u32 s48, s48, 0
s_add_u32 s55, s44, s48
s_add_u32 s55, s55, s81
s_lshl_b32 s48, s48, 11
s_add_u32 s48, s48, s57
s_lshl_b32 s56, s42, 2
s_add_u32 s48, s48, s56
v_mov_b32 v3, s48
v_mov_b32 v4, s55
s_mov_b64 s[58:59], exec
s_mov_b64 exec, 1
s_cmp_eq_u32 s80, 0
s_cbranch_scc1 LB61
buffer_store_dword v4, v3, s[32:35], 0 offen
s_branch LB62
LB61:
buffer_store_dword v4, v3, s[32:35], 0 offen sc0 sc1
LB62:
s_mov_b64 exec, s[58:59]
LB60:
v_lshrrev_b32 v3, 2, v1
v_and_b32 v4, 3, v0
v_lshlrev_b32 v4, 3, v4
v_and_b32 v5, 1, v2
v_lshlrev_b32 v5, 2, v5
v_lshlrev_b32 v6, 3, v2
v_add_u32 v6, v6, v3
v_add_u32 v3, v6, v5
v_mul_u32_u24 v3, 160, v3
v_add_u32 v24, v3, v4
v_xor_b32 v5, 4, v5
v_add_u32 v3, v6, v5
v_mul_u32_u24 v3, 160, v3
v_add_u32 v25, v3, v4
v_add_u32 v27, 110592, v24
v_add_u32 v28, 110592, v25
v_add_u32 v24, 49152, v24
v_add_u32 v25, 49152, v25
s_lshr_b32 s48, s42, 3
s_lshl_b32 s48, s48, 2
s_lshl_b32 s64, s41, 3
s_add_u32 s64, s64, s48
s_add_u32 s64, s64, s40
s_mul_i32 s64, s64, 20480
s_add_u32 s64, s64, s51
v_lshlrev_b32 v3, 4, v0
v_add_u32 v26, s64, v3
s_cmp_lg_u32 s40, 0
s_cbranch_scc1 LB63
s_lshl_b32 s48, s43, 2
s_add_u32 s48, s48, 0
s_add_u32 s55, s44, s48
s_lshl_b32 s48, s48, 11
s_add_u32 s48, s48, s57
v_lshlrev_b32 v3, 2, v1
v_add_u32 v3, s48, v3
s_mov_b32 s56, 0
LB64:
buffer_load_dword v4, v3, s[32:35], 0 offen sc0 sc1
s_waitcnt vmcnt(0)
v_and_b32 v6, 0xffffff87, v4
v_cmp_ne_u32 vcc, s55, v6
s_cbranch_vccz LB63
s_add_u32 s56, s56, 1
s_cmp_lt_u32 s56, 20000
s_cbranch_scc1 LB64
LB63:
s_barrier
s_mov_b32 s47, 0
buffer_load_dwordx4 v[160:163], v26, s[32:35], s47 offen offset:0 sc1
s_mov_b32 s47, 0
buffer_load_dwordx4 v[164:167], v26, s[32:35], s47 offen offset:1024 sc1
s_mov_b32 s47, 0
buffer_load_dwordx4 v[168:171], v26, s[32:35], s47 offen offset:2048 sc1
s_mov_b32 s47, 0
buffer_load_dwordx4 v[172:175], v26, s[32:35], s47 offen offset:3072 sc1
s_mov_b32 s47, 4096
buffer_load_dwordx4 v[176:179], v26, s[32:35], s47 offen offset:0 sc1
s_mov_b32 s47, 4096
buffer_load_dwordx4 v[180:183], v26, s[32:35], s47 offen offset:1024 sc1
s_mov_b32 s47, 4096
buffer_load_dwordx4 v[184:187], v26, s[32:35], s47 offen offset:2048 sc1
s_mov_b32 s47, 4096
buffer_load_dwordx4 v[188:191], v26, s[32:35], s47 offen offset:3072 sc1
s_mov_b32 s47, 8192
buffer_load_dwordx4 v[192:195], v26, s[32:35], s47 offen offset:0 sc1
s_mov_b32 s47, 8192
buffer_load_dwordx4 v[196:199], v26, s[32:35], s47 offen offset:1024 sc1
s_mov_b32 s47, 8192
buffer_load_dwordx4 v[200:203], v26, s[32:35], s47 offen offset:2048 sc1
s_mov_b32 s47, 8192
buffer_load_dwordx4 v[204:207], v26, s[32:35], s47 offen offset:3072 sc1
s_mov_b32 s47, 12288
buffer_load_dwordx4 v[208:211], v26, s[32:35], s47 offen offset:0 sc1
s_mov_b32 s47, 12288
buffer_load_dwordx4 v[212:215], v26, s[32:35], s47 offen offset:1024 sc1
s_mov_b32 s47, 12288
buffer_load_dwordx4 v[216:219], v26, s[32:35], s47 offen offset:2048 sc1
s_mov_b32 s47, 12288
buffer_load_dwordx4 v[220:223], v26, s[32:35], s47 offen offset:3072 sc1
s_barrier
ds_read_b64_tr_b16 v[72:73], v24 offset:0
ds_read_b64_tr_b16 v[74:75], v25 offset:0
ds_read_b64_tr_b16 v[76:77], v24 offset:32
ds_read_b64_tr_b16 v[78:79], v25 offset:32
ds_read_b64_tr_b16 v[80:81], v24 offset:64
ds_read_b64_tr_b16 v[82:83], v25 offset:64
ds_read_b64_tr_b16 v[84:85], v24 offset:96
ds_read_b64_tr_b16 v[86:87], v25 offset:96
ds_read_b64_tr_b16 v[88:89], v24 offset:128
ds_read_b64_tr_b16 v[90:91], v25 offset:128
ds_read_b64_tr_b16 v[92:93], v24 offset:5120
ds_read_b64_tr_b16 v[94:95], v25 offset:5120
ds_read_b64_tr_b16 v[96:97], v24 offset:5152
ds_read_b64_tr_b16 v[98:99], v25 offset:5152
ds_read_b64_tr_b16 v[100:101], v24 offset:5184
ds_read_b64_tr_b16 v[102:103], v25 offset:5184
ds_read_b64_tr_b16 v[104:105], v24 offset:5216
ds_read_b64_tr_b16 v[106:107], v25 offset:5216
ds_read_b64_tr_b16 v[108:109], v24 offset:5248
ds_read_b64_tr_b16 v[110:111], v25 offset:5248
s_waitcnt lgkmcnt(10)
s_waitcnt vmcnt(15)
v_mfma_f32_16x16x32_bf16 v[48:51], v[72:75], v[160:163], 0
ds_read_b64_tr_b16 v[112:113], v24 offset:10240
ds_read_b64_tr_b16 v[114:115], v25 offset:10240
ds_read_b64_tr_b16 v[116:117], v24 offset:10272
v_mfma_f32_16x16x32_bf16 v[52:55], v[76:79], v[160:163], 0
ds_read_b64_tr_b16 v[118:119], v25 offset:10272
ds_read_b64_tr_b16 v[120:121], v24 offset:10304
v_mfma_f32_16x16x32_bf16 v[56:59], v[80:83], v[160:163], 0
ds_read_b64_tr_b16 v[122:123], v25 offset:10304
ds_read_b64_tr_b16 v[124:125], v24 offset:10336
ds_read_b64_tr_b16 v[126:127], v25 offset:10336
v_mfma_f32_16x16x32_bf16 v[60:63], v[84:87], v[160:163], 0
ds_read_b64_tr_b16 v[128:129], v24 offset:10368
ds_read_b64_tr_b16 v[130:131], v25 offset:10368
v_mfma_f32_16x16x32_bf16 v[64:67], v[88:91], v[160:163], 0
s_waitcnt lgkmcnt(10)
s_waitcnt vmcnt(14)
v_mfma_f32_16x16x32_bf16 v[48:51], v[92:95], v[164:167], v[48:51]
ds_read_b64_tr_b16 v[72:73], v24 offset:15360
ds_read_b64_tr_b16 v[74:75], v25 offset:15360
ds_read_b64_tr_b16 v[76:77], v24 offset:15392
v_mfma_f32_16x16x32_bf16 v[52:55], v[96:99], v[164:167], v[52:55]
ds_read_b64_tr_b16 v[78:79], v25 offset:15392
ds_read_b64_tr_b16 v[80:81], v24 offset:15424
v_mfma_f32_16x16x32_bf16 v[56:59], v[100:103], v[164:167], v[56:59]
ds_read_b64_tr_b16 v[82:83], v25 offset:15424
ds_read_b64_tr_b16 v[84:85], v24 offset:15456
ds_read_b64_tr_b16 v[86:87], v25 offset:15456
v_mfma_f32_16x16x32_bf16 v[60:63], v[104:107], v[164:167], v[60:63]
ds_read_b64_tr_b16 v[88:89], v24 offset:15488
ds_read_b64_tr_b16 v[90:91], v25 offset:15488
v_mfma_f32_16x16x32_bf16 v[64:67], v[108:111], v[164:167], v[64:67]
s_waitcnt lgkmcnt(0)
s_barrier
s_waitcnt vmcnt(13)
v_mfma_f32_16x16x32_bf16 v[48:51], v[112:115], v[168:171], v[48:51]
ds_read_b64_tr_b16 v[92:93], v24 offset:20480
ds_read_b64_tr_b16 v[94:95], v25 offset:20480
ds_read_b64_tr_b16 v[96:97], v24 offset:20512
v_mfma_f32_16x16x32_bf16 v[52:55], v[116:119], v[168:171], v[52:55]
ds_read_b64_tr_b16 v[98:99], v25 offset:20512
ds_read_b64_tr_b16 v[100:101], v24 offset:20544
v_mfma_f32_16x16x32_bf16 v[56:59], v[120:123], v[168:171], v[56:59]
ds_read_b64_tr_b16 v[102:103], v25 offset:20544
ds_read_b64_tr_b16 v[104:105], v24 offset:20576
ds_read_b64_tr_b16 v[106:107], v25 offset:20576
v_mfma_f32_16x16x32_bf16 v[60:63], v[124:127], v[168:171], v[60:63]
ds_read_b64_tr_b16 v[108:109], v24 offset:20608
ds_read_b64_tr_b16 v[110:111], v25 offset:20608
v_mfma_f32_16x16x32_bf16 v[64:67], v[128:131], v[168:171], v[64:67]
s_waitcnt lgkmcnt(10)
s_waitcnt vmcnt(12)
v_mfma_f32_16x16x32_bf16 v[48:51], v[72:75], v[172:175], v[48:51]
ds_read_b64_tr_b16 v[112:113], v24 offset:25600
ds_read_b64_tr_b16 v[114:115], v25 offset:25600
ds_read_b64_tr_b16 v[116:117], v24 offset:25632
v_mfma_f32_16x16x32_bf16 v[52:55], v[76:79], v[172:175], v[52:55]
ds_read_b64_tr_b16 v[118:119], v25 offset:25632
ds_read_b64_tr_b16 v[120:121], v24 offset:25664
v_mfma_f32_16x16x32_bf16 v[56:59], v[80:83], v[172:175], v[56:59]
ds_read_b64_tr_b16 v[122:123], v25 offset:25664
ds_read_b64_tr_b16 v[124:125], v24 offset:25696
ds_read_b64_tr_b16 v[126:127], v25 offset:25696
v_mfma_f32_16x16x32_bf16 v[60:63], v[84:87], v[172:175], v[60:63]
ds_read_b64_tr_b16 v[128:129], v24 offset:25728
ds_read_b64_tr_b16 v[130:131], v25 offset:25728
v_mfma_f32_16x16x32_bf16 v[64:67], v[88:91], v[172:175], v[64:67]
s_waitcnt lgkmcnt(10)
s_waitcnt vmcnt(11)
v_mfma_f32_16x16x32_bf16 v[48:51], v[92:95], v[176:179], v[48:51]
ds_read_b64_tr_b16 v[72:73], v24 offset:30720
ds_read_b64_tr_b16 v[74:75], v25 offset:30720
ds_read_b64_tr_b16 v[76:77], v24 offset:30752
ds_read_b64_tr_b16 v[78:79], v25 offset:30752
v_mfma_f32_16x16x32_bf16 v[52:55], v[96:99], v[176:179], v[52:55]
ds_read_b64_tr_b16 v[80:81], v24 offset:30784
ds_read_b64_tr_b16 v[82:83], v25 offset:30784
ds_read_b64_tr_b16 v[84:85], v24 offset:30816
v_mfma_f32_16x16x32_bf16 v[56:59], v[100:103], v[176:179], v[56:59]
ds_read_b64_tr_b16 v[86:87], v25 offset:30816
ds_read_b64_tr_b16 v[88:89], v24 offset:30848
ds_read_b64_tr_b16 v[90:91], v25 offset:30848
s_mov_b32 s47, 16384
buffer_load_dwordx4 v[160:163], v26, s[32:35], s47 offen offset:0 sc1
v_mfma_f32_16x16x32_bf16 v[60:63], v[104:107], v[176:179], v[60:63]
s_mov_b32 s47, 16384
buffer_load_dwordx4 v[164:167], v26, s[32:35], s47 offen offset:1024 sc1
s_mov_b32 s47, 16384
buffer_load_dwordx4 v[168:171], v26, s[32:35], s47 offen offset:2048 sc1
s_mov_b32 s47, 16384
buffer_load_dwordx4 v[172:175], v26, s[32:35], s47 offen offset:3072 sc1
v_mfma_f32_16x16x32_bf16 v[64:67], v[108:111], v[176:179], v[64:67]
s_waitcnt lgkmcnt(10)
s_waitcnt vmcnt(14)
v_mfma_f32_16x16x32_bf16 v[48:51], v[112:115], v[180:183], v[48:51]
ds_read_b64_tr_b16 v[92:93], v24 offset:35840
ds_read_b64_tr_b16 v[94:95], v25 offset:35840
ds_read_b64_tr_b16 v[96:97], v24 offset:35872
v_mfma_f32_16x16x32_bf16 v[52:55], v[116:119], v[180:183], v[52:55]
ds_read_b64_tr_b16 v[98:99], v25 offset:35872
ds_read_b64_tr_b16 v[100:101], v24 offset:35904
v_mfma_f32_16x16x32_bf16 v[56:59], v[120:123], v[180:183], v[56:59]
ds_read_b64_tr_b16 v[102:103], v25 offset:35904
ds_read_b64_tr_b16 v[104:105], v24 offset:35936
ds_read_b64_tr_b16 v[106:107], v25 offset:35936
v_mfma_f32_16x16x32_bf16 v[60:63], v[124:127], v[180:183], v[60:63]
ds_read_b64_tr_b16 v[108:109], v24 offset:35968
ds_read_b64_tr_b16 v[110:111], v25 offset:35968
v_mfma_f32_16x16x32_bf16 v[64:67], v[128:131], v[180:183], v[64:67]
s_waitcnt lgkmcnt(0)
s_barrier
s_waitcnt vmcnt(13)
v_mfma_f32_16x16x32_bf16 v[48:51], v[72:75], v[184:187], v[48:51]
ds_read_b64_tr_b16 v[112:113], v24 offset:40960
ds_read_b64_tr_b16 v[114:115], v25 offset:40960
ds_read_b64_tr_b16 v[116:117], v24 offset:40992
v_mfma_f32_16x16x32_bf16 v[52:55], v[76:79], v[184:187], v[52:55]
ds_read_b64_tr_b16 v[118:119], v25 offset:40992
ds_read_b64_tr_b16 v[120:121], v24 offset:41024
v_mfma_f32_16x16x32_bf16 v[56:59], v[80:83], v[184:187], v[56:59]
ds_read_b64_tr_b16 v[122:123], v25 offset:41024
ds_read_b64_tr_b16 v[124:125], v24 offset:41056
ds_read_b64_tr_b16 v[126:127], v25 offset:41056
v_mfma_f32_16x16x32_bf16 v[60:63], v[84:87], v[184:187], v[60:63]
ds_read_b64_tr_b16 v[128:129], v24 offset:41088
ds_read_b64_tr_b16 v[130:131], v25 offset:41088
v_mfma_f32_16x16x32_bf16 v[64:67], v[88:91], v[184:187], v[64:67]
s_waitcnt lgkmcnt(10)
s_waitcnt vmcnt(12)
v_mfma_f32_16x16x32_bf16 v[48:51], v[92:95], v[188:191], v[48:51]
ds_read_b64_tr_b16 v[72:73], v24 offset:46080
ds_read_b64_tr_b16 v[74:75], v25 offset:46080
ds_read_b64_tr_b16 v[76:77], v24 offset:46112
v_mfma_f32_16x16x32_bf16 v[52:55], v[96:99], v[188:191], v[52:55]
ds_read_b64_tr_b16 v[78:79], v25 offset:46112
ds_read_b64_tr_b16 v[80:81], v24 offset:46144
v_mfma_f32_16x16x32_bf16 v[56:59], v[100:103], v[188:191], v[56:59]
ds_read_b64_tr_b16 v[82:83], v25 offset:46144
ds_read_b64_tr_b16 v[84:85], v24 offset:46176
ds_read_b64_tr_b16 v[86:87], v25 offset:46176
v_mfma_f32_16x16x32_bf16 v[60:63], v[104:107], v[188:191], v[60:63]
ds_read_b64_tr_b16 v[88:89], v24 offset:46208
ds_read_b64_tr_b16 v[90:91], v25 offset:46208
v_mfma_f32_16x16x32_bf16 v[64:67], v[108:111], v[188:191], v[64:67]
s_waitcnt lgkmcnt(10)
s_waitcnt vmcnt(11)
v_mfma_f32_16x16x32_bf16 v[48:51], v[112:115], v[192:195], v[48:51]
ds_read_b64_tr_b16 v[92:93], v24 offset:51200
ds_read_b64_tr_b16 v[94:95], v25 offset:51200
ds_read_b64_tr_b16 v[96:97], v24 offset:51232
v_mfma_f32_16x16x32_bf16 v[52:55], v[116:119], v[192:195], v[52:55]
ds_read_b64_tr_b16 v[98:99], v25 offset:51232
ds_read_b64_tr_b16 v[100:101], v24 offset:51264
v_mfma_f32_16x16x32_bf16 v[56:59], v[120:123], v[192:195], v[56:59]
ds_read_b64_tr_b16 v[102:103], v25 offset:51264
ds_read_b64_tr_b16 v[104:105], v24 offset:51296
ds_read_b64_tr_b16 v[106:107], v25 offset:51296
v_mfma_f32_16x16x32_bf16 v[60:63], v[124:127], v[192:195], v[60:63]
ds_read_b64_tr_b16 v[108:109], v24 offset:51328
ds_read_b64_tr_b16 v[110:111], v25 offset:51328
v_mfma_f32_16x16x32_bf16 v[64:67], v[128:131], v[192:195], v[64:67]
s_waitcnt lgkmcnt(10)
s_waitcnt vmcnt(10)
v_mfma_f32_16x16x32_bf16 v[48:51], v[72:75], v[196:199], v[48:51]
ds_read_b64_tr_b16 v[112:113], v24 offset:56320
ds_read_b64_tr_b16 v[114:115], v25 offset:56320
ds_read_b64_tr_b16 v[116:117], v24 offset:56352
v_mfma_f32_16x16x32_bf16 v[52:55], v[76:79], v[196:199], v[52:55]
ds_read_b64_tr_b16 v[118:119], v25 offset:56352
ds_read_b64_tr_b16 v[120:121], v24 offset:56384
v_mfma_f32_16x16x32_bf16 v[56:59], v[80:83], v[196:199], v[56:59]
ds_read_b64_tr_b16 v[122:123], v25 offset:56384
ds_read_b64_tr_b16 v[124:125], v24 offset:56416
ds_read_b64_tr_b16 v[126:127], v25 offset:56416
v_mfma_f32_16x16x32_bf16 v[60:63], v[84:87], v[196:199], v[60:63]
ds_read_b64_tr_b16 v[128:129], v24 offset:56448
ds_read_b64_tr_b16 v[130:131], v25 offset:56448
v_mfma_f32_16x16x32_bf16 v[64:67], v[88:91], v[196:199], v[64:67]
s_waitcnt lgkmcnt(0)
s_barrier
s_waitcnt vmcnt(9)
v_mfma_f32_16x16x32_bf16 v[48:51], v[92:95], v[200:203], v[48:51]
ds_read_b64_tr_b16 v[72:73], v27 offset:0
ds_read_b64_tr_b16 v[74:75], v28 offset:0
ds_read_b64_tr_b16 v[76:77], v27 offset:32
v_mfma_f32_16x16x32_bf16 v[52:55], v[96:99], v[200:203], v[52:55]
ds_read_b64_tr_b16 v[78:79], v28 offset:32
ds_read_b64_tr_b16 v[80:81], v27 offset:64
v_mfma_f32_16x16x32_bf16 v[56:59], v[100:103], v[200:203], v[56:59]
ds_read_b64_tr_b16 v[82:83], v28 offset:64
ds_read_b64_tr_b16 v[84:85], v27 offset:96
ds_read_b64_tr_b16 v[86:87], v28 offset:96
v_mfma_f32_16x16x32_bf16 v[60:63], v[104:107], v[200:203], v[60:63]
ds_read_b64_tr_b16 v[88:89], v27 offset:128
ds_read_b64_tr_b16 v[90:91], v28 offset:128
v_mfma_f32_16x16x32_bf16 v[64:67], v[108:111], v[200:203], v[64:67]
s_waitcnt lgkmcnt(10)
s_waitcnt vmcnt(8)
v_mfma_f32_16x16x32_bf16 v[48:51], v[112:115], v[204:207], v[48:51]
ds_read_b64_tr_b16 v[92:93], v27 offset:5120
ds_read_b64_tr_b16 v[94:95], v28 offset:5120
ds_read_b64_tr_b16 v[96:97], v27 offset:5152
v_mfma_f32_16x16x32_bf16 v[52:55], v[116:119], v[204:207], v[52:55]
ds_read_b64_tr_b16 v[98:99], v28 offset:5152
ds_read_b64_tr_b16 v[100:101], v27 offset:5184
v_mfma_f32_16x16x32_bf16 v[56:59], v[120:123], v[204:207], v[56:59]
ds_read_b64_tr_b16 v[102:103], v28 offset:5184
ds_read_b64_tr_b16 v[104:105], v27 offset:5216
ds_read_b64_tr_b16 v[106:107], v28 offset:5216
v_mfma_f32_16x16x32_bf16 v[60:63], v[124:127], v[204:207], v[60:63]
ds_read_b64_tr_b16 v[108:109], v27 offset:5248
ds_read_b64_tr_b16 v[110:111], v28 offset:5248
v_mfma_f32_16x16x32_bf16 v[64:67], v[128:131], v[204:207], v[64:67]
s_waitcnt lgkmcnt(10)
s_waitcnt vmcnt(7)
v_mfma_f32_16x16x32_bf16 v[48:51], v[72:75], v[208:211], v[48:51]
ds_read_b64_tr_b16 v[112:113], v27 offset:10240
ds_read_b64_tr_b16 v[114:115], v28 offset:10240
ds_read_b64_tr_b16 v[116:117], v27 offset:10272
v_mfma_f32_16x16x32_bf16 v[52:55], v[76:79], v[208:211], v[52:55]
ds_read_b64_tr_b16 v[118:119], v28 offset:10272
ds_read_b64_tr_b16 v[120:121], v27 offset:10304
v_mfma_f32_16x16x32_bf16 v[56:59], v[80:83], v[208:211], v[56:59]
ds_read_b64_tr_b16 v[122:123], v28 offset:10304
ds_read_b64_tr_b16 v[124:125], v27 offset:10336
ds_read_b64_tr_b16 v[126:127], v28 offset:10336
v_mfma_f32_16x16x32_bf16 v[60:63], v[84:87], v[208:211], v[60:63]
ds_read_b64_tr_b16 v[128:129], v27 offset:10368
ds_read_b64_tr_b16 v[130:131], v28 offset:10368
v_mfma_f32_16x16x32_bf16 v[64:67], v[88:91], v[208:211], v[64:67]
s_waitcnt lgkmcnt(10)
s_waitcnt vmcnt(6)
v_mfma_f32_16x16x32_bf16 v[48:51], v[92:95], v[212:215], v[48:51]
ds_read_b64_tr_b16 v[72:73], v27 offset:15360
ds_read_b64_tr_b16 v[74:75], v28 offset:15360
ds_read_b64_tr_b16 v[76:77], v27 offset:15392
v_mfma_f32_16x16x32_bf16 v[52:55], v[96:99], v[212:215], v[52:55]
ds_read_b64_tr_b16 v[78:79], v28 offset:15392
ds_read_b64_tr_b16 v[80:81], v27 offset:15424
v_mfma_f32_16x16x32_bf16 v[56:59], v[100:103], v[212:215], v[56:59]
ds_read_b64_tr_b16 v[82:83], v28 offset:15424
ds_read_b64_tr_b16 v[84:85], v27 offset:15456
ds_read_b64_tr_b16 v[86:87], v28 offset:15456
v_mfma_f32_16x16x32_bf16 v[60:63], v[104:107], v[212:215], v[60:63]
ds_read_b64_tr_b16 v[88:89], v27 offset:15488
ds_read_b64_tr_b16 v[90:91], v28 offset:15488
v_mfma_f32_16x16x32_bf16 v[64:67], v[108:111], v[212:215], v[64:67]
s_waitcnt lgkmcnt(0)
s_barrier
s_waitcnt vmcnt(5)
v_mfma_f32_16x16x32_bf16 v[48:51], v[112:115], v[216:219], v[48:51]
ds_read_b64_tr_b16 v[92:93], v27 offset:20480
ds_read_b64_tr_b16 v[94:95], v28 offset:20480
ds_read_b64_tr_b16 v[96:97], v27 offset:20512
v_mfma_f32_16x16x32_bf16 v[52:55], v[116:119], v[216:219], v[52:55]
ds_read_b64_tr_b16 v[98:99], v28 offset:20512
ds_read_b64_tr_b16 v[100:101], v27 offset:20544
v_mfma_f32_16x16x32_bf16 v[56:59], v[120:123], v[216:219], v[56:59]
ds_read_b64_tr_b16 v[102:103], v28 offset:20544
ds_read_b64_tr_b16 v[104:105], v27 offset:20576
ds_read_b64_tr_b16 v[106:107], v28 offset:20576
v_mfma_f32_16x16x32_bf16 v[60:63], v[124:127], v[216:219], v[60:63]
ds_read_b64_tr_b16 v[108:109], v27 offset:20608
ds_read_b64_tr_b16 v[110:111], v28 offset:20608
v_mfma_f32_16x16x32_bf16 v[64:67], v[128:131], v[216:219], v[64:67]
s_waitcnt lgkmcnt(10)
s_waitcnt vmcnt(4)
v_mfma_f32_16x16x32_bf16 v[48:51], v[72:75], v[220:223], v[48:51]
ds_read_b64_tr_b16 v[112:113], v27 offset:25600
ds_read_b64_tr_b16 v[114:115], v28 offset:25600
ds_read_b64_tr_b16 v[116:117], v27 offset:25632
v_mfma_f32_16x16x32_bf16 v[52:55], v[76:79], v[220:223], v[52:55]
ds_read_b64_tr_b16 v[118:119], v28 offset:25632
ds_read_b64_tr_b16 v[120:121], v27 offset:25664
v_mfma_f32_16x16x32_bf16 v[56:59], v[80:83], v[220:223], v[56:59]
ds_read_b64_tr_b16 v[122:123], v28 offset:25664
ds_read_b64_tr_b16 v[124:125], v27 offset:25696
ds_read_b64_tr_b16 v[126:127], v28 offset:25696
v_mfma_f32_16x16x32_bf16 v[60:63], v[84:87], v[220:223], v[60:63]
ds_read_b64_tr_b16 v[128:129], v27 offset:25728
ds_read_b64_tr_b16 v[130:131], v28 offset:25728
v_mfma_f32_16x16x32_bf16 v[64:67], v[88:91], v[220:223], v[64:67]
s_waitcnt lgkmcnt(10)
s_waitcnt vmcnt(3)
v_mfma_f32_16x16x32_bf16 v[48:51], v[92:95], v[160:163], v[48:51]
ds_read_b64_tr_b16 v[72:73], v27 offset:30720
ds_read_b64_tr_b16 v[74:75], v28 offset:30720
ds_read_b64_tr_b16 v[76:77], v27 offset:30752
v_mfma_f32_16x16x32_bf16 v[52:55], v[96:99], v[160:163], v[52:55]
ds_read_b64_tr_b16 v[78:79], v28 offset:30752
ds_read_b64_tr_b16 v[80:81], v27 offset:30784
v_mfma_f32_16x16x32_bf16 v[56:59], v[100:103], v[160:163], v[56:59]
ds_read_b64_tr_b16 v[82:83], v28 offset:30784
ds_read_b64_tr_b16 v[84:85], v27 offset:30816
ds_read_b64_tr_b16 v[86:87], v28 offset:30816
v_mfma_f32_16x16x32_bf16 v[60:63], v[104:107], v[160:163], v[60:63]
ds_read_b64_tr_b16 v[88:89], v27 offset:30848
ds_read_b64_tr_b16 v[90:91], v28 offset:30848
v_mfma_f32_16x16x32_bf16 v[64:67], v[108:111], v[160:163], v[64:67]
s_waitcnt lgkmcnt(10)
s_waitcnt vmcnt(2)
v_mfma_f32_16x16x32_bf16 v[48:51], v[112:115], v[164:167], v[48:51]
ds_read_b64_tr_b16 v[92:93], v27 offset:35840
ds_read_b64_tr_b16 v[94:95], v28 offset:35840
ds_read_b64_tr_b16 v[96:97], v27 offset:35872
v_mfma_f32_16x16x32_bf16 v[52:55], v[116:119], v[164:167], v[52:55]
ds_read_b64_tr_b16 v[98:99], v28 offset:35872
ds_read_b64_tr_b16 v[100:101], v27 offset:35904
v_mfma_f32_16x16x32_bf16 v[56:59], v[120:123], v[164:167], v[56:59]
ds_read_b64_tr_b16 v[102:103], v28 offset:35904
ds_read_b64_tr_b16 v[104:105], v27 offset:35936
ds_read_b64_tr_b16 v[106:107], v28 offset:35936
v_mfma_f32_16x16x32_bf16 v[60:63], v[124:127], v[164:167], v[60:63]
ds_read_b64_tr_b16 v[108:109], v27 offset:35968
ds_read_b64_tr_b16 v[110:111], v28 offset:35968
v_mfma_f32_16x16x32_bf16 v[64:67], v[128:131], v[164:167], v[64:67]
s_waitcnt lgkmcnt(10)
s_waitcnt vmcnt(1)
v_mfma_f32_16x16x32_bf16 v[48:51], v[72:75], v[168:171], v[48:51]
v_mfma_f32_16x16x32_bf16 v[52:55], v[76:79], v[168:171], v[52:55]
v_mfma_f32_16x16x32_bf16 v[56:59], v[80:83], v[168:171], v[56:59]
v_mfma_f32_16x16x32_bf16 v[60:63], v[84:87], v[168:171], v[60:63]
v_mfma_f32_16x16x32_bf16 v[64:67], v[88:91], v[168:171], v[64:67]
s_waitcnt lgkmcnt(0)
s_waitcnt vmcnt(0)
v_mfma_f32_16x16x32_bf16 v[48:51], v[92:95], v[172:175], v[48:51]
v_mfma_f32_16x16x32_bf16 v[52:55], v[96:99], v[172:175], v[52:55]
v_mfma_f32_16x16x32_bf16 v[56:59], v[100:103], v[172:175], v[56:59]
v_mfma_f32_16x16x32_bf16 v[60:63], v[104:107], v[172:175], v[60:63]
v_mfma_f32_16x16x32_bf16 v[64:67], v[108:111], v[172:175], v[64:67]
s_barrier
s_nop 7
s_nop 7
v_cvt_pk_bf16_f32 v72, v48, v49
v_cvt_pk_bf16_f32 v73, v50, v51
v_lshlrev_b32 v74, 16, v72
v_and_b32 v75, 0xffff0000, v72
v_lshlrev_b32 v76, 16, v10
v_and_b32 v77, 0xffff0000, v10
v_add_f32 v74, v74, v76
v_add_f32 v75, v75, v77
v_cvt_pk_bf16_f32 v10, v74, v75
v_lshlrev_b32 v74, 16, v73
v_and_b32 v75, 0xffff0000, v73
v_lshlrev_b32 v76, 16, v11
v_and_b32 v77, 0xffff0000, v11
v_add_f32 v74, v74, v76
v_add_f32 v75, v75, v77
v_cvt_pk_bf16_f32 v11, v74, v75
v_cvt_pk_bf16_f32 v80, v52, v53
v_cvt_pk_bf16_f32 v81, v54, v55
v_lshlrev_b32 v82, 16, v80
v_and_b32 v83, 0xffff0000, v80
v_lshlrev_b32 v84, 16, v12
v_and_b32 v85, 0xffff0000, v12
v_add_f32 v82, v82, v84
v_add_f32 v83, v83, v85
v_cvt_pk_bf16_f32 v12, v82, v83
v_lshlrev_b32 v82, 16, v81
v_and_b32 v83, 0xffff0000, v81
v_lshlrev_b32 v84, 16, v13
v_and_b32 v85, 0xffff0000, v13
v_add_f32 v82, v82, v84
v_add_f32 v83, v83, v85
v_cvt_pk_bf16_f32 v13, v82, v83
v_cvt_pk_bf16_f32 v88, v56, v57
v_cvt_pk_bf16_f32 v89, v58, v59
v_lshlrev_b32 v90, 16, v88
v_and_b32 v91, 0xffff0000, v88
v_lshlrev_b32 v92, 16, v14
v_and_b32 v93, 0xffff0000, v14
v_add_f32 v90, v90, v92
v_add_f32 v91, v91, v93
v_cvt_pk_bf16_f32 v14, v90, v91
v_lshlrev_b32 v90, 16, v89
v_and_b32 v91, 0xffff0000, v89
v_lshlrev_b32 v92, 16, v15
v_and_b32 v93, 0xffff0000, v15
v_add_f32 v90, v90, v92
v_add_f32 v91, v91, v93
v_cvt_pk_bf16_f32 v15, v90, v91
v_cvt_pk_bf16_f32 v96, v60, v61
v_cvt_pk_bf16_f32 v97, v62, v63
v_lshlrev_b32 v98, 16, v96
v_and_b32 v99, 0xffff0000, v96
v_lshlrev_b32 v100, 16, v16
v_and_b32 v101, 0xffff0000, v16
v_add_f32 v98, v98, v100
v_add_f32 v99, v99, v101
v_cvt_pk_bf16_f32 v16, v98, v99
v_lshlrev_b32 v98, 16, v97
v_and_b32 v99, 0xffff0000, v97
v_lshlrev_b32 v100, 16, v17
v_and_b32 v101, 0xffff0000, v17
v_add_f32 v98, v98, v100
v_add_f32 v99, v99, v101
v_cvt_pk_bf16_f32 v17, v98, v99
v_cvt_pk_bf16_f32 v104, v64, v65
v_cvt_pk_bf16_f32 v105, v66, v67
v_lshlrev_b32 v106, 16, v104
v_and_b32 v107, 0xffff0000, v104
v_lshlrev_b32 v108, 16, v18
v_and_b32 v109, 0xffff0000, v18
v_add_f32 v106, v106, v108
v_add_f32 v107, v107, v109
v_cvt_pk_bf16_f32 v18, v106, v107
v_lshlrev_b32 v106, 16, v105
v_and_b32 v107, 0xffff0000, v105
v_lshlrev_b32 v108, 16, v19
v_and_b32 v109, 0xffff0000, v19
v_add_f32 v106, v106, v108
v_add_f32 v107, v107, v109
v_cvt_pk_bf16_f32 v19, v106, v107
s_cmp_eq_u32 s80, 0
s_cbranch_scc1 LB66
buffer_store_dwordx4 v[10:13], v22, s[32:35], s52 offen sc0 sc1
buffer_store_dwordx4 v[14:17], v22, s[32:35], s52 offen offset:1024 sc0 sc1
buffer_store_dwordx2 v[18:19], v23, s[32:35], s52 offen sc0 sc1
s_branch LB67
LB66:
buffer_store_dwordx4 v[10:13], v22, s[32:35], s52 offen sc0 sc1
buffer_store_dwordx4 v[14:17], v22, s[32:35], s52 offen offset:1024 sc0 sc1
buffer_store_dwordx2 v[18:19], v23, s[32:35], s52 offen sc0 sc1
LB67:
v_mov_b32 v114, 0x3f803f80
v_mov_b32 v112, 0
v_mov_b32 v113, 0
v_dot2_f32_bf16 v112, v10, v114, v112
v_dot2_f32_bf16 v113, v10, v10, v113
v_dot2_f32_bf16 v112, v11, v114, v112
v_dot2_f32_bf16 v113, v11, v11, v113
v_dot2_f32_bf16 v112, v12, v114, v112
v_dot2_f32_bf16 v113, v12, v12, v113
v_dot2_f32_bf16 v112, v13, v114, v112
v_dot2_f32_bf16 v113, v13, v13, v113
v_dot2_f32_bf16 v112, v14, v114, v112
v_dot2_f32_bf16 v113, v14, v14, v113
v_dot2_f32_bf16 v112, v15, v114, v112
v_dot2_f32_bf16 v113, v15, v15, v113
v_dot2_f32_bf16 v112, v16, v114, v112
v_dot2_f32_bf16 v113, v16, v16, v113
v_dot2_f32_bf16 v112, v17, v114, v112
v_dot2_f32_bf16 v113, v17, v17, v113
v_dot2_f32_bf16 v112, v18, v114, v112
v_dot2_f32_bf16 v113, v18, v18, v113
v_dot2_f32_bf16 v112, v19, v114, v112
v_dot2_f32_bf16 v113, v19, v19, v113
s_nop 2
v_mov_b32 v114, v112
s_nop 1
v_permlane32_swap_b32 v112, v114
s_nop 1
v_add_f32 v112, v112, v114
v_mov_b32 v114, v112
s_nop 1
v_permlane16_swap_b32 v112, v114
s_nop 1
v_add_f32 v112, v112, v114
v_mov_b32 v114, v113
s_nop 1
v_permlane32_swap_b32 v113, v114
s_nop 1
v_add_f32 v113, v113, v114
v_mov_b32 v114, v113
s_nop 1
v_permlane16_swap_b32 v113, v114
s_nop 1
v_add_f32 v113, v113, v114
s_lshr_b32 s48, s42, 3
s_lshl_b32 s48, s48, 2
s_lshl_b32 s55, s41, 3
s_add_u32 s55, s55, s48
s_add_u32 s55, s55, s40
s_lshl_b32 s55, s55, 10
s_lshr_b32 s48, s49, 1
s_lshl_b32 s48, s48, 8
s_add_u32 s55, s55, s48
s_lshl_b32 s48, s50, 3
s_add_u32 s55, s55, s48
s_add_u32 s55, s55, 27262976
s_mul_i32 s48, s43, 262144
s_add_u32 s55, s55, s48
v_lshlrev_b32 v114, 4, v1
s_mov_b64 exec, 0xffff
s_cmp_eq_u32 s80, 0
s_cbranch_scc1 LB68
buffer_store_dwordx2 v[112:113], v114, s[32:35], s55 offen sc0 sc1
s_branch LB69
LB68:
buffer_store_dwordx2 v[112:113], v114, s[32:35], s55 offen sc0 sc1
LB69:
s_mov_b64 exec, -1
s_waitcnt vmcnt(0)
s_barrier
s_cmp_lg_u32 s40, 0
s_cbranch_scc1 LB70
s_lshl_b32 s48, s43, 2
s_add_u32 s48, s48, 1
s_add_u32 s55, s44, s48
s_add_u32 s55, s55, s81
s_lshl_b32 s48, s48, 11
s_add_u32 s48, s48, s57
s_lshl_b32 s56, s42, 2
s_add_u32 s48, s48, s56
v_mov_b32 v3, s48
v_mov_b32 v4, s55
s_mov_b64 s[58:59], exec
s_mov_b64 exec, 1
s_cmp_eq_u32 s80, 0
s_cbranch_scc1 LB71
buffer_store_dword v4, v3, s[32:35], 0 offen
s_branch LB72
LB71:
buffer_store_dword v4, v3, s[32:35], 0 offen sc0 sc1
LB72:
s_mov_b64 exec, s[58:59]
LB70:
v_lshrrev_b32 v3, 2, v1
v_and_b32 v4, 3, v0
v_lshlrev_b32 v5, 2, v2
v_add_u32 v5, v5, v3
v_lshrrev_b32 v6, 2, v5
v_lshrrev_b32 v7, 3, v5
v_xor_b32 v6, v6, v7
v_and_b32 v6, 1, v6
v_lshlrev_b32 v6, 2, v6
v_and_b32 v7, 3, v5
v_or_b32 v6, v6, v7
s_lshl_b32 s48, s40, 1
v_xor_b32 v6, s48, v6
v_lshlrev_b32 v6, 5, v6
v_lshlrev_b32 v5, 8, v5
v_add_u32 v5, v5, v6
v_lshlrev_b32 v7, 3, v4
v_add_u32 v24, v5, v7
v_xor_b32 v25, 32, v24
v_xor_b32 v26, 64, v24
v_xor_b32 v27, 96, v24
v_xor_b32 v28, 128, v24
v_xor_b32 v29, 160, v24
v_xor_b32 v30, 192, v24
v_xor_b32 v31, 224, v24
v_lshlrev_b32 v5, 2, v2
v_add_u32 v5, v5, v3
v_add_u32 v5, 16, v5
v_lshrrev_b32 v6, 2, v5
v_lshrrev_b32 v7, 3, v5
v_xor_b32 v6, v6, v7
v_and_b32 v6, 1, v6
v_lshlrev_b32 v6, 2, v6
v_and_b32 v7, 3, v5
v_or_b32 v6, v6, v7
s_lshl_b32 s48, s40, 1
v_xor_b32 v6, s48, v6
v_lshlrev_b32 v6, 5, v6
v_lshlrev_b32 v5, 8, v5
v_add_u32 v5, v5, v6
v_lshlrev_b32 v7, 3, v4
v_add_u32 v32, v5, v7
v_xor_b32 v33, 32, v32
v_xor_b32 v34, 64, v32
v_xor_b32 v35, 96, v32
v_xor_b32 v36, 128, v32
v_xor_b32 v37, 160, v32
v_xor_b32 v38, 192, v32
v_xor_b32 v39, 224, v32
s_lshl_b32 s64, s41, 3
s_lshl_b32 s48, s40, 1
s_add_u32 s64, s64, s48
s_mul_i32 s64, s64, 20480
s_add_u32 s64, s64, s52
v_lshlrev_b32 v3, 4, v0
v_add_u32 v45, s64, v3
v_add_u32 v46, 20480, v45
s_cmp_lg_u32 s40, 0
s_cbranch_scc1 LB73
s_lshl_b32 s48, s43, 2
s_add_u32 s48, s48, 1
s_add_u32 s55, s44, s48
s_lshl_b32 s48, s48, 11
s_add_u32 s48, s48, s57
v_lshlrev_b32 v3, 2, v1
v_add_u32 v3, s48, v3
s_mov_b32 s56, 0
LB74:
buffer_load_dword v4, v3, s[32:35], 0 offen sc0 sc1
s_waitcnt vmcnt(0)
v_and_b32 v6, 0xffffff87, v4
v_cmp_ne_u32 vcc, s55, v6
s_cbranch_vccz LB73
s_add_u32 s56, s56, 1
s_cmp_lt_u32 s56, 20000
s_cbranch_scc1 LB74
LB73:
s_barrier
v_mov_b32 v4, 0x3f803f80
v_mov_b32 v5, 0x3f803f80
v_mov_b32 v6, 0x3f803f80
v_mov_b32 v7, 0x3f803f80
s_mov_b32 s47, 0
buffer_load_dwordx4 v[184:187], v45, s[32:35], s47 offen offset:0 sc1
s_mov_b32 s47, 0
buffer_load_dwordx4 v[188:191], v46, s[32:35], s47 offen offset:0 sc1
s_mov_b32 s47, 0
buffer_load_dwordx4 v[192:195], v45, s[32:35], s47 offen offset:1024 sc1
s_mov_b32 s47, 0
buffer_load_dwordx4 v[196:199], v46, s[32:35], s47 offen offset:1024 sc1
s_mov_b32 s47, 0
buffer_load_dwordx4 v[200:203], v45, s[32:35], s47 offen offset:2048 sc1
s_mov_b32 s47, 0
buffer_load_dwordx4 v[204:207], v46, s[32:35], s47 offen offset:2048 sc1
s_mov_b32 s47, 0
buffer_load_dwordx4 v[208:211], v45, s[32:35], s47 offen offset:3072 sc1
s_mov_b32 s47, 0
buffer_load_dwordx4 v[212:215], v46, s[32:35], s47 offen offset:3072 sc1
s_mov_b32 s47, 4096
buffer_load_dwordx4 v[216:219], v45, s[32:35], s47 offen offset:0 sc1
s_mov_b32 s47, 4096
buffer_load_dwordx4 v[220:223], v46, s[32:35], s47 offen offset:0 sc1
s_mov_b32 s47, 4096
buffer_load_dwordx4 v[224:227], v45, s[32:35], s47 offen offset:1024 sc1
s_mov_b32 s47, 4096
buffer_load_dwordx4 v[228:231], v46, s[32:35], s47 offen offset:1024 sc1
s_mov_b32 s47, 4096
buffer_load_dwordx4 v[232:235], v45, s[32:35], s47 offen offset:2048 sc1
s_mov_b32 s47, 4096
buffer_load_dwordx4 v[236:239], v46, s[32:35], s47 offen offset:2048 sc1
s_mov_b32 s47, 4096
buffer_load_dwordx4 v[240:243], v45, s[32:35], s47 offen offset:3072 sc1
s_mov_b32 s47, 4096
buffer_load_dwordx4 v[244:247], v46, s[32:35], s47 offen offset:3072 sc1
s_lshl_b32 s48, s41, 3
s_lshl_b32 s55, s40, 1
s_add_u32 s55, s55, s48
s_lshl_b32 s55, s55, 10
s_mul_i32 s56, s43, 0x40000
s_add_u32 s55, s55, s56
s_add_u32 s55, s55, 27262976
v_lshlrev_b32 v3, 4, v0
buffer_load_dwordx4 a[0:3], v3, s[32:35], s55 offen offset:0 sc1
buffer_load_dwordx4 a[4:7], v3, s[32:35], s55 offen offset:1024 sc1
LB76:
s_barrier
ds_read_b64_tr_b16 v[120:121], v24 offset:0
ds_read_b64_tr_b16 v[122:123], v32 offset:0
ds_read_b64_tr_b16 v[124:125], v25 offset:0
ds_read_b64_tr_b16 v[126:127], v33 offset:0
ds_read_b64_tr_b16 v[128:129], v26 offset:0
ds_read_b64_tr_b16 v[130:131], v34 offset:0
ds_read_b64_tr_b16 v[132:133], v27 offset:0
ds_read_b64_tr_b16 v[134:135], v35 offset:0
ds_read_b64_tr_b16 v[136:137], v28 offset:0
ds_read_b64_tr_b16 v[138:139], v36 offset:0
ds_read_b64_tr_b16 v[140:141], v29 offset:0
ds_read_b64_tr_b16 v[142:143], v37 offset:0
ds_read_b64_tr_b16 v[144:145], v30 offset:0
ds_read_b64_tr_b16 v[146:147], v38 offset:0
ds_read_b64_tr_b16 v[148:149], v31 offset:0
ds_read_b64_tr_b16 v[150:151], v39 offset:0
s_waitcnt lgkmcnt(0)
s_waitcnt vmcnt(14)
v_mfma_f32_16x16x32_bf16 v[48:51], v[120:123], v[184:187], 0
ds_read_b64_tr_b16 v[152:153], v24 offset:8192
ds_read_b64_tr_b16 v[154:155], v32 offset:8192
v_mfma_f32_16x16x32_bf16 v[80:83], v[120:123], v[188:191], 0
ds_read_b64_tr_b16 v[156:157], v25 offset:8192
v_mfma_f32_16x16x32_bf16 v[52:55], v[124:127], v[184:187], 0
ds_read_b64_tr_b16 v[158:159], v33 offset:8192
v_mfma_f32_16x16x32_bf16 v[84:87], v[124:127], v[188:191], 0
ds_read_b64_tr_b16 v[160:161], v26 offset:8192
v_mfma_f32_16x16x32_bf16 v[56:59], v[128:131], v[184:187], 0
ds_read_b64_tr_b16 v[162:163], v34 offset:8192
ds_read_b64_tr_b16 v[164:165], v27 offset:8192
v_mfma_f32_16x16x32_bf16 v[88:91], v[128:131], v[188:191], 0
ds_read_b64_tr_b16 v[166:167], v35 offset:8192
v_mfma_f32_16x16x32_bf16 v[60:63], v[132:135], v[184:187], 0
ds_read_b64_tr_b16 v[168:169], v28 offset:8192
v_mfma_f32_16x16x32_bf16 v[92:95], v[132:135], v[188:191], 0
ds_read_b64_tr_b16 v[170:171], v36 offset:8192
v_mfma_f32_16x16x32_bf16 v[64:67], v[136:139], v[184:187], 0
ds_read_b64_tr_b16 v[172:173], v29 offset:8192
ds_read_b64_tr_b16 v[174:175], v37 offset:8192
v_mfma_f32_16x16x32_bf16 v[96:99], v[136:139], v[188:191], 0
ds_read_b64_tr_b16 v[176:177], v30 offset:8192
v_mfma_f32_16x16x32_bf16 v[68:71], v[140:143], v[184:187], 0
ds_read_b64_tr_b16 v[178:179], v38 offset:8192
v_mfma_f32_16x16x32_bf16 v[100:103], v[140:143], v[188:191], 0
ds_read_b64_tr_b16 v[180:181], v31 offset:8192
v_mfma_f32_16x16x32_bf16 v[72:75], v[144:147], v[184:187], 0
ds_read_b64_tr_b16 v[182:183], v39 offset:8192
v_mfma_f32_16x16x32_bf16 v[104:107], v[144:147], v[188:191], 0
v_mfma_f32_16x16x32_bf16 v[76:79], v[148:151], v[184:187], 0
v_mfma_f32_16x16x32_bf16 v[108:111], v[148:151], v[188:191], 0
s_cmp_eq_u32 s43, 0
s_cbranch_scc0 LB77
v_mfma_f32_16x16x32_bf16 v[112:115], v[120:123], v[4:7], 0
v_mfma_f32_16x16x32_bf16 v[116:119], v[124:127], v[4:7], 0
LB77:
s_waitcnt lgkmcnt(0)
s_barrier
s_waitcnt vmcnt(12)
v_mfma_f32_16x16x32_bf16 v[48:51], v[152:155], v[192:195], v[48:51]
ds_read_b64_tr_b16 v[120:121], v24 offset:16384
ds_read_b64_tr_b16 v[122:123], v32 offset:16384
v_mfma_f32_16x16x32_bf16 v[80:83], v[152:155], v[196:199], v[80:83]
ds_read_b64_tr_b16 v[124:125], v25 offset:16384
v_mfma_f32_16x16x32_bf16 v[52:55], v[156:159], v[192:195], v[52:55]
ds_read_b64_tr_b16 v[126:127], v33 offset:16384
v_mfma_f32_16x16x32_bf16 v[84:87], v[156:159], v[196:199], v[84:87]
ds_read_b64_tr_b16 v[128:129], v26 offset:16384
v_mfma_f32_16x16x32_bf16 v[56:59], v[160:163], v[192:195], v[56:59]
ds_read_b64_tr_b16 v[130:131], v34 offset:16384
ds_read_b64_tr_b16 v[132:133], v27 offset:16384
v_mfma_f32_16x16x32_bf16 v[88:91], v[160:163], v[196:199], v[88:91]
ds_read_b64_tr_b16 v[134:135], v35 offset:16384
v_mfma_f32_16x16x32_bf16 v[60:63], v[164:167], v[192:195], v[60:63]
ds_read_b64_tr_b16 v[136:137], v28 offset:16384
v_mfma_f32_16x16x32_bf16 v[92:95], v[164:167], v[196:199], v[92:95]
ds_read_b64_tr_b16 v[138:139], v36 offset:16384
v_mfma_f32_16x16x32_bf16 v[64:67], v[168:171], v[192:195], v[64:67]
ds_read_b64_tr_b16 v[140:141], v29 offset:16384
ds_read_b64_tr_b16 v[142:143], v37 offset:16384
v_mfma_f32_16x16x32_bf16 v[96:99], v[168:171], v[196:199], v[96:99]
ds_read_b64_tr_b16 v[144:145], v30 offset:16384
v_mfma_f32_16x16x32_bf16 v[68:71], v[172:175], v[192:195], v[68:71]
ds_read_b64_tr_b16 v[146:147], v38 offset:16384
v_mfma_f32_16x16x32_bf16 v[100:103], v[172:175], v[196:199], v[100:103]
ds_read_b64_tr_b16 v[148:149], v31 offset:16384
v_mfma_f32_16x16x32_bf16 v[72:75], v[176:179], v[192:195], v[72:75]
ds_read_b64_tr_b16 v[150:151], v39 offset:16384
v_mfma_f32_16x16x32_bf16 v[104:107], v[176:179], v[196:199], v[104:107]
v_mfma_f32_16x16x32_bf16 v[76:79], v[180:183], v[192:195], v[76:79]
v_mfma_f32_16x16x32_bf16 v[108:111], v[180:183], v[196:199], v[108:111]
s_cmp_eq_u32 s43, 0
s_cbranch_scc0 LB78
v_mfma_f32_16x16x32_bf16 v[112:115], v[152:155], v[4:7], v[112:115]
v_mfma_f32_16x16x32_bf16 v[116:119], v[156:159], v[4:7], v[116:119]
LB78:
s_waitcnt lgkmcnt(0)
s_waitcnt vmcnt(10)
v_mfma_f32_16x16x32_bf16 v[48:51], v[120:123], v[200:203], v[48:51]
ds_read_b64_tr_b16 v[152:153], v24 offset:24576
ds_read_b64_tr_b16 v[154:155], v32 offset:24576
v_mfma_f32_16x16x32_bf16 v[80:83], v[120:123], v[204:207], v[80:83]
ds_read_b64_tr_b16 v[156:157], v25 offset:24576
ds_read_b64_tr_b16 v[158:159], v33 offset:24576
v_mfma_f32_16x16x32_bf16 v[52:55], v[124:127], v[200:203], v[52:55]
ds_read_b64_tr_b16 v[160:161], v26 offset:24576
v_mfma_f32_16x16x32_bf16 v[84:87], v[124:127], v[204:207], v[84:87]
ds_read_b64_tr_b16 v[162:163], v34 offset:24576
ds_read_b64_tr_b16 v[164:165], v27 offset:24576
v_mfma_f32_16x16x32_bf16 v[56:59], v[128:131], v[200:203], v[56:59]
ds_read_b64_tr_b16 v[166:167], v35 offset:24576
v_mfma_f32_16x16x32_bf16 v[88:91], v[128:131], v[204:207], v[88:91]
ds_read_b64_tr_b16 v[168:169], v28 offset:24576
ds_read_b64_tr_b16 v[170:171], v36 offset:24576
v_mfma_f32_16x16x32_bf16 v[60:63], v[132:135], v[200:203], v[60:63]
ds_read_b64_tr_b16 v[172:173], v29 offset:24576
v_mfma_f32_16x16x32_bf16 v[92:95], v[132:135], v[204:207], v[92:95]
ds_read_b64_tr_b16 v[174:175], v37 offset:24576
ds_read_b64_tr_b16 v[176:177], v30 offset:24576
v_mfma_f32_16x16x32_bf16 v[64:67], v[136:139], v[200:203], v[64:67]
ds_read_b64_tr_b16 v[178:179], v38 offset:24576
ds_read_b64_tr_b16 v[180:181], v31 offset:24576
v_mfma_f32_16x16x32_bf16 v[96:99], v[136:139], v[204:207], v[96:99]
ds_read_b64_tr_b16 v[182:183], v39 offset:24576
v_mfma_f32_16x16x32_bf16 v[68:71], v[140:143], v[200:203], v[68:71]
s_mov_b32 s47, 8192
buffer_load_dwordx4 v[184:187], v45, s[32:35], s47 offen offset:0 sc1
s_mov_b32 s47, 8192
buffer_load_dwordx4 v[188:191], v46, s[32:35], s47 offen offset:0 sc1
v_mfma_f32_16x16x32_bf16 v[100:103], v[140:143], v[204:207], v[100:103]
s_mov_b32 s47, 8192
buffer_load_dwordx4 v[192:195], v45, s[32:35], s47 offen offset:1024 sc1
v_mfma_f32_16x16x32_bf16 v[72:75], v[144:147], v[200:203], v[72:75]
s_mov_b32 s47, 8192
buffer_load_dwordx4 v[196:199], v46, s[32:35], s47 offen offset:1024 sc1
v_mfma_f32_16x16x32_bf16 v[104:107], v[144:147], v[204:207], v[104:107]
v_mfma_f32_16x16x32_bf16 v[76:79], v[148:151], v[200:203], v[76:79]
v_mfma_f32_16x16x32_bf16 v[108:111], v[148:151], v[204:207], v[108:111]
s_cmp_eq_u32 s43, 0
s_cbranch_scc0 LB79
v_mfma_f32_16x16x32_bf16 v[112:115], v[120:123], v[4:7], v[112:115]
v_mfma_f32_16x16x32_bf16 v[116:119], v[124:127], v[4:7], v[116:119]
LB79:
s_waitcnt lgkmcnt(0)
s_barrier
s_waitcnt vmcnt(12)
v_mfma_f32_16x16x32_bf16 v[48:51], v[152:155], v[208:211], v[48:51]
ds_read_b64_tr_b16 v[120:121], v24 offset:32768
ds_read_b64_tr_b16 v[122:123], v32 offset:32768
v_mfma_f32_16x16x32_bf16 v[80:83], v[152:155], v[212:215], v[80:83]
ds_read_b64_tr_b16 v[124:125], v25 offset:32768
v_mfma_f32_16x16x32_bf16 v[52:55], v[156:159], v[208:211], v[52:55]
ds_read_b64_tr_b16 v[126:127], v33 offset:32768
v_mfma_f32_16x16x32_bf16 v[84:87], v[156:159], v[212:215], v[84:87]
ds_read_b64_tr_b16 v[128:129], v26 offset:32768
v_mfma_f32_16x16x32_bf16 v[56:59], v[160:163], v[208:211], v[56:59]
ds_read_b64_tr_b16 v[130:131], v34 offset:32768
ds_read_b64_tr_b16 v[132:133], v27 offset:32768
v_mfma_f32_16x16x32_bf16 v[88:91], v[160:163], v[212:215], v[88:91]
ds_read_b64_tr_b16 v[134:135], v35 offset:32768
v_mfma_f32_16x16x32_bf16 v[60:63], v[164:167], v[208:211], v[60:63]
ds_read_b64_tr_b16 v[136:137], v28 offset:32768
v_mfma_f32_16x16x32_bf16 v[92:95], v[164:167], v[212:215], v[92:95]
ds_read_b64_tr_b16 v[138:139], v36 offset:32768
v_mfma_f32_16x16x32_bf16 v[64:67], v[168:171], v[208:211], v[64:67]
ds_read_b64_tr_b16 v[140:141], v29 offset:32768
ds_read_b64_tr_b16 v[142:143], v37 offset:32768
v_mfma_f32_16x16x32_bf16 v[96:99], v[168:171], v[212:215], v[96:99]
ds_read_b64_tr_b16 v[144:145], v30 offset:32768
v_mfma_f32_16x16x32_bf16 v[68:71], v[172:175], v[208:211], v[68:71]
ds_read_b64_tr_b16 v[146:147], v38 offset:32768
v_mfma_f32_16x16x32_bf16 v[100:103], v[172:175], v[212:215], v[100:103]
ds_read_b64_tr_b16 v[148:149], v31 offset:32768
v_mfma_f32_16x16x32_bf16 v[72:75], v[176:179], v[208:211], v[72:75]
ds_read_b64_tr_b16 v[150:151], v39 offset:32768
v_mfma_f32_16x16x32_bf16 v[104:107], v[176:179], v[212:215], v[104:107]
v_mfma_f32_16x16x32_bf16 v[76:79], v[180:183], v[208:211], v[76:79]
v_mfma_f32_16x16x32_bf16 v[108:111], v[180:183], v[212:215], v[108:111]
s_cmp_eq_u32 s43, 0
s_cbranch_scc0 LB80
v_mfma_f32_16x16x32_bf16 v[112:115], v[152:155], v[4:7], v[112:115]
v_mfma_f32_16x16x32_bf16 v[116:119], v[156:159], v[4:7], v[116:119]
LB80:
s_waitcnt lgkmcnt(0)
s_waitcnt vmcnt(10)
v_mfma_f32_16x16x32_bf16 v[48:51], v[120:123], v[216:219], v[48:51]
ds_read_b64_tr_b16 v[152:153], v24 offset:40960
ds_read_b64_tr_b16 v[154:155], v32 offset:40960
v_mfma_f32_16x16x32_bf16 v[80:83], v[120:123], v[220:223], v[80:83]
ds_read_b64_tr_b16 v[156:157], v25 offset:40960
ds_read_b64_tr_b16 v[158:159], v33 offset:40960
v_mfma_f32_16x16x32_bf16 v[52:55], v[124:127], v[216:219], v[52:55]
ds_read_b64_tr_b16 v[160:161], v26 offset:40960
v_mfma_f32_16x16x32_bf16 v[84:87], v[124:127], v[220:223], v[84:87]
ds_read_b64_tr_b16 v[162:163], v34 offset:40960
ds_read_b64_tr_b16 v[164:165], v27 offset:40960
v_mfma_f32_16x16x32_bf16 v[56:59], v[128:131], v[216:219], v[56:59]
ds_read_b64_tr_b16 v[166:167], v35 offset:40960
v_mfma_f32_16x16x32_bf16 v[88:91], v[128:131], v[220:223], v[88:91]
ds_read_b64_tr_b16 v[168:169], v28 offset:40960
ds_read_b64_tr_b16 v[170:171], v36 offset:40960
v_mfma_f32_16x16x32_bf16 v[60:63], v[132:135], v[216:219], v[60:63]
ds_read_b64_tr_b16 v[172:173], v29 offset:40960
v_mfma_f32_16x16x32_bf16 v[92:95], v[132:135], v[220:223], v[92:95]
ds_read_b64_tr_b16 v[174:175], v37 offset:40960
ds_read_b64_tr_b16 v[176:177], v30 offset:40960
v_mfma_f32_16x16x32_bf16 v[64:67], v[136:139], v[216:219], v[64:67]
ds_read_b64_tr_b16 v[178:179], v38 offset:40960
ds_read_b64_tr_b16 v[180:181], v31 offset:40960
v_mfma_f32_16x16x32_bf16 v[96:99], v[136:139], v[220:223], v[96:99]
ds_read_b64_tr_b16 v[182:183], v39 offset:40960
v_mfma_f32_16x16x32_bf16 v[68:71], v[140:143], v[216:219], v[68:71]
s_mov_b32 s47, 8192
buffer_load_dwordx4 v[200:203], v45, s[32:35], s47 offen offset:2048 sc1
s_mov_b32 s47, 8192
buffer_load_dwordx4 v[204:207], v46, s[32:35], s47 offen offset:2048 sc1
v_mfma_f32_16x16x32_bf16 v[100:103], v[140:143], v[220:223], v[100:103]
s_mov_b32 s47, 8192
buffer_load_dwordx4 v[208:211], v45, s[32:35], s47 offen offset:3072 sc1
v_mfma_f32_16x16x32_bf16 v[72:75], v[144:147], v[216:219], v[72:75]
s_mov_b32 s47, 8192
buffer_load_dwordx4 v[212:215], v46, s[32:35], s47 offen offset:3072 sc1
v_mfma_f32_16x16x32_bf16 v[104:107], v[144:147], v[220:223], v[104:107]
v_mfma_f32_16x16x32_bf16 v[76:79], v[148:151], v[216:219], v[76:79]
v_mfma_f32_16x16x32_bf16 v[108:111], v[148:151], v[220:223], v[108:111]
s_cmp_eq_u32 s43, 0
s_cbranch_scc0 LB81
v_mfma_f32_16x16x32_bf16 v[112:115], v[120:123], v[4:7], v[112:115]
v_mfma_f32_16x16x32_bf16 v[116:119], v[124:127], v[4:7], v[116:119]
LB81:
s_waitcnt lgkmcnt(0)
s_barrier
s_waitcnt vmcnt(12)
v_mfma_f32_16x16x32_bf16 v[48:51], v[152:155], v[224:227], v[48:51]
ds_read_b64_tr_b16 v[120:121], v24 offset:49152
ds_read_b64_tr_b16 v[122:123], v32 offset:49152
v_mfma_f32_16x16x32_bf16 v[80:83], v[152:155], v[228:231], v[80:83]
ds_read_b64_tr_b16 v[124:125], v25 offset:49152
v_mfma_f32_16x16x32_bf16 v[52:55], v[156:159], v[224:227], v[52:55]
ds_read_b64_tr_b16 v[126:127], v33 offset:49152
v_mfma_f32_16x16x32_bf16 v[84:87], v[156:159], v[228:231], v[84:87]
ds_read_b64_tr_b16 v[128:129], v26 offset:49152
v_mfma_f32_16x16x32_bf16 v[56:59], v[160:163], v[224:227], v[56:59]
ds_read_b64_tr_b16 v[130:131], v34 offset:49152
ds_read_b64_tr_b16 v[132:133], v27 offset:49152
v_mfma_f32_16x16x32_bf16 v[88:91], v[160:163], v[228:231], v[88:91]
ds_read_b64_tr_b16 v[134:135], v35 offset:49152
v_mfma_f32_16x16x32_bf16 v[60:63], v[164:167], v[224:227], v[60:63]
ds_read_b64_tr_b16 v[136:137], v28 offset:49152
v_mfma_f32_16x16x32_bf16 v[92:95], v[164:167], v[228:231], v[92:95]
ds_read_b64_tr_b16 v[138:139], v36 offset:49152
v_mfma_f32_16x16x32_bf16 v[64:67], v[168:171], v[224:227], v[64:67]
ds_read_b64_tr_b16 v[140:141], v29 offset:49152
ds_read_b64_tr_b16 v[142:143], v37 offset:49152
v_mfma_f32_16x16x32_bf16 v[96:99], v[168:171], v[228:231], v[96:99]
ds_read_b64_tr_b16 v[144:145], v30 offset:49152
v_mfma_f32_16x16x32_bf16 v[68:71], v[172:175], v[224:227], v[68:71]
ds_read_b64_tr_b16 v[146:147], v38 offset:49152
v_mfma_f32_16x16x32_bf16 v[100:103], v[172:175], v[228:231], v[100:103]
ds_read_b64_tr_b16 v[148:149], v31 offset:49152
v_mfma_f32_16x16x32_bf16 v[72:75], v[176:179], v[224:227], v[72:75]
ds_read_b64_tr_b16 v[150:151], v39 offset:49152
v_mfma_f32_16x16x32_bf16 v[104:107], v[176:179], v[228:231], v[104:107]
v_mfma_f32_16x16x32_bf16 v[76:79], v[180:183], v[224:227], v[76:79]
v_mfma_f32_16x16x32_bf16 v[108:111], v[180:183], v[228:231], v[108:111]
s_cmp_eq_u32 s43, 0
s_cbranch_scc0 LB82
v_mfma_f32_16x16x32_bf16 v[112:115], v[152:155], v[4:7], v[112:115]
v_mfma_f32_16x16x32_bf16 v[116:119], v[156:159], v[4:7], v[116:119]
LB82:
s_waitcnt lgkmcnt(0)
s_waitcnt vmcnt(10)
v_mfma_f32_16x16x32_bf16 v[48:51], v[120:123], v[232:235], v[48:51]
ds_read_b64_tr_b16 v[152:153], v24 offset:57344
ds_read_b64_tr_b16 v[154:155], v32 offset:57344
v_mfma_f32_16x16x32_bf16 v[80:83], v[120:123], v[236:239], v[80:83]
ds_read_b64_tr_b16 v[156:157], v25 offset:57344
ds_read_b64_tr_b16 v[158:159], v33 offset:57344
v_mfma_f32_16x16x32_bf16 v[52:55], v[124:127], v[232:235], v[52:55]
ds_read_b64_tr_b16 v[160:161], v26 offset:57344
v_mfma_f32_16x16x32_bf16 v[84:87], v[124:127], v[236:239], v[84:87]
ds_read_b64_tr_b16 v[162:163], v34 offset:57344
ds_read_b64_tr_b16 v[164:165], v27 offset:57344
v_mfma_f32_16x16x32_bf16 v[56:59], v[128:131], v[232:235], v[56:59]
ds_read_b64_tr_b16 v[166:167], v35 offset:57344
v_mfma_f32_16x16x32_bf16 v[88:91], v[128:131], v[236:239], v[88:91]
ds_read_b64_tr_b16 v[168:169], v28 offset:57344
ds_read_b64_tr_b16 v[170:171], v36 offset:57344
v_mfma_f32_16x16x32_bf16 v[60:63], v[132:135], v[232:235], v[60:63]
ds_read_b64_tr_b16 v[172:173], v29 offset:57344
v_mfma_f32_16x16x32_bf16 v[92:95], v[132:135], v[236:239], v[92:95]
ds_read_b64_tr_b16 v[174:175], v37 offset:57344
ds_read_b64_tr_b16 v[176:177], v30 offset:57344
v_mfma_f32_16x16x32_bf16 v[64:67], v[136:139], v[232:235], v[64:67]
ds_read_b64_tr_b16 v[178:179], v38 offset:57344
ds_read_b64_tr_b16 v[180:181], v31 offset:57344
v_mfma_f32_16x16x32_bf16 v[96:99], v[136:139], v[236:239], v[96:99]
ds_read_b64_tr_b16 v[182:183], v39 offset:57344
v_mfma_f32_16x16x32_bf16 v[68:71], v[140:143], v[232:235], v[68:71]
s_mov_b32 s47, 12288
buffer_load_dwordx4 v[216:219], v45, s[32:35], s47 offen offset:0 sc1
s_mov_b32 s47, 12288
buffer_load_dwordx4 v[220:223], v46, s[32:35], s47 offen offset:0 sc1
v_mfma_f32_16x16x32_bf16 v[100:103], v[140:143], v[236:239], v[100:103]
s_mov_b32 s47, 12288
buffer_load_dwordx4 v[224:227], v45, s[32:35], s47 offen offset:1024 sc1
v_mfma_f32_16x16x32_bf16 v[72:75], v[144:147], v[232:235], v[72:75]
s_mov_b32 s47, 12288
buffer_load_dwordx4 v[228:231], v46, s[32:35], s47 offen offset:1024 sc1
v_mfma_f32_16x16x32_bf16 v[104:107], v[144:147], v[236:239], v[104:107]
v_mfma_f32_16x16x32_bf16 v[76:79], v[148:151], v[232:235], v[76:79]
v_mfma_f32_16x16x32_bf16 v[108:111], v[148:151], v[236:239], v[108:111]
s_cmp_eq_u32 s43, 0
s_cbranch_scc0 LB83
v_mfma_f32_16x16x32_bf16 v[112:115], v[120:123], v[4:7], v[112:115]
v_mfma_f32_16x16x32_bf16 v[116:119], v[124:127], v[4:7], v[116:119]
LB83:
s_waitcnt lgkmcnt(0)
s_barrier
s_waitcnt vmcnt(12)
v_mfma_f32_16x16x32_bf16 v[48:51], v[152:155], v[240:243], v[48:51]
ds_read_b64_tr_b16 v[120:121], v24 offset:0
ds_read_b64_tr_b16 v[122:123], v32 offset:0
v_mfma_f32_16x16x32_bf16 v[80:83], v[152:155], v[244:247], v[80:83]
ds_read_b64_tr_b16 v[124:125], v25 offset:0
v_mfma_f32_16x16x32_bf16 v[52:55], v[156:159], v[240:243], v[52:55]
ds_read_b64_tr_b16 v[126:127], v33 offset:0
v_mfma_f32_16x16x32_bf16 v[84:87], v[156:159], v[244:247], v[84:87]
ds_read_b64_tr_b16 v[128:129], v26 offset:0
v_mfma_f32_16x16x32_bf16 v[56:59], v[160:163], v[240:243], v[56:59]
ds_read_b64_tr_b16 v[130:131], v34 offset:0
ds_read_b64_tr_b16 v[132:133], v27 offset:0
v_mfma_f32_16x16x32_bf16 v[88:91], v[160:163], v[244:247], v[88:91]
ds_read_b64_tr_b16 v[134:135], v35 offset:0
v_mfma_f32_16x16x32_bf16 v[60:63], v[164:167], v[240:243], v[60:63]
ds_read_b64_tr_b16 v[136:137], v28 offset:0
v_mfma_f32_16x16x32_bf16 v[92:95], v[164:167], v[244:247], v[92:95]
ds_read_b64_tr_b16 v[138:139], v36 offset:0
v_mfma_f32_16x16x32_bf16 v[64:67], v[168:171], v[240:243], v[64:67]
ds_read_b64_tr_b16 v[140:141], v29 offset:0
ds_read_b64_tr_b16 v[142:143], v37 offset:0
v_mfma_f32_16x16x32_bf16 v[96:99], v[168:171], v[244:247], v[96:99]
ds_read_b64_tr_b16 v[144:145], v30 offset:0
v_mfma_f32_16x16x32_bf16 v[68:71], v[172:175], v[240:243], v[68:71]
ds_read_b64_tr_b16 v[146:147], v38 offset:0
v_mfma_f32_16x16x32_bf16 v[100:103], v[172:175], v[244:247], v[100:103]
ds_read_b64_tr_b16 v[148:149], v31 offset:0
v_mfma_f32_16x16x32_bf16 v[72:75], v[176:179], v[240:243], v[72:75]
ds_read_b64_tr_b16 v[150:151], v39 offset:0
v_mfma_f32_16x16x32_bf16 v[104:107], v[176:179], v[244:247], v[104:107]
v_mfma_f32_16x16x32_bf16 v[76:79], v[180:183], v[240:243], v[76:79]
v_mfma_f32_16x16x32_bf16 v[108:111], v[180:183], v[244:247], v[108:111]
s_cmp_eq_u32 s43, 0
s_cbranch_scc0 LB84
v_mfma_f32_16x16x32_bf16 v[112:115], v[152:155], v[4:7], v[112:115]
v_mfma_f32_16x16x32_bf16 v[116:119], v[156:159], v[4:7], v[116:119]
LB84:
s_waitcnt lgkmcnt(0)
s_waitcnt vmcnt(10)
v_mfma_f32_16x16x32_bf16 v[48:51], v[120:123], v[184:187], v[48:51]
ds_read_b64_tr_b16 v[152:153], v24 offset:8192
ds_read_b64_tr_b16 v[154:155], v32 offset:8192
v_mfma_f32_16x16x32_bf16 v[80:83], v[120:123], v[188:191], v[80:83]
ds_read_b64_tr_b16 v[156:157], v25 offset:8192
ds_read_b64_tr_b16 v[158:159], v33 offset:8192
v_mfma_f32_16x16x32_bf16 v[52:55], v[124:127], v[184:187], v[52:55]
ds_read_b64_tr_b16 v[160:161], v26 offset:8192
v_mfma_f32_16x16x32_bf16 v[84:87], v[124:127], v[188:191], v[84:87]
ds_read_b64_tr_b16 v[162:163], v34 offset:8192
ds_read_b64_tr_b16 v[164:165], v27 offset:8192
v_mfma_f32_16x16x32_bf16 v[56:59], v[128:131], v[184:187], v[56:59]
ds_read_b64_tr_b16 v[166:167], v35 offset:8192
v_mfma_f32_16x16x32_bf16 v[88:91], v[128:131], v[188:191], v[88:91]
ds_read_b64_tr_b16 v[168:169], v28 offset:8192
ds_read_b64_tr_b16 v[170:171], v36 offset:8192
v_mfma_f32_16x16x32_bf16 v[60:63], v[132:135], v[184:187], v[60:63]
ds_read_b64_tr_b16 v[172:173], v29 offset:8192
v_mfma_f32_16x16x32_bf16 v[92:95], v[132:135], v[188:191], v[92:95]
ds_read_b64_tr_b16 v[174:175], v37 offset:8192
ds_read_b64_tr_b16 v[176:177], v30 offset:8192
v_mfma_f32_16x16x32_bf16 v[64:67], v[136:139], v[184:187], v[64:67]
ds_read_b64_tr_b16 v[178:179], v38 offset:8192
ds_read_b64_tr_b16 v[180:181], v31 offset:8192
v_mfma_f32_16x16x32_bf16 v[96:99], v[136:139], v[188:191], v[96:99]
ds_read_b64_tr_b16 v[182:183], v39 offset:8192
v_mfma_f32_16x16x32_bf16 v[68:71], v[140:143], v[184:187], v[68:71]
s_mov_b32 s47, 12288
buffer_load_dwordx4 v[232:235], v45, s[32:35], s47 offen offset:2048 sc1
s_mov_b32 s47, 12288
buffer_load_dwordx4 v[236:239], v46, s[32:35], s47 offen offset:2048 sc1
v_mfma_f32_16x16x32_bf16 v[100:103], v[140:143], v[188:191], v[100:103]
s_mov_b32 s47, 12288
buffer_load_dwordx4 v[240:243], v45, s[32:35], s47 offen offset:3072 sc1
v_mfma_f32_16x16x32_bf16 v[72:75], v[144:147], v[184:187], v[72:75]
s_mov_b32 s47, 12288
buffer_load_dwordx4 v[244:247], v46, s[32:35], s47 offen offset:3072 sc1
v_mfma_f32_16x16x32_bf16 v[104:107], v[144:147], v[188:191], v[104:107]
v_mfma_f32_16x16x32_bf16 v[76:79], v[148:151], v[184:187], v[76:79]
v_mfma_f32_16x16x32_bf16 v[108:111], v[148:151], v[188:191], v[108:111]
s_cmp_eq_u32 s43, 0
s_cbranch_scc0 LB85
v_mfma_f32_16x16x32_bf16 v[112:115], v[120:123], v[4:7], v[112:115]
v_mfma_f32_16x16x32_bf16 v[116:119], v[124:127], v[4:7], v[116:119]
LB85:
s_waitcnt lgkmcnt(0)
s_barrier
s_waitcnt vmcnt(12)
v_mfma_f32_16x16x32_bf16 v[48:51], v[152:155], v[192:195], v[48:51]
ds_read_b64_tr_b16 v[120:121], v24 offset:16384
ds_read_b64_tr_b16 v[122:123], v32 offset:16384
v_mfma_f32_16x16x32_bf16 v[80:83], v[152:155], v[196:199], v[80:83]
ds_read_b64_tr_b16 v[124:125], v25 offset:16384
v_mfma_f32_16x16x32_bf16 v[52:55], v[156:159], v[192:195], v[52:55]
ds_read_b64_tr_b16 v[126:127], v33 offset:16384
v_mfma_f32_16x16x32_bf16 v[84:87], v[156:159], v[196:199], v[84:87]
ds_read_b64_tr_b16 v[128:129], v26 offset:16384
v_mfma_f32_16x16x32_bf16 v[56:59], v[160:163], v[192:195], v[56:59]
ds_read_b64_tr_b16 v[130:131], v34 offset:16384
ds_read_b64_tr_b16 v[132:133], v27 offset:16384
v_mfma_f32_16x16x32_bf16 v[88:91], v[160:163], v[196:199], v[88:91]
ds_read_b64_tr_b16 v[134:135], v35 offset:16384
v_mfma_f32_16x16x32_bf16 v[60:63], v[164:167], v[192:195], v[60:63]
ds_read_b64_tr_b16 v[136:137], v28 offset:16384
v_mfma_f32_16x16x32_bf16 v[92:95], v[164:167], v[196:199], v[92:95]
ds_read_b64_tr_b16 v[138:139], v36 offset:16384
v_mfma_f32_16x16x32_bf16 v[64:67], v[168:171], v[192:195], v[64:67]
ds_read_b64_tr_b16 v[140:141], v29 offset:16384
ds_read_b64_tr_b16 v[142:143], v37 offset:16384
v_mfma_f32_16x16x32_bf16 v[96:99], v[168:171], v[196:199], v[96:99]
ds_read_b64_tr_b16 v[144:145], v30 offset:16384
v_mfma_f32_16x16x32_bf16 v[68:71], v[172:175], v[192:195], v[68:71]
ds_read_b64_tr_b16 v[146:147], v38 offset:16384
v_mfma_f32_16x16x32_bf16 v[100:103], v[172:175], v[196:199], v[100:103]
ds_read_b64_tr_b16 v[148:149], v31 offset:16384
v_mfma_f32_16x16x32_bf16 v[72:75], v[176:179], v[192:195], v[72:75]
ds_read_b64_tr_b16 v[150:151], v39 offset:16384
v_mfma_f32_16x16x32_bf16 v[104:107], v[176:179], v[196:199], v[104:107]
v_mfma_f32_16x16x32_bf16 v[76:79], v[180:183], v[192:195], v[76:79]
v_mfma_f32_16x16x32_bf16 v[108:111], v[180:183], v[196:199], v[108:111]
s_cmp_eq_u32 s43, 0
s_cbranch_scc0 LB86
v_mfma_f32_16x16x32_bf16 v[112:115], v[152:155], v[4:7], v[112:115]
v_mfma_f32_16x16x32_bf16 v[116:119], v[156:159], v[4:7], v[116:119]
LB86:
s_waitcnt lgkmcnt(0)
s_waitcnt vmcnt(10)
v_mfma_f32_16x16x32_bf16 v[48:51], v[120:123], v[200:203], v[48:51]
ds_read_b64_tr_b16 v[152:153], v24 offset:24576
ds_read_b64_tr_b16 v[154:155], v32 offset:24576
v_mfma_f32_16x16x32_bf16 v[80:83], v[120:123], v[204:207], v[80:83]
ds_read_b64_tr_b16 v[156:157], v25 offset:24576
ds_read_b64_tr_b16 v[158:159], v33 offset:24576
v_mfma_f32_16x16x32_bf16 v[52:55], v[124:127], v[200:203], v[52:55]
ds_read_b64_tr_b16 v[160:161], v26 offset:24576
v_mfma_f32_16x16x32_bf16 v[84:87], v[124:127], v[204:207], v[84:87]
ds_read_b64_tr_b16 v[162:163], v34 offset:24576
ds_read_b64_tr_b16 v[164:165], v27 offset:24576
v_mfma_f32_16x16x32_bf16 v[56:59], v[128:131], v[200:203], v[56:59]
ds_read_b64_tr_b16 v[166:167], v35 offset:24576
v_mfma_f32_16x16x32_bf16 v[88:91], v[128:131], v[204:207], v[88:91]
ds_read_b64_tr_b16 v[168:169], v28 offset:24576
ds_read_b64_tr_b16 v[170:171], v36 offset:24576
v_mfma_f32_16x16x32_bf16 v[60:63], v[132:135], v[200:203], v[60:63]
ds_read_b64_tr_b16 v[172:173], v29 offset:24576
v_mfma_f32_16x16x32_bf16 v[92:95], v[132:135], v[204:207], v[92:95]
ds_read_b64_tr_b16 v[174:175], v37 offset:24576
ds_read_b64_tr_b16 v[176:177], v30 offset:24576
v_mfma_f32_16x16x32_bf16 v[64:67], v[136:139], v[200:203], v[64:67]
ds_read_b64_tr_b16 v[178:179], v38 offset:24576
ds_read_b64_tr_b16 v[180:181], v31 offset:24576
v_mfma_f32_16x16x32_bf16 v[96:99], v[136:139], v[204:207], v[96:99]
ds_read_b64_tr_b16 v[182:183], v39 offset:24576
v_mfma_f32_16x16x32_bf16 v[68:71], v[140:143], v[200:203], v[68:71]
s_mov_b32 s47, 16384
buffer_load_dwordx4 v[184:187], v45, s[32:35], s47 offen offset:0 sc1
s_mov_b32 s47, 16384
buffer_load_dwordx4 v[188:191], v46, s[32:35], s47 offen offset:0 sc1
v_mfma_f32_16x16x32_bf16 v[100:103], v[140:143], v[204:207], v[100:103]
s_mov_b32 s47, 16384
buffer_load_dwordx4 v[192:195], v45, s[32:35], s47 offen offset:1024 sc1
v_mfma_f32_16x16x32_bf16 v[72:75], v[144:147], v[200:203], v[72:75]
s_mov_b32 s47, 16384
buffer_load_dwordx4 v[196:199], v46, s[32:35], s47 offen offset:1024 sc1
v_mfma_f32_16x16x32_bf16 v[104:107], v[144:147], v[204:207], v[104:107]
v_mfma_f32_16x16x32_bf16 v[76:79], v[148:151], v[200:203], v[76:79]
v_mfma_f32_16x16x32_bf16 v[108:111], v[148:151], v[204:207], v[108:111]
s_cmp_eq_u32 s43, 0
s_cbranch_scc0 LB87
v_mfma_f32_16x16x32_bf16 v[112:115], v[120:123], v[4:7], v[112:115]
v_mfma_f32_16x16x32_bf16 v[116:119], v[124:127], v[4:7], v[116:119]
LB87:
s_waitcnt lgkmcnt(0)
s_barrier
s_waitcnt vmcnt(12)
v_mfma_f32_16x16x32_bf16 v[48:51], v[152:155], v[208:211], v[48:51]
ds_read_b64_tr_b16 v[120:121], v24 offset:32768
ds_read_b64_tr_b16 v[122:123], v32 offset:32768
v_mfma_f32_16x16x32_bf16 v[80:83], v[152:155], v[212:215], v[80:83]
ds_read_b64_tr_b16 v[124:125], v25 offset:32768
v_mfma_f32_16x16x32_bf16 v[52:55], v[156:159], v[208:211], v[52:55]
ds_read_b64_tr_b16 v[126:127], v33 offset:32768
v_mfma_f32_16x16x32_bf16 v[84:87], v[156:159], v[212:215], v[84:87]
ds_read_b64_tr_b16 v[128:129], v26 offset:32768
v_mfma_f32_16x16x32_bf16 v[56:59], v[160:163], v[208:211], v[56:59]
ds_read_b64_tr_b16 v[130:131], v34 offset:32768
ds_read_b64_tr_b16 v[132:133], v27 offset:32768
v_mfma_f32_16x16x32_bf16 v[88:91], v[160:163], v[212:215], v[88:91]
ds_read_b64_tr_b16 v[134:135], v35 offset:32768
v_mfma_f32_16x16x32_bf16 v[60:63], v[164:167], v[208:211], v[60:63]
ds_read_b64_tr_b16 v[136:137], v28 offset:32768
v_mfma_f32_16x16x32_bf16 v[92:95], v[164:167], v[212:215], v[92:95]
ds_read_b64_tr_b16 v[138:139], v36 offset:32768
v_mfma_f32_16x16x32_bf16 v[64:67], v[168:171], v[208:211], v[64:67]
ds_read_b64_tr_b16 v[140:141], v29 offset:32768
ds_read_b64_tr_b16 v[142:143], v37 offset:32768
v_mfma_f32_16x16x32_bf16 v[96:99], v[168:171], v[212:215], v[96:99]
ds_read_b64_tr_b16 v[144:145], v30 offset:32768
v_mfma_f32_16x16x32_bf16 v[68:71], v[172:175], v[208:211], v[68:71]
ds_read_b64_tr_b16 v[146:147], v38 offset:32768
v_mfma_f32_16x16x32_bf16 v[100:103], v[172:175], v[212:215], v[100:103]
ds_read_b64_tr_b16 v[148:149], v31 offset:32768
v_mfma_f32_16x16x32_bf16 v[72:75], v[176:179], v[208:211], v[72:75]
ds_read_b64_tr_b16 v[150:151], v39 offset:32768
v_mfma_f32_16x16x32_bf16 v[104:107], v[176:179], v[212:215], v[104:107]
v_mfma_f32_16x16x32_bf16 v[76:79], v[180:183], v[208:211], v[76:79]
v_mfma_f32_16x16x32_bf16 v[108:111], v[180:183], v[212:215], v[108:111]
s_cmp_eq_u32 s43, 0
s_cbranch_scc0 LB88
v_mfma_f32_16x16x32_bf16 v[112:115], v[152:155], v[4:7], v[112:115]
v_mfma_f32_16x16x32_bf16 v[116:119], v[156:159], v[4:7], v[116:119]
LB88:
s_waitcnt lgkmcnt(0)
s_waitcnt vmcnt(10)
v_mfma_f32_16x16x32_bf16 v[48:51], v[120:123], v[216:219], v[48:51]
ds_read_b64_tr_b16 v[152:153], v24 offset:40960
ds_read_b64_tr_b16 v[154:155], v32 offset:40960
v_mfma_f32_16x16x32_bf16 v[80:83], v[120:123], v[220:223], v[80:83]
ds_read_b64_tr_b16 v[156:157], v25 offset:40960
ds_read_b64_tr_b16 v[158:159], v33 offset:40960
v_mfma_f32_16x16x32_bf16 v[52:55], v[124:127], v[216:219], v[52:55]
ds_read_b64_tr_b16 v[160:161], v26 offset:40960
v_mfma_f32_16x16x32_bf16 v[84:87], v[124:127], v[220:223], v[84:87]
ds_read_b64_tr_b16 v[162:163], v34 offset:40960
ds_read_b64_tr_b16 v[164:165], v27 offset:40960
v_mfma_f32_16x16x32_bf16 v[56:59], v[128:131], v[216:219], v[56:59]
ds_read_b64_tr_b16 v[166:167], v35 offset:40960
v_mfma_f32_16x16x32_bf16 v[88:91], v[128:131], v[220:223], v[88:91]
ds_read_b64_tr_b16 v[168:169], v28 offset:40960
ds_read_b64_tr_b16 v[170:171], v36 offset:40960
v_mfma_f32_16x16x32_bf16 v[60:63], v[132:135], v[216:219], v[60:63]
ds_read_b64_tr_b16 v[172:173], v29 offset:40960
v_mfma_f32_16x16x32_bf16 v[92:95], v[132:135], v[220:223], v[92:95]
ds_read_b64_tr_b16 v[174:175], v37 offset:40960
ds_read_b64_tr_b16 v[176:177], v30 offset:40960
v_mfma_f32_16x16x32_bf16 v[64:67], v[136:139], v[216:219], v[64:67]
ds_read_b64_tr_b16 v[178:179], v38 offset:40960
ds_read_b64_tr_b16 v[180:181], v31 offset:40960
v_mfma_f32_16x16x32_bf16 v[96:99], v[136:139], v[220:223], v[96:99]
ds_read_b64_tr_b16 v[182:183], v39 offset:40960
v_mfma_f32_16x16x32_bf16 v[68:71], v[140:143], v[216:219], v[68:71]
s_mov_b32 s47, 16384
buffer_load_dwordx4 v[200:203], v45, s[32:35], s47 offen offset:2048 sc1
s_mov_b32 s47, 16384
buffer_load_dwordx4 v[204:207], v46, s[32:35], s47 offen offset:2048 sc1
v_mfma_f32_16x16x32_bf16 v[100:103], v[140:143], v[220:223], v[100:103]
s_mov_b32 s47, 16384
buffer_load_dwordx4 v[208:211], v45, s[32:35], s47 offen offset:3072 sc1
v_mfma_f32_16x16x32_bf16 v[72:75], v[144:147], v[216:219], v[72:75]
s_mov_b32 s47, 16384
buffer_load_dwordx4 v[212:215], v46, s[32:35], s47 offen offset:3072 sc1
v_mfma_f32_16x16x32_bf16 v[104:107], v[144:147], v[220:223], v[104:107]
v_mfma_f32_16x16x32_bf16 v[76:79], v[148:151], v[216:219], v[76:79]
v_mfma_f32_16x16x32_bf16 v[108:111], v[148:151], v[220:223], v[108:111]
s_cmp_eq_u32 s43, 0
s_cbranch_scc0 LB89
v_mfma_f32_16x16x32_bf16 v[112:115], v[120:123], v[4:7], v[112:115]
v_mfma_f32_16x16x32_bf16 v[116:119], v[124:127], v[4:7], v[116:119]
LB89:
s_waitcnt lgkmcnt(0)
s_barrier
s_waitcnt vmcnt(12)
v_mfma_f32_16x16x32_bf16 v[48:51], v[152:155], v[224:227], v[48:51]
ds_read_b64_tr_b16 v[120:121], v24 offset:49152
ds_read_b64_tr_b16 v[122:123], v32 offset:49152
v_mfma_f32_16x16x32_bf16 v[80:83], v[152:155], v[228:231], v[80:83]
ds_read_b64_tr_b16 v[124:125], v25 offset:49152
v_mfma_f32_16x16x32_bf16 v[52:55], v[156:159], v[224:227], v[52:55]
ds_read_b64_tr_b16 v[126:127], v33 offset:49152
v_mfma_f32_16x16x32_bf16 v[84:87], v[156:159], v[228:231], v[84:87]
ds_read_b64_tr_b16 v[128:129], v26 offset:49152
v_mfma_f32_16x16x32_bf16 v[56:59], v[160:163], v[224:227], v[56:59]
ds_read_b64_tr_b16 v[130:131], v34 offset:49152
ds_read_b64_tr_b16 v[132:133], v27 offset:49152
v_mfma_f32_16x16x32_bf16 v[88:91], v[160:163], v[228:231], v[88:91]
ds_read_b64_tr_b16 v[134:135], v35 offset:49152
v_mfma_f32_16x16x32_bf16 v[60:63], v[164:167], v[224:227], v[60:63]
ds_read_b64_tr_b16 v[136:137], v28 offset:49152
v_mfma_f32_16x16x32_bf16 v[92:95], v[164:167], v[228:231], v[92:95]
ds_read_b64_tr_b16 v[138:139], v36 offset:49152
v_mfma_f32_16x16x32_bf16 v[64:67], v[168:171], v[224:227], v[64:67]
ds_read_b64_tr_b16 v[140:141], v29 offset:49152
ds_read_b64_tr_b16 v[142:143], v37 offset:49152
v_mfma_f32_16x16x32_bf16 v[96:99], v[168:171], v[228:231], v[96:99]
ds_read_b64_tr_b16 v[144:145], v30 offset:49152
v_mfma_f32_16x16x32_bf16 v[68:71], v[172:175], v[224:227], v[68:71]
ds_read_b64_tr_b16 v[146:147], v38 offset:49152
v_mfma_f32_16x16x32_bf16 v[100:103], v[172:175], v[228:231], v[100:103]
ds_read_b64_tr_b16 v[148:149], v31 offset:49152
v_mfma_f32_16x16x32_bf16 v[72:75], v[176:179], v[224:227], v[72:75]
ds_read_b64_tr_b16 v[150:151], v39 offset:49152
v_mfma_f32_16x16x32_bf16 v[104:107], v[176:179], v[228:231], v[104:107]
v_mfma_f32_16x16x32_bf16 v[76:79], v[180:183], v[224:227], v[76:79]
v_mfma_f32_16x16x32_bf16 v[108:111], v[180:183], v[228:231], v[108:111]
s_cmp_eq_u32 s43, 0
s_cbranch_scc0 LB90
v_mfma_f32_16x16x32_bf16 v[112:115], v[152:155], v[4:7], v[112:115]
v_mfma_f32_16x16x32_bf16 v[116:119], v[156:159], v[4:7], v[116:119]
LB90:
s_waitcnt lgkmcnt(0)
s_waitcnt vmcnt(10)
v_mfma_f32_16x16x32_bf16 v[48:51], v[120:123], v[232:235], v[48:51]
ds_read_b64_tr_b16 v[152:153], v24 offset:57344
ds_read_b64_tr_b16 v[154:155], v32 offset:57344
v_mfma_f32_16x16x32_bf16 v[80:83], v[120:123], v[236:239], v[80:83]
ds_read_b64_tr_b16 v[156:157], v25 offset:57344
v_mfma_f32_16x16x32_bf16 v[52:55], v[124:127], v[232:235], v[52:55]
ds_read_b64_tr_b16 v[158:159], v33 offset:57344
v_mfma_f32_16x16x32_bf16 v[84:87], v[124:127], v[236:239], v[84:87]
ds_read_b64_tr_b16 v[160:161], v26 offset:57344
v_mfma_f32_16x16x32_bf16 v[56:59], v[128:131], v[232:235], v[56:59]
ds_read_b64_tr_b16 v[162:163], v34 offset:57344
ds_read_b64_tr_b16 v[164:165], v27 offset:57344
v_mfma_f32_16x16x32_bf16 v[88:91], v[128:131], v[236:239], v[88:91]
ds_read_b64_tr_b16 v[166:167], v35 offset:57344
v_mfma_f32_16x16x32_bf16 v[60:63], v[132:135], v[232:235], v[60:63]
ds_read_b64_tr_b16 v[168:169], v28 offset:57344
v_mfma_f32_16x16x32_bf16 v[92:95], v[132:135], v[236:239], v[92:95]
ds_read_b64_tr_b16 v[170:171], v36 offset:57344
v_mfma_f32_16x16x32_bf16 v[64:67], v[136:139], v[232:235], v[64:67]
ds_read_b64_tr_b16 v[172:173], v29 offset:57344
ds_read_b64_tr_b16 v[174:175], v37 offset:57344
v_mfma_f32_16x16x32_bf16 v[96:99], v[136:139], v[236:239], v[96:99]
ds_read_b64_tr_b16 v[176:177], v30 offset:57344
v_mfma_f32_16x16x32_bf16 v[68:71], v[140:143], v[232:235], v[68:71]
ds_read_b64_tr_b16 v[178:179], v38 offset:57344
v_mfma_f32_16x16x32_bf16 v[100:103], v[140:143], v[236:239], v[100:103]
ds_read_b64_tr_b16 v[180:181], v31 offset:57344
v_mfma_f32_16x16x32_bf16 v[72:75], v[144:147], v[232:235], v[72:75]
ds_read_b64_tr_b16 v[182:183], v39 offset:57344
v_mfma_f32_16x16x32_bf16 v[104:107], v[144:147], v[236:239], v[104:107]
v_mfma_f32_16x16x32_bf16 v[76:79], v[148:151], v[232:235], v[76:79]
v_mfma_f32_16x16x32_bf16 v[108:111], v[148:151], v[236:239], v[108:111]
s_cmp_eq_u32 s43, 0
s_cbranch_scc0 LB91
v_mfma_f32_16x16x32_bf16 v[112:115], v[120:123], v[4:7], v[112:115]
v_mfma_f32_16x16x32_bf16 v[116:119], v[124:127], v[4:7], v[116:119]
LB91:
s_waitcnt lgkmcnt(0)
s_barrier
s_waitcnt vmcnt(8)
v_mfma_f32_16x16x32_bf16 v[48:51], v[152:155], v[240:243], v[48:51]
ds_read_b64_tr_b16 v[120:121], v24 offset:0
ds_read_b64_tr_b16 v[122:123], v32 offset:0
v_mfma_f32_16x16x32_bf16 v[80:83], v[152:155], v[244:247], v[80:83]
ds_read_b64_tr_b16 v[124:125], v25 offset:0
v_mfma_f32_16x16x32_bf16 v[52:55], v[156:159], v[240:243], v[52:55]
ds_read_b64_tr_b16 v[126:127], v33 offset:0
v_mfma_f32_16x16x32_bf16 v[84:87], v[156:159], v[244:247], v[84:87]
ds_read_b64_tr_b16 v[128:129], v26 offset:0
v_mfma_f32_16x16x32_bf16 v[56:59], v[160:163], v[240:243], v[56:59]
ds_read_b64_tr_b16 v[130:131], v34 offset:0
ds_read_b64_tr_b16 v[132:133], v27 offset:0
v_mfma_f32_16x16x32_bf16 v[88:91], v[160:163], v[244:247], v[88:91]
ds_read_b64_tr_b16 v[134:135], v35 offset:0
v_mfma_f32_16x16x32_bf16 v[60:63], v[164:167], v[240:243], v[60:63]
ds_read_b64_tr_b16 v[136:137], v28 offset:0
v_mfma_f32_16x16x32_bf16 v[92:95], v[164:167], v[244:247], v[92:95]
ds_read_b64_tr_b16 v[138:139], v36 offset:0
v_mfma_f32_16x16x32_bf16 v[64:67], v[168:171], v[240:243], v[64:67]
ds_read_b64_tr_b16 v[140:141], v29 offset:0
ds_read_b64_tr_b16 v[142:143], v37 offset:0
v_mfma_f32_16x16x32_bf16 v[96:99], v[168:171], v[244:247], v[96:99]
ds_read_b64_tr_b16 v[144:145], v30 offset:0
v_mfma_f32_16x16x32_bf16 v[68:71], v[172:175], v[240:243], v[68:71]
ds_read_b64_tr_b16 v[146:147], v38 offset:0
v_mfma_f32_16x16x32_bf16 v[100:103], v[172:175], v[244:247], v[100:103]
ds_read_b64_tr_b16 v[148:149], v31 offset:0
v_mfma_f32_16x16x32_bf16 v[72:75], v[176:179], v[240:243], v[72:75]
ds_read_b64_tr_b16 v[150:151], v39 offset:0
v_mfma_f32_16x16x32_bf16 v[104:107], v[176:179], v[244:247], v[104:107]
v_mfma_f32_16x16x32_bf16 v[76:79], v[180:183], v[240:243], v[76:79]
v_mfma_f32_16x16x32_bf16 v[108:111], v[180:183], v[244:247], v[108:111]
s_cmp_eq_u32 s43, 0
s_cbranch_scc0 LB92
v_mfma_f32_16x16x32_bf16 v[112:115], v[152:155], v[4:7], v[112:115]
v_mfma_f32_16x16x32_bf16 v[116:119], v[156:159], v[4:7], v[116:119]
LB92:
s_waitcnt lgkmcnt(0)
s_waitcnt vmcnt(6)
v_mfma_f32_16x16x32_bf16 v[48:51], v[120:123], v[184:187], v[48:51]
ds_read_b64_tr_b16 v[152:153], v24 offset:8192
ds_read_b64_tr_b16 v[154:155], v32 offset:8192
v_mfma_f32_16x16x32_bf16 v[80:83], v[120:123], v[188:191], v[80:83]
ds_read_b64_tr_b16 v[156:157], v25 offset:8192
v_mfma_f32_16x16x32_bf16 v[52:55], v[124:127], v[184:187], v[52:55]
ds_read_b64_tr_b16 v[158:159], v33 offset:8192
v_mfma_f32_16x16x32_bf16 v[84:87], v[124:127], v[188:191], v[84:87]
ds_read_b64_tr_b16 v[160:161], v26 offset:8192
v_mfma_f32_16x16x32_bf16 v[56:59], v[128:131], v[184:187], v[56:59]
ds_read_b64_tr_b16 v[162:163], v34 offset:8192
ds_read_b64_tr_b16 v[164:165], v27 offset:8192
v_mfma_f32_16x16x32_bf16 v[88:91], v[128:131], v[188:191], v[88:91]
ds_read_b64_tr_b16 v[166:167], v35 offset:8192
v_mfma_f32_16x16x32_bf16 v[60:63], v[132:135], v[184:187], v[60:63]
ds_read_b64_tr_b16 v[168:169], v28 offset:8192
v_mfma_f32_16x16x32_bf16 v[92:95], v[132:135], v[188:191], v[92:95]
ds_read_b64_tr_b16 v[170:171], v36 offset:8192
v_mfma_f32_16x16x32_bf16 v[64:67], v[136:139], v[184:187], v[64:67]
ds_read_b64_tr_b16 v[172:173], v29 offset:8192
ds_read_b64_tr_b16 v[174:175], v37 offset:8192
v_mfma_f32_16x16x32_bf16 v[96:99], v[136:139], v[188:191], v[96:99]
ds_read_b64_tr_b16 v[176:177], v30 offset:8192
v_mfma_f32_16x16x32_bf16 v[68:71], v[140:143], v[184:187], v[68:71]
ds_read_b64_tr_b16 v[178:179], v38 offset:8192
v_mfma_f32_16x16x32_bf16 v[100:103], v[140:143], v[188:191], v[100:103]
ds_read_b64_tr_b16 v[180:181], v31 offset:8192
v_mfma_f32_16x16x32_bf16 v[72:75], v[144:147], v[184:187], v[72:75]
ds_read_b64_tr_b16 v[182:183], v39 offset:8192
v_mfma_f32_16x16x32_bf16 v[104:107], v[144:147], v[188:191], v[104:107]
v_mfma_f32_16x16x32_bf16 v[76:79], v[148:151], v[184:187], v[76:79]
v_mfma_f32_16x16x32_bf16 v[108:111], v[148:151], v[188:191], v[108:111]
s_cmp_eq_u32 s43, 0
s_cbranch_scc0 LB93
v_mfma_f32_16x16x32_bf16 v[112:115], v[120:123], v[4:7], v[112:115]
v_mfma_f32_16x16x32_bf16 v[116:119], v[124:127], v[4:7], v[116:119]
LB93:
s_waitcnt lgkmcnt(0)
s_barrier
s_waitcnt vmcnt(4)
v_mfma_f32_16x16x32_bf16 v[48:51], v[152:155], v[192:195], v[48:51]
ds_read_b64_tr_b16 v[120:121], v24 offset:16384
ds_read_b64_tr_b16 v[122:123], v32 offset:16384
v_mfma_f32_16x16x32_bf16 v[80:83], v[152:155], v[196:199], v[80:83]
ds_read_b64_tr_b16 v[124:125], v25 offset:16384
v_mfma_f32_16x16x32_bf16 v[52:55], v[156:159], v[192:195], v[52:55]
ds_read_b64_tr_b16 v[126:127], v33 offset:16384
v_mfma_f32_16x16x32_bf16 v[84:87], v[156:159], v[196:199], v[84:87]
ds_read_b64_tr_b16 v[128:129], v26 offset:16384
v_mfma_f32_16x16x32_bf16 v[56:59], v[160:163], v[192:195], v[56:59]
ds_read_b64_tr_b16 v[130:131], v34 offset:16384
ds_read_b64_tr_b16 v[132:133], v27 offset:16384
v_mfma_f32_16x16x32_bf16 v[88:91], v[160:163], v[196:199], v[88:91]
ds_read_b64_tr_b16 v[134:135], v35 offset:16384
v_mfma_f32_16x16x32_bf16 v[60:63], v[164:167], v[192:195], v[60:63]
ds_read_b64_tr_b16 v[136:137], v28 offset:16384
v_mfma_f32_16x16x32_bf16 v[92:95], v[164:167], v[196:199], v[92:95]
ds_read_b64_tr_b16 v[138:139], v36 offset:16384
v_mfma_f32_16x16x32_bf16 v[64:67], v[168:171], v[192:195], v[64:67]
ds_read_b64_tr_b16 v[140:141], v29 offset:16384
ds_read_b64_tr_b16 v[142:143], v37 offset:16384
v_mfma_f32_16x16x32_bf16 v[96:99], v[168:171], v[196:199], v[96:99]
ds_read_b64_tr_b16 v[144:145], v30 offset:16384
v_mfma_f32_16x16x32_bf16 v[68:71], v[172:175], v[192:195], v[68:71]
ds_read_b64_tr_b16 v[146:147], v38 offset:16384
v_mfma_f32_16x16x32_bf16 v[100:103], v[172:175], v[196:199], v[100:103]
ds_read_b64_tr_b16 v[148:149], v31 offset:16384
v_mfma_f32_16x16x32_bf16 v[72:75], v[176:179], v[192:195], v[72:75]
ds_read_b64_tr_b16 v[150:151], v39 offset:16384
v_mfma_f32_16x16x32_bf16 v[104:107], v[176:179], v[196:199], v[104:107]
v_mfma_f32_16x16x32_bf16 v[76:79], v[180:183], v[192:195], v[76:79]
v_mfma_f32_16x16x32_bf16 v[108:111], v[180:183], v[196:199], v[108:111]
s_cmp_eq_u32 s43, 0
s_cbranch_scc0 LB94
v_mfma_f32_16x16x32_bf16 v[112:115], v[152:155], v[4:7], v[112:115]
v_mfma_f32_16x16x32_bf16 v[116:119], v[156:159], v[4:7], v[116:119]
LB94:
s_waitcnt lgkmcnt(0)
s_waitcnt vmcnt(2)
v_mfma_f32_16x16x32_bf16 v[48:51], v[120:123], v[200:203], v[48:51]
ds_read_b64_tr_b16 v[152:153], v24 offset:24576
ds_read_b64_tr_b16 v[154:155], v32 offset:24576
v_mfma_f32_16x16x32_bf16 v[80:83], v[120:123], v[204:207], v[80:83]
ds_read_b64_tr_b16 v[156:157], v25 offset:24576
v_mfma_f32_16x16x32_bf16 v[52:55], v[124:127], v[200:203], v[52:55]
ds_read_b64_tr_b16 v[158:159], v33 offset:24576
v_mfma_f32_16x16x32_bf16 v[84:87], v[124:127], v[204:207], v[84:87]
ds_read_b64_tr_b16 v[160:161], v26 offset:24576
v_mfma_f32_16x16x32_bf16 v[56:59], v[128:131], v[200:203], v[56:59]
ds_read_b64_tr_b16 v[162:163], v34 offset:24576
ds_read_b64_tr_b16 v[164:165], v27 offset:24576
v_mfma_f32_16x16x32_bf16 v[88:91], v[128:131], v[204:207], v[88:91]
ds_read_b64_tr_b16 v[166:167], v35 offset:24576
v_mfma_f32_16x16x32_bf16 v[60:63], v[132:135], v[200:203], v[60:63]
ds_read_b64_tr_b16 v[168:169], v28 offset:24576
v_mfma_f32_16x16x32_bf16 v[92:95], v[132:135], v[204:207], v[92:95]
ds_read_b64_tr_b16 v[170:171], v36 offset:24576
v_mfma_f32_16x16x32_bf16 v[64:67], v[136:139], v[200:203], v[64:67]
ds_read_b64_tr_b16 v[172:173], v29 offset:24576
ds_read_b64_tr_b16 v[174:175], v37 offset:24576
v_mfma_f32_16x16x32_bf16 v[96:99], v[136:139], v[204:207], v[96:99]
ds_read_b64_tr_b16 v[176:177], v30 offset:24576
v_mfma_f32_16x16x32_bf16 v[68:71], v[140:143], v[200:203], v[68:71]
ds_read_b64_tr_b16 v[178:179], v38 offset:24576
v_mfma_f32_16x16x32_bf16 v[100:103], v[140:143], v[204:207], v[100:103]
ds_read_b64_tr_b16 v[180:181], v31 offset:24576
v_mfma_f32_16x16x32_bf16 v[72:75], v[144:147], v[200:203], v[72:75]
ds_read_b64_tr_b16 v[182:183], v39 offset:24576
v_mfma_f32_16x16x32_bf16 v[104:107], v[144:147], v[204:207], v[104:107]
v_mfma_f32_16x16x32_bf16 v[76:79], v[148:151], v[200:203], v[76:79]
v_mfma_f32_16x16x32_bf16 v[108:111], v[148:151], v[204:207], v[108:111]
s_cmp_eq_u32 s43, 0
s_cbranch_scc0 LB95
v_mfma_f32_16x16x32_bf16 v[112:115], v[120:123], v[4:7], v[112:115]
v_mfma_f32_16x16x32_bf16 v[116:119], v[124:127], v[4:7], v[116:119]
LB95:
s_waitcnt lgkmcnt(0)
s_waitcnt vmcnt(0)
v_mfma_f32_16x16x32_bf16 v[48:51], v[152:155], v[208:211], v[48:51]
v_mfma_f32_16x16x32_bf16 v[80:83], v[152:155], v[212:215], v[80:83]
v_mfma_f32_16x16x32_bf16 v[52:55], v[156:159], v[208:211], v[52:55]
v_mfma_f32_16x16x32_bf16 v[84:87], v[156:159], v[212:215], v[84:87]
v_mfma_f32_16x16x32_bf16 v[56:59], v[160:163], v[208:211], v[56:59]
v_mfma_f32_16x16x32_bf16 v[88:91], v[160:163], v[212:215], v[88:91]
v_mfma_f32_16x16x32_bf16 v[60:63], v[164:167], v[208:211], v[60:63]
v_mfma_f32_16x16x32_bf16 v[92:95], v[164:167], v[212:215], v[92:95]
v_mfma_f32_16x16x32_bf16 v[64:67], v[168:171], v[208:211], v[64:67]
v_mfma_f32_16x16x32_bf16 v[96:99], v[168:171], v[212:215], v[96:99]
v_mfma_f32_16x16x32_bf16 v[68:71], v[172:175], v[208:211], v[68:71]
v_mfma_f32_16x16x32_bf16 v[100:103], v[172:175], v[212:215], v[100:103]
v_mfma_f32_16x16x32_bf16 v[72:75], v[176:179], v[208:211], v[72:75]
v_mfma_f32_16x16x32_bf16 v[104:107], v[176:179], v[212:215], v[104:107]
v_mfma_f32_16x16x32_bf16 v[76:79], v[180:183], v[208:211], v[76:79]
v_mfma_f32_16x16x32_bf16 v[108:111], v[180:183], v[212:215], v[108:111]
s_cmp_eq_u32 s43, 0
s_cbranch_scc0 LB96
v_mfma_f32_16x16x32_bf16 v[112:115], v[152:155], v[4:7], v[112:115]
v_mfma_f32_16x16x32_bf16 v[116:119], v[156:159], v[4:7], v[116:119]
LB96:
s_barrier
s_nop 7
s_nop 7
s_lshl_b32 s48, s40, 7
s_add_u32 s48, s48, 163328
v_lshlrev_b32 v3, 4, v2
v_add_u32 v4, s48, v3
s_cmp_eq_u32 s43, 0
s_cbranch_scc0 LB97
ds_write_b128 v4, v[112:115]
ds_write_b128 v4, v[116:119] offset:64
s_waitcnt lgkmcnt(0)
s_barrier
LB97:
s_xor_b32 s48, s40, 0
s_lshl_b32 s48, s48, 7
s_add_u32 s48, s48, 163328
v_add_u32 v4, s48, v3
ds_read_b128 v[120:123], v4
ds_read_b128 v[124:127], v4 offset:64
s_xor_b32 s48, s40, 1
s_lshl_b32 s48, s48, 7
s_add_u32 s48, s48, 163328
v_add_u32 v4, s48, v3
ds_read_b128 v[128:131], v4
ds_read_b128 v[132:135], v4 offset:64
s_xor_b32 s48, s40, 2
s_lshl_b32 s48, s48, 7
s_add_u32 s48, s48, 163328
v_add_u32 v4, s48, v3
ds_read_b128 v[136:139], v4
ds_read_b128 v[140:143], v4 offset:64
s_xor_b32 s48, s40, 3
s_lshl_b32 s48, s48, 7
s_add_u32 s48, s48, 163328
v_add_u32 v4, s48, v3
ds_read_b128 v[144:147], v4
ds_read_b128 v[148:151], v4 offset:64
v_accvgpr_read_b32 v42, a0
v_accvgpr_read_b32 v43, a1
v_accvgpr_read_b32 v5, a2
v_accvgpr_read_b32 v6, a3
s_nop 0
v_add_f32 v42, v42, v5
v_add_f32 v43, v43, v6
v_accvgpr_read_b32 v44, a4
v_accvgpr_read_b32 v45, a5
v_accvgpr_read_b32 v5, a6
v_accvgpr_read_b32 v6, a7
s_nop 0
v_add_f32 v44, v44, v5
v_add_f32 v45, v45, v6
v_mov_b32 v5, v42
s_nop 1
v_permlane32_swap_b32 v42, v5
s_nop 1
v_add_f32 v42, v42, v5
v_mov_b32 v5, v42
s_nop 1
v_permlane16_swap_b32 v42, v5
s_nop 1
v_add_f32 v42, v42, v5
v_mov_b32 v5, v43
s_nop 1
v_permlane32_swap_b32 v43, v5
s_nop 1
v_add_f32 v43, v43, v5
v_mov_b32 v5, v43
s_nop 1
v_permlane16_swap_b32 v43, v5
s_nop 1
v_add_f32 v43, v43, v5
s_mov_b32 s48, 0x3acccccd
v_mul_f32 v42, s48, v42
v_mul_f32 v43, s48, v43
v_fma_f32 v43, -v42, v42, v43
v_max_f32 v43, 0, v43
v_add_f32 v43, 0x3727c5ac, v43
v_rsq_f32 v43, v43
s_nop 0
v_mov_b32 v5, v44
s_nop 1
v_permlane32_swap_b32 v44, v5
s_nop 1
v_add_f32 v44, v44, v5
v_mov_b32 v5, v44
s_nop 1
v_permlane16_swap_b32 v44, v5
s_nop 1
v_add_f32 v44, v44, v5
v_mov_b32 v5, v45
s_nop 1
v_permlane32_swap_b32 v45, v5
s_nop 1
v_add_f32 v45, v45, v5
v_mov_b32 v5, v45
s_nop 1
v_permlane16_swap_b32 v45, v5
s_nop 1
v_add_f32 v45, v45, v5
s_mov_b32 s48, 0x3acccccd
v_mul_f32 v44, s48, v44
v_mul_f32 v45, s48, v45
v_fma_f32 v45, -v44, v44, v45
v_max_f32 v45, 0, v45
v_add_f32 v45, 0x3727c5ac, v45
v_rsq_f32 v45, v45
s_nop 0
s_waitcnt lgkmcnt(0)
s_lshl_b32 s65, s42, 3
s_mul_i32 s64, s42, 6
s_add_u32 s64, s64, 12
s_cmp_lt_u32 s42, 6
s_cselect_b32 s65, s65, s64
s_lshr_b32 s65, s65, 1
s_cmp_lt_u32 s42, 6
s_cselect_b32 s54, 4, 3
s_lshl_b32 s64, s41, 3
s_lshl_b32 s48, s40, 1
s_add_u32 s64, s64, s48
s_mul_i32 s64, s64, 54
s_add_u32 s64, s64, s65
s_lshl_b32 s64, s64, 10
s_add_u32 s64, s64, s53
v_lshlrev_b32 v3, 4, v0
s_xor_b32 s48, s40, 0
s_cmp_ge_u32 s48, s54
s_cbranch_scc1 LB101
s_lshl_b32 s48, s48, 10
s_add_u32 s48, s48, s64
v_pk_fma_f32 v[152:153], v[120:121], v[42:43], v[48:49] op_sel:[0,0,0] op_sel_hi:[1,0,1] neg_lo:[0,1,0] neg_hi:[0,1,0]
v_pk_fma_f32 v[154:155], v[122:123], v[42:43], v[50:51] op_sel:[0,0,0] op_sel_hi:[1,0,1] neg_lo:[0,1,0] neg_hi:[0,1,0]
v_pk_mul_f32 v[152:153], v[152:153], v[42:43] op_sel:[0,1] op_sel_hi:[1,1]
v_pk_mul_f32 v[154:155], v[154:155], v[42:43] op_sel:[0,1] op_sel_hi:[1,1]
v_cvt_pk_bf16_f32 v152, v152, v153
v_cvt_pk_bf16_f32 v153, v154, v155
v_pk_max_i16 v152, v152, 0
v_pk_max_i16 v153, v153, 0
v_pk_fma_f32 v[154:155], v[124:125], v[42:43], v[52:53] op_sel:[0,0,0] op_sel_hi:[1,0,1] neg_lo:[0,1,0] neg_hi:[0,1,0]
v_pk_fma_f32 v[156:157], v[126:127], v[42:43], v[54:55] op_sel:[0,0,0] op_sel_hi:[1,0,1] neg_lo:[0,1,0] neg_hi:[0,1,0]
v_pk_mul_f32 v[154:155], v[154:155], v[42:43] op_sel:[0,1] op_sel_hi:[1,1]
v_pk_mul_f32 v[156:157], v[156:157], v[42:43] op_sel:[0,1] op_sel_hi:[1,1]
v_cvt_pk_bf16_f32 v154, v154, v155
v_cvt_pk_bf16_f32 v155, v156, v157
v_pk_max_i16 v154, v154, 0
v_pk_max_i16 v155, v155, 0
s_add_u32 s55, s48, 0
s_cmp_eq_u32 s80, 0
s_cbranch_scc1 LB102
buffer_store_dwordx4 v[152:155], v3, s[32:35], s55 offen sc0 sc1
s_branch LB103
LB102:
buffer_store_dwordx4 v[152:155], v3, s[32:35], s55 offen sc0 sc1
LB103:
s_nop 1
v_pk_fma_f32 v[160:161], v[120:121], v[44:45], v[80:81] op_sel:[0,0,0] op_sel_hi:[1,0,1] neg_lo:[0,1,0] neg_hi:[0,1,0]
v_pk_fma_f32 v[162:163], v[122:123], v[44:45], v[82:83] op_sel:[0,0,0] op_sel_hi:[1,0,1] neg_lo:[0,1,0] neg_hi:[0,1,0]
v_pk_mul_f32 v[160:161], v[160:161], v[44:45] op_sel:[0,1] op_sel_hi:[1,1]
v_pk_mul_f32 v[162:163], v[162:163], v[44:45] op_sel:[0,1] op_sel_hi:[1,1]
v_cvt_pk_bf16_f32 v160, v160, v161
v_cvt_pk_bf16_f32 v161, v162, v163
v_pk_max_i16 v160, v160, 0
v_pk_max_i16 v161, v161, 0
v_pk_fma_f32 v[162:163], v[124:125], v[44:45], v[84:85] op_sel:[0,0,0] op_sel_hi:[1,0,1] neg_lo:[0,1,0] neg_hi:[0,1,0]
v_pk_fma_f32 v[164:165], v[126:127], v[44:45], v[86:87] op_sel:[0,0,0] op_sel_hi:[1,0,1] neg_lo:[0,1,0] neg_hi:[0,1,0]
v_pk_mul_f32 v[162:163], v[162:163], v[44:45] op_sel:[0,1] op_sel_hi:[1,1]
v_pk_mul_f32 v[164:165], v[164:165], v[44:45] op_sel:[0,1] op_sel_hi:[1,1]
v_cvt_pk_bf16_f32 v162, v162, v163
v_cvt_pk_bf16_f32 v163, v164, v165
v_pk_max_i16 v162, v162, 0
v_pk_max_i16 v163, v163, 0
s_add_u32 s55, s48, 55296
s_cmp_eq_u32 s80, 0
s_cbranch_scc1 LB104
buffer_store_dwordx4 v[160:163], v3, s[32:35], s55 offen sc0 sc1
s_branch LB105
LB104:
buffer_store_dwordx4 v[160:163], v3, s[32:35], s55 offen sc0 sc1
LB105:
s_nop 1
LB101:
s_xor_b32 s48, s40, 1
s_cmp_ge_u32 s48, s54
s_cbranch_scc1 LB106
s_lshl_b32 s48, s48, 10
s_add_u32 s48, s48, s64
v_pk_fma_f32 v[152:153], v[128:129], v[42:43], v[56:57] op_sel:[0,0,0] op_sel_hi:[1,0,1] neg_lo:[0,1,0] neg_hi:[0,1,0]
v_pk_fma_f32 v[154:155], v[130:131], v[42:43], v[58:59] op_sel:[0,0,0] op_sel_hi:[1,0,1] neg_lo:[0,1,0] neg_hi:[0,1,0]
v_pk_mul_f32 v[152:153], v[152:153], v[42:43] op_sel:[0,1] op_sel_hi:[1,1]
v_pk_mul_f32 v[154:155], v[154:155], v[42:43] op_sel:[0,1] op_sel_hi:[1,1]
v_cvt_pk_bf16_f32 v152, v152, v153
v_cvt_pk_bf16_f32 v153, v154, v155
v_pk_max_i16 v152, v152, 0
v_pk_max_i16 v153, v153, 0
v_pk_fma_f32 v[154:155], v[132:133], v[42:43], v[60:61] op_sel:[0,0,0] op_sel_hi:[1,0,1] neg_lo:[0,1,0] neg_hi:[0,1,0]
v_pk_fma_f32 v[156:157], v[134:135], v[42:43], v[62:63] op_sel:[0,0,0] op_sel_hi:[1,0,1] neg_lo:[0,1,0] neg_hi:[0,1,0]
v_pk_mul_f32 v[154:155], v[154:155], v[42:43] op_sel:[0,1] op_sel_hi:[1,1]
v_pk_mul_f32 v[156:157], v[156:157], v[42:43] op_sel:[0,1] op_sel_hi:[1,1]
v_cvt_pk_bf16_f32 v154, v154, v155
v_cvt_pk_bf16_f32 v155, v156, v157
v_pk_max_i16 v154, v154, 0
v_pk_max_i16 v155, v155, 0
s_add_u32 s55, s48, 0
s_cmp_eq_u32 s80, 0
s_cbranch_scc1 LB107
buffer_store_dwordx4 v[152:155], v3, s[32:35], s55 offen sc0 sc1
s_branch LB108
LB107:
buffer_store_dwordx4 v[152:155], v3, s[32:35], s55 offen sc0 sc1
LB108:
s_nop 1
v_pk_fma_f32 v[160:161], v[128:129], v[44:45], v[88:89] op_sel:[0,0,0] op_sel_hi:[1,0,1] neg_lo:[0,1,0] neg_hi:[0,1,0]
v_pk_fma_f32 v[162:163], v[130:131], v[44:45], v[90:91] op_sel:[0,0,0] op_sel_hi:[1,0,1] neg_lo:[0,1,0] neg_hi:[0,1,0]
v_pk_mul_f32 v[160:161], v[160:161], v[44:45] op_sel:[0,1] op_sel_hi:[1,1]
v_pk_mul_f32 v[162:163], v[162:163], v[44:45] op_sel:[0,1] op_sel_hi:[1,1]
v_cvt_pk_bf16_f32 v160, v160, v161
v_cvt_pk_bf16_f32 v161, v162, v163
v_pk_max_i16 v160, v160, 0
v_pk_max_i16 v161, v161, 0
v_pk_fma_f32 v[162:163], v[132:133], v[44:45], v[92:93] op_sel:[0,0,0] op_sel_hi:[1,0,1] neg_lo:[0,1,0] neg_hi:[0,1,0]
v_pk_fma_f32 v[164:165], v[134:135], v[44:45], v[94:95] op_sel:[0,0,0] op_sel_hi:[1,0,1] neg_lo:[0,1,0] neg_hi:[0,1,0]
v_pk_mul_f32 v[162:163], v[162:163], v[44:45] op_sel:[0,1] op_sel_hi:[1,1]
v_pk_mul_f32 v[164:165], v[164:165], v[44:45] op_sel:[0,1] op_sel_hi:[1,1]
v_cvt_pk_bf16_f32 v162, v162, v163
v_cvt_pk_bf16_f32 v163, v164, v165
v_pk_max_i16 v162, v162, 0
v_pk_max_i16 v163, v163, 0
s_add_u32 s55, s48, 55296
s_cmp_eq_u32 s80, 0
s_cbranch_scc1 LB109
buffer_store_dwordx4 v[160:163], v3, s[32:35], s55 offen sc0 sc1
s_branch LB110
LB109:
buffer_store_dwordx4 v[160:163], v3, s[32:35], s55 offen sc0 sc1
LB110:
s_nop 1
LB106:
s_xor_b32 s48, s40, 2
s_cmp_ge_u32 s48, s54
s_cbranch_scc1 LB111
s_lshl_b32 s48, s48, 10
s_add_u32 s48, s48, s64
v_pk_fma_f32 v[152:153], v[136:137], v[42:43], v[64:65] op_sel:[0,0,0] op_sel_hi:[1,0,1] neg_lo:[0,1,0] neg_hi:[0,1,0]
v_pk_fma_f32 v[154:155], v[138:139], v[42:43], v[66:67] op_sel:[0,0,0] op_sel_hi:[1,0,1] neg_lo:[0,1,0] neg_hi:[0,1,0]
v_pk_mul_f32 v[152:153], v[152:153], v[42:43] op_sel:[0,1] op_sel_hi:[1,1]
v_pk_mul_f32 v[154:155], v[154:155], v[42:43] op_sel:[0,1] op_sel_hi:[1,1]
v_cvt_pk_bf16_f32 v152, v152, v153
v_cvt_pk_bf16_f32 v153, v154, v155
v_pk_max_i16 v152, v152, 0
v_pk_max_i16 v153, v153, 0
v_pk_fma_f32 v[154:155], v[140:141], v[42:43], v[68:69] op_sel:[0,0,0] op_sel_hi:[1,0,1] neg_lo:[0,1,0] neg_hi:[0,1,0]
v_pk_fma_f32 v[156:157], v[142:143], v[42:43], v[70:71] op_sel:[0,0,0] op_sel_hi:[1,0,1] neg_lo:[0,1,0] neg_hi:[0,1,0]
v_pk_mul_f32 v[154:155], v[154:155], v[42:43] op_sel:[0,1] op_sel_hi:[1,1]
v_pk_mul_f32 v[156:157], v[156:157], v[42:43] op_sel:[0,1] op_sel_hi:[1,1]
v_cvt_pk_bf16_f32 v154, v154, v155
v_cvt_pk_bf16_f32 v155, v156, v157
v_pk_max_i16 v154, v154, 0
v_pk_max_i16 v155, v155, 0
s_add_u32 s55, s48, 0
s_cmp_eq_u32 s80, 0
s_cbranch_scc1 LB112
buffer_store_dwordx4 v[152:155], v3, s[32:35], s55 offen sc0 sc1
s_branch LB113
LB112:
buffer_store_dwordx4 v[152:155], v3, s[32:35], s55 offen sc0 sc1
LB113:
s_nop 1
v_pk_fma_f32 v[160:161], v[136:137], v[44:45], v[96:97] op_sel:[0,0,0] op_sel_hi:[1,0,1] neg_lo:[0,1,0] neg_hi:[0,1,0]
v_pk_fma_f32 v[162:163], v[138:139], v[44:45], v[98:99] op_sel:[0,0,0] op_sel_hi:[1,0,1] neg_lo:[0,1,0] neg_hi:[0,1,0]
v_pk_mul_f32 v[160:161], v[160:161], v[44:45] op_sel:[0,1] op_sel_hi:[1,1]
v_pk_mul_f32 v[162:163], v[162:163], v[44:45] op_sel:[0,1] op_sel_hi:[1,1]
v_cvt_pk_bf16_f32 v160, v160, v161
v_cvt_pk_bf16_f32 v161, v162, v163
v_pk_max_i16 v160, v160, 0
v_pk_max_i16 v161, v161, 0
v_pk_fma_f32 v[162:163], v[140:141], v[44:45], v[100:101] op_sel:[0,0,0] op_sel_hi:[1,0,1] neg_lo:[0,1,0] neg_hi:[0,1,0]
v_pk_fma_f32 v[164:165], v[142:143], v[44:45], v[102:103] op_sel:[0,0,0] op_sel_hi:[1,0,1] neg_lo:[0,1,0] neg_hi:[0,1,0]
v_pk_mul_f32 v[162:163], v[162:163], v[44:45] op_sel:[0,1] op_sel_hi:[1,1]
v_pk_mul_f32 v[164:165], v[164:165], v[44:45] op_sel:[0,1] op_sel_hi:[1,1]
v_cvt_pk_bf16_f32 v162, v162, v163
v_cvt_pk_bf16_f32 v163, v164, v165
v_pk_max_i16 v162, v162, 0
v_pk_max_i16 v163, v163, 0
s_add_u32 s55, s48, 55296
s_cmp_eq_u32 s80, 0
s_cbranch_scc1 LB114
buffer_store_dwordx4 v[160:163], v3, s[32:35], s55 offen sc0 sc1
s_branch LB115
LB114:
buffer_store_dwordx4 v[160:163], v3, s[32:35], s55 offen sc0 sc1
LB115:
s_nop 1
LB111:
s_xor_b32 s48, s40, 3
s_cmp_ge_u32 s48, s54
s_cbranch_scc1 LB116
s_lshl_b32 s48, s48, 10
s_add_u32 s48, s48, s64
v_pk_fma_f32 v[152:153], v[144:145], v[42:43], v[72:73] op_sel:[0,0,0] op_sel_hi:[1,0,1] neg_lo:[0,1,0] neg_hi:[0,1,0]
v_pk_fma_f32 v[154:155], v[146:147], v[42:43], v[74:75] op_sel:[0,0,0] op_sel_hi:[1,0,1] neg_lo:[0,1,0] neg_hi:[0,1,0]
v_pk_mul_f32 v[152:153], v[152:153], v[42:43] op_sel:[0,1] op_sel_hi:[1,1]
v_pk_mul_f32 v[154:155], v[154:155], v[42:43] op_sel:[0,1] op_sel_hi:[1,1]
v_cvt_pk_bf16_f32 v152, v152, v153
v_cvt_pk_bf16_f32 v153, v154, v155
v_pk_max_i16 v152, v152, 0
v_pk_max_i16 v153, v153, 0
v_pk_fma_f32 v[154:155], v[148:149], v[42:43], v[76:77] op_sel:[0,0,0] op_sel_hi:[1,0,1] neg_lo:[0,1,0] neg_hi:[0,1,0]
v_pk_fma_f32 v[156:157], v[150:151], v[42:43], v[78:79] op_sel:[0,0,0] op_sel_hi:[1,0,1] neg_lo:[0,1,0] neg_hi:[0,1,0]
v_pk_mul_f32 v[154:155], v[154:155], v[42:43] op_sel:[0,1] op_sel_hi:[1,1]
v_pk_mul_f32 v[156:157], v[156:157], v[42:43] op_sel:[0,1] op_sel_hi:[1,1]
v_cvt_pk_bf16_f32 v154, v154, v155
v_cvt_pk_bf16_f32 v155, v156, v157
v_pk_max_i16 v154, v154, 0
v_pk_max_i16 v155, v155, 0
s_add_u32 s55, s48, 0
s_cmp_eq_u32 s80, 0
s_cbranch_scc1 LB117
buffer_store_dwordx4 v[152:155], v3, s[32:35], s55 offen sc0 sc1
s_branch LB118
LB117:
buffer_store_dwordx4 v[152:155], v3, s[32:35], s55 offen sc0 sc1
LB118:
s_nop 1
v_pk_fma_f32 v[160:161], v[144:145], v[44:45], v[104:105] op_sel:[0,0,0] op_sel_hi:[1,0,1] neg_lo:[0,1,0] neg_hi:[0,1,0]
v_pk_fma_f32 v[162:163], v[146:147], v[44:45], v[106:107] op_sel:[0,0,0] op_sel_hi:[1,0,1] neg_lo:[0,1,0] neg_hi:[0,1,0]
v_pk_mul_f32 v[160:161], v[160:161], v[44:45] op_sel:[0,1] op_sel_hi:[1,1]
v_pk_mul_f32 v[162:163], v[162:163], v[44:45] op_sel:[0,1] op_sel_hi:[1,1]
v_cvt_pk_bf16_f32 v160, v160, v161
v_cvt_pk_bf16_f32 v161, v162, v163
v_pk_max_i16 v160, v160, 0
v_pk_max_i16 v161, v161, 0
v_pk_fma_f32 v[162:163], v[148:149], v[44:45], v[108:109] op_sel:[0,0,0] op_sel_hi:[1,0,1] neg_lo:[0,1,0] neg_hi:[0,1,0]
v_pk_fma_f32 v[164:165], v[150:151], v[44:45], v[110:111] op_sel:[0,0,0] op_sel_hi:[1,0,1] neg_lo:[0,1,0] neg_hi:[0,1,0]
v_pk_mul_f32 v[162:163], v[162:163], v[44:45] op_sel:[0,1] op_sel_hi:[1,1]
v_pk_mul_f32 v[164:165], v[164:165], v[44:45] op_sel:[0,1] op_sel_hi:[1,1]
v_cvt_pk_bf16_f32 v162, v162, v163
v_cvt_pk_bf16_f32 v163, v164, v165
v_pk_max_i16 v162, v162, 0
v_pk_max_i16 v163, v163, 0
s_add_u32 s55, s48, 55296
s_cmp_eq_u32 s80, 0
s_cbranch_scc1 LB119
buffer_store_dwordx4 v[160:163], v3, s[32:35], s55 offen sc0 sc1
s_branch LB120
LB119:
buffer_store_dwordx4 v[160:163], v3, s[32:35], s55 offen sc0 sc1
LB120:
s_nop 1
LB116:
s_waitcnt vmcnt(0)
s_barrier
s_cmp_lg_u32 s40, 0
s_cbranch_scc1 LB121
s_lshl_b32 s48, s43, 2
s_add_u32 s48, s48, 2
s_add_u32 s55, s44, s48
s_add_u32 s55, s55, s81
s_lshl_b32 s48, s48, 11
s_add_u32 s48, s48, s57
s_lshl_b32 s56, s42, 2
s_add_u32 s48, s48, s56
v_mov_b32 v3, s48
v_mov_b32 v4, s55
s_mov_b64 s[58:59], exec
s_mov_b64 exec, 1
s_cmp_eq_u32 s80, 0
s_cbranch_scc1 LB122
buffer_store_dword v4, v3, s[32:35], 0 offen
s_branch LB123
LB122:
buffer_store_dword v4, v3, s[32:35], 0 offen sc0 sc1
LB123:
s_mov_b64 exec, s[58:59]
LB121:
v_lshrrev_b32 v3, 2, v1
v_and_b32 v4, 3, v0
v_lshlrev_b32 v4, 3, v4
v_lshlrev_b32 v6, 2, v2
v_add_u32 v3, v6, v3
v_mul_u32_u24 v3, 160, v3
v_add_u32 v24, v3, v4
v_add_u32 v25, 2560, v24
v_add_u32 v27, 61440, v24
v_add_u32 v28, 61440, v25
v_add_u32 v24, 0, v24
v_add_u32 v25, 0, v25
s_lshr_b32 s48, s42, 3
s_lshl_b32 s48, s48, 2
s_lshl_b32 s64, s41, 3
s_add_u32 s64, s64, s48
s_add_u32 s64, s64, s40
s_mul_i32 s64, s64, 55296
s_add_u32 s64, s64, s53
v_lshlrev_b32 v3, 4, v0
v_add_u32 v26, s64, v3
s_cmp_lg_u32 s40, 0
s_cbranch_scc1 LB124
s_lshl_b32 s48, s43, 2
s_add_u32 s48, s48, 2
s_add_u32 s55, s44, s48
s_lshl_b32 s48, s48, 11
s_add_u32 s48, s48, s57
v_lshlrev_b32 v3, 2, v1
v_add_u32 v3, s48, v3
s_mov_b32 s56, 0
LB125:
buffer_load_dword v4, v3, s[32:35], 0 offen sc0 sc1
s_waitcnt vmcnt(0)
v_and_b32 v6, 0xffffff87, v4
v_cmp_ne_u32 vcc, s55, v6
s_cbranch_vccz LB124
s_add_u32 s56, s56, 1
s_cmp_lt_u32 s56, 20000
s_cbranch_scc1 LB125
LB124:
s_barrier
s_mov_b32 s47, 0
buffer_load_dwordx4 v[160:163], v26, s[32:35], s47 offen offset:0 sc1
s_mov_b32 s47, 0
buffer_load_dwordx4 v[164:167], v26, s[32:35], s47 offen offset:1024 sc1
s_mov_b32 s47, 0
buffer_load_dwordx4 v[168:171], v26, s[32:35], s47 offen offset:2048 sc1
s_mov_b32 s47, 0
buffer_load_dwordx4 v[172:175], v26, s[32:35], s47 offen offset:3072 sc1
s_mov_b32 s47, 4096
buffer_load_dwordx4 v[176:179], v26, s[32:35], s47 offen offset:0 sc1
s_mov_b32 s47, 4096
buffer_load_dwordx4 v[180:183], v26, s[32:35], s47 offen offset:1024 sc1
s_mov_b32 s47, 4096
buffer_load_dwordx4 v[184:187], v26, s[32:35], s47 offen offset:2048 sc1
s_mov_b32 s47, 4096
buffer_load_dwordx4 v[188:191], v26, s[32:35], s47 offen offset:3072 sc1
s_mov_b32 s47, 8192
buffer_load_dwordx4 v[192:195], v26, s[32:35], s47 offen offset:0 sc1
s_mov_b32 s47, 8192
buffer_load_dwordx4 v[196:199], v26, s[32:35], s47 offen offset:1024 sc1
s_mov_b32 s47, 8192
buffer_load_dwordx4 v[200:203], v26, s[32:35], s47 offen offset:2048 sc1
s_mov_b32 s47, 8192
buffer_load_dwordx4 v[204:207], v26, s[32:35], s47 offen offset:3072 sc1
s_mov_b32 s47, 12288
buffer_load_dwordx4 v[208:211], v26, s[32:35], s47 offen offset:0 sc1
s_mov_b32 s47, 12288
buffer_load_dwordx4 v[212:215], v26, s[32:35], s47 offen offset:1024 sc1
s_mov_b32 s47, 12288
buffer_load_dwordx4 v[216:219], v26, s[32:35], s47 offen offset:2048 sc1
s_mov_b32 s47, 12288
buffer_load_dwordx4 v[220:223], v26, s[32:35], s47 offen offset:3072 sc1
s_barrier
ds_read_b64_tr_b16 v[72:73], v24 offset:0
ds_read_b64_tr_b16 v[74:75], v25 offset:0
ds_read_b64_tr_b16 v[76:77], v24 offset:32
ds_read_b64_tr_b16 v[78:79], v25 offset:32
ds_read_b64_tr_b16 v[80:81], v24 offset:64
ds_read_b64_tr_b16 v[82:83], v25 offset:64
ds_read_b64_tr_b16 v[84:85], v24 offset:96
ds_read_b64_tr_b16 v[86:87], v25 offset:96
ds_read_b64_tr_b16 v[88:89], v24 offset:128
ds_read_b64_tr_b16 v[90:91], v25 offset:128
ds_read_b64_tr_b16 v[92:93], v24 offset:5120
ds_read_b64_tr_b16 v[94:95], v25 offset:5120
ds_read_b64_tr_b16 v[96:97], v24 offset:5152
ds_read_b64_tr_b16 v[98:99], v25 offset:5152
ds_read_b64_tr_b16 v[100:101], v24 offset:5184
ds_read_b64_tr_b16 v[102:103], v25 offset:5184
ds_read_b64_tr_b16 v[104:105], v24 offset:5216
ds_read_b64_tr_b16 v[106:107], v25 offset:5216
ds_read_b64_tr_b16 v[108:109], v24 offset:5248
ds_read_b64_tr_b16 v[110:111], v25 offset:5248
s_waitcnt lgkmcnt(10)
s_waitcnt vmcnt(15)
v_mfma_f32_16x16x32_bf16 v[48:51], v[72:75], v[160:163], 0
ds_read_b64_tr_b16 v[112:113], v24 offset:10240
ds_read_b64_tr_b16 v[114:115], v25 offset:10240
ds_read_b64_tr_b16 v[116:117], v24 offset:10272
v_mfma_f32_16x16x32_bf16 v[52:55], v[76:79], v[160:163], 0
ds_read_b64_tr_b16 v[118:119], v25 offset:10272
ds_read_b64_tr_b16 v[120:121], v24 offset:10304
v_mfma_f32_16x16x32_bf16 v[56:59], v[80:83], v[160:163], 0
ds_read_b64_tr_b16 v[122:123], v25 offset:10304
ds_read_b64_tr_b16 v[124:125], v24 offset:10336
ds_read_b64_tr_b16 v[126:127], v25 offset:10336
v_mfma_f32_16x16x32_bf16 v[60:63], v[84:87], v[160:163], 0
ds_read_b64_tr_b16 v[128:129], v24 offset:10368
ds_read_b64_tr_b16 v[130:131], v25 offset:10368
v_mfma_f32_16x16x32_bf16 v[64:67], v[88:91], v[160:163], 0
s_waitcnt lgkmcnt(10)
s_waitcnt vmcnt(14)
v_mfma_f32_16x16x32_bf16 v[48:51], v[92:95], v[164:167], v[48:51]
ds_read_b64_tr_b16 v[72:73], v24 offset:15360
ds_read_b64_tr_b16 v[74:75], v25 offset:15360
ds_read_b64_tr_b16 v[76:77], v24 offset:15392
v_mfma_f32_16x16x32_bf16 v[52:55], v[96:99], v[164:167], v[52:55]
ds_read_b64_tr_b16 v[78:79], v25 offset:15392
ds_read_b64_tr_b16 v[80:81], v24 offset:15424
v_mfma_f32_16x16x32_bf16 v[56:59], v[100:103], v[164:167], v[56:59]
ds_read_b64_tr_b16 v[82:83], v25 offset:15424
ds_read_b64_tr_b16 v[84:85], v24 offset:15456
ds_read_b64_tr_b16 v[86:87], v25 offset:15456
v_mfma_f32_16x16x32_bf16 v[60:63], v[104:107], v[164:167], v[60:63]
ds_read_b64_tr_b16 v[88:89], v24 offset:15488
ds_read_b64_tr_b16 v[90:91], v25 offset:15488
v_mfma_f32_16x16x32_bf16 v[64:67], v[108:111], v[164:167], v[64:67]
s_waitcnt lgkmcnt(0)
s_barrier
s_waitcnt vmcnt(13)
v_mfma_f32_16x16x32_bf16 v[48:51], v[112:115], v[168:171], v[48:51]
ds_read_b64_tr_b16 v[92:93], v24 offset:20480
ds_read_b64_tr_b16 v[94:95], v25 offset:20480
ds_read_b64_tr_b16 v[96:97], v24 offset:20512
v_mfma_f32_16x16x32_bf16 v[52:55], v[116:119], v[168:171], v[52:55]
ds_read_b64_tr_b16 v[98:99], v25 offset:20512
ds_read_b64_tr_b16 v[100:101], v24 offset:20544
v_mfma_f32_16x16x32_bf16 v[56:59], v[120:123], v[168:171], v[56:59]
ds_read_b64_tr_b16 v[102:103], v25 offset:20544
ds_read_b64_tr_b16 v[104:105], v24 offset:20576
ds_read_b64_tr_b16 v[106:107], v25 offset:20576
v_mfma_f32_16x16x32_bf16 v[60:63], v[124:127], v[168:171], v[60:63]
ds_read_b64_tr_b16 v[108:109], v24 offset:20608
ds_read_b64_tr_b16 v[110:111], v25 offset:20608
v_mfma_f32_16x16x32_bf16 v[64:67], v[128:131], v[168:171], v[64:67]
s_waitcnt lgkmcnt(10)
s_waitcnt vmcnt(12)
v_mfma_f32_16x16x32_bf16 v[48:51], v[72:75], v[172:175], v[48:51]
ds_read_b64_tr_b16 v[112:113], v24 offset:25600
ds_read_b64_tr_b16 v[114:115], v25 offset:25600
ds_read_b64_tr_b16 v[116:117], v24 offset:25632
v_mfma_f32_16x16x32_bf16 v[52:55], v[76:79], v[172:175], v[52:55]
ds_read_b64_tr_b16 v[118:119], v25 offset:25632
ds_read_b64_tr_b16 v[120:121], v24 offset:25664
v_mfma_f32_16x16x32_bf16 v[56:59], v[80:83], v[172:175], v[56:59]
ds_read_b64_tr_b16 v[122:123], v25 offset:25664
ds_read_b64_tr_b16 v[124:125], v24 offset:25696
ds_read_b64_tr_b16 v[126:127], v25 offset:25696
v_mfma_f32_16x16x32_bf16 v[60:63], v[84:87], v[172:175], v[60:63]
ds_read_b64_tr_b16 v[128:129], v24 offset:25728
ds_read_b64_tr_b16 v[130:131], v25 offset:25728
v_mfma_f32_16x16x32_bf16 v[64:67], v[88:91], v[172:175], v[64:67]
s_waitcnt lgkmcnt(10)
s_waitcnt vmcnt(11)
v_mfma_f32_16x16x32_bf16 v[48:51], v[92:95], v[176:179], v[48:51]
ds_read_b64_tr_b16 v[72:73], v24 offset:30720
ds_read_b64_tr_b16 v[74:75], v25 offset:30720
ds_read_b64_tr_b16 v[76:77], v24 offset:30752
ds_read_b64_tr_b16 v[78:79], v25 offset:30752
v_mfma_f32_16x16x32_bf16 v[52:55], v[96:99], v[176:179], v[52:55]
ds_read_b64_tr_b16 v[80:81], v24 offset:30784
ds_read_b64_tr_b16 v[82:83], v25 offset:30784
ds_read_b64_tr_b16 v[84:85], v24 offset:30816
v_mfma_f32_16x16x32_bf16 v[56:59], v[100:103], v[176:179], v[56:59]
ds_read_b64_tr_b16 v[86:87], v25 offset:30816
ds_read_b64_tr_b16 v[88:89], v24 offset:30848
ds_read_b64_tr_b16 v[90:91], v25 offset:30848
s_mov_b32 s47, 16384
buffer_load_dwordx4 v[160:163], v26, s[32:35], s47 offen offset:0 sc1
v_mfma_f32_16x16x32_bf16 v[60:63], v[104:107], v[176:179], v[60:63]
s_mov_b32 s47, 16384
buffer_load_dwordx4 v[164:167], v26, s[32:35], s47 offen offset:1024 sc1
s_mov_b32 s47, 16384
buffer_load_dwordx4 v[168:171], v26, s[32:35], s47 offen offset:2048 sc1
s_mov_b32 s47, 16384
buffer_load_dwordx4 v[172:175], v26, s[32:35], s47 offen offset:3072 sc1
v_mfma_f32_16x16x32_bf16 v[64:67], v[108:111], v[176:179], v[64:67]
s_waitcnt lgkmcnt(10)
s_waitcnt vmcnt(14)
v_mfma_f32_16x16x32_bf16 v[48:51], v[112:115], v[180:183], v[48:51]
ds_read_b64_tr_b16 v[92:93], v24 offset:35840
ds_read_b64_tr_b16 v[94:95], v25 offset:35840
ds_read_b64_tr_b16 v[96:97], v24 offset:35872
v_mfma_f32_16x16x32_bf16 v[52:55], v[116:119], v[180:183], v[52:55]
ds_read_b64_tr_b16 v[98:99], v25 offset:35872
ds_read_b64_tr_b16 v[100:101], v24 offset:35904
v_mfma_f32_16x16x32_bf16 v[56:59], v[120:123], v[180:183], v[56:59]
ds_read_b64_tr_b16 v[102:103], v25 offset:35904
ds_read_b64_tr_b16 v[104:105], v24 offset:35936
ds_read_b64_tr_b16 v[106:107], v25 offset:35936
v_mfma_f32_16x16x32_bf16 v[60:63], v[124:127], v[180:183], v[60:63]
ds_read_b64_tr_b16 v[108:109], v24 offset:35968
ds_read_b64_tr_b16 v[110:111], v25 offset:35968
v_mfma_f32_16x16x32_bf16 v[64:67], v[128:131], v[180:183], v[64:67]
s_waitcnt lgkmcnt(0)
s_barrier
s_waitcnt vmcnt(13)
v_mfma_f32_16x16x32_bf16 v[48:51], v[72:75], v[184:187], v[48:51]
ds_read_b64_tr_b16 v[112:113], v24 offset:40960
ds_read_b64_tr_b16 v[114:115], v25 offset:40960
ds_read_b64_tr_b16 v[116:117], v24 offset:40992
v_mfma_f32_16x16x32_bf16 v[52:55], v[76:79], v[184:187], v[52:55]
ds_read_b64_tr_b16 v[118:119], v25 offset:40992
ds_read_b64_tr_b16 v[120:121], v24 offset:41024
v_mfma_f32_16x16x32_bf16 v[56:59], v[80:83], v[184:187], v[56:59]
ds_read_b64_tr_b16 v[122:123], v25 offset:41024
ds_read_b64_tr_b16 v[124:125], v24 offset:41056
ds_read_b64_tr_b16 v[126:127], v25 offset:41056
v_mfma_f32_16x16x32_bf16 v[60:63], v[84:87], v[184:187], v[60:63]
ds_read_b64_tr_b16 v[128:129], v24 offset:41088
ds_read_b64_tr_b16 v[130:131], v25 offset:41088
v_mfma_f32_16x16x32_bf16 v[64:67], v[88:91], v[184:187], v[64:67]
s_waitcnt lgkmcnt(10)
s_waitcnt vmcnt(12)
v_mfma_f32_16x16x32_bf16 v[48:51], v[92:95], v[188:191], v[48:51]
ds_read_b64_tr_b16 v[72:73], v24 offset:46080
ds_read_b64_tr_b16 v[74:75], v25 offset:46080
ds_read_b64_tr_b16 v[76:77], v24 offset:46112
v_mfma_f32_16x16x32_bf16 v[52:55], v[96:99], v[188:191], v[52:55]
ds_read_b64_tr_b16 v[78:79], v25 offset:46112
ds_read_b64_tr_b16 v[80:81], v24 offset:46144
v_mfma_f32_16x16x32_bf16 v[56:59], v[100:103], v[188:191], v[56:59]
ds_read_b64_tr_b16 v[82:83], v25 offset:46144
ds_read_b64_tr_b16 v[84:85], v24 offset:46176
ds_read_b64_tr_b16 v[86:87], v25 offset:46176
v_mfma_f32_16x16x32_bf16 v[60:63], v[104:107], v[188:191], v[60:63]
ds_read_b64_tr_b16 v[88:89], v24 offset:46208
ds_read_b64_tr_b16 v[90:91], v25 offset:46208
v_mfma_f32_16x16x32_bf16 v[64:67], v[108:111], v[188:191], v[64:67]
s_waitcnt lgkmcnt(10)
s_waitcnt vmcnt(11)
v_mfma_f32_16x16x32_bf16 v[48:51], v[112:115], v[192:195], v[48:51]
ds_read_b64_tr_b16 v[92:93], v24 offset:51200
ds_read_b64_tr_b16 v[94:95], v25 offset:51200
ds_read_b64_tr_b16 v[96:97], v24 offset:51232
ds_read_b64_tr_b16 v[98:99], v25 offset:51232
v_mfma_f32_16x16x32_bf16 v[52:55], v[116:119], v[192:195], v[52:55]
ds_read_b64_tr_b16 v[100:101], v24 offset:51264
ds_read_b64_tr_b16 v[102:103], v25 offset:51264
ds_read_b64_tr_b16 v[104:105], v24 offset:51296
v_mfma_f32_16x16x32_bf16 v[56:59], v[120:123], v[192:195], v[56:59]
ds_read_b64_tr_b16 v[106:107], v25 offset:51296
ds_read_b64_tr_b16 v[108:109], v24 offset:51328
ds_read_b64_tr_b16 v[110:111], v25 offset:51328
s_mov_b32 s47, 20480
buffer_load_dwordx4 v[176:179], v26, s[32:35], s47 offen offset:0 sc1
v_mfma_f32_16x16x32_bf16 v[60:63], v[124:127], v[192:195], v[60:63]
s_mov_b32 s47, 20480
buffer_load_dwordx4 v[180:183], v26, s[32:35], s47 offen offset:1024 sc1
s_mov_b32 s47, 20480
buffer_load_dwordx4 v[184:187], v26, s[32:35], s47 offen offset:2048 sc1
s_mov_b32 s47, 20480
buffer_load_dwordx4 v[188:191], v26, s[32:35], s47 offen offset:3072 sc1
v_mfma_f32_16x16x32_bf16 v[64:67], v[128:131], v[192:195], v[64:67]
s_waitcnt lgkmcnt(10)
s_waitcnt vmcnt(14)
v_mfma_f32_16x16x32_bf16 v[48:51], v[72:75], v[196:199], v[48:51]
ds_read_b64_tr_b16 v[112:113], v24 offset:56320
ds_read_b64_tr_b16 v[114:115], v25 offset:56320
ds_read_b64_tr_b16 v[116:117], v24 offset:56352
v_mfma_f32_16x16x32_bf16 v[52:55], v[76:79], v[196:199], v[52:55]
ds_read_b64_tr_b16 v[118:119], v25 offset:56352
ds_read_b64_tr_b16 v[120:121], v24 offset:56384
v_mfma_f32_16x16x32_bf16 v[56:59], v[80:83], v[196:199], v[56:59]
ds_read_b64_tr_b16 v[122:123], v25 offset:56384
ds_read_b64_tr_b16 v[124:125], v24 offset:56416
ds_read_b64_tr_b16 v[126:127], v25 offset:56416
v_mfma_f32_16x16x32_bf16 v[60:63], v[84:87], v[196:199], v[60:63]
ds_read_b64_tr_b16 v[128:129], v24 offset:56448
ds_read_b64_tr_b16 v[130:131], v25 offset:56448
v_mfma_f32_16x16x32_bf16 v[64:67], v[88:91], v[196:199], v[64:67]
s_waitcnt lgkmcnt(0)
s_barrier
s_waitcnt vmcnt(13)
v_mfma_f32_16x16x32_bf16 v[48:51], v[92:95], v[200:203], v[48:51]
ds_read_b64_tr_b16 v[72:73], v27 offset:0
ds_read_b64_tr_b16 v[74:75], v28 offset:0
ds_read_b64_tr_b16 v[76:77], v27 offset:32
v_mfma_f32_16x16x32_bf16 v[52:55], v[96:99], v[200:203], v[52:55]
ds_read_b64_tr_b16 v[78:79], v28 offset:32
ds_read_b64_tr_b16 v[80:81], v27 offset:64
v_mfma_f32_16x16x32_bf16 v[56:59], v[100:103], v[200:203], v[56:59]
ds_read_b64_tr_b16 v[82:83], v28 offset:64
ds_read_b64_tr_b16 v[84:85], v27 offset:96
ds_read_b64_tr_b16 v[86:87], v28 offset:96
v_mfma_f32_16x16x32_bf16 v[60:63], v[104:107], v[200:203], v[60:63]
ds_read_b64_tr_b16 v[88:89], v27 offset:128
ds_read_b64_tr_b16 v[90:91], v28 offset:128
v_mfma_f32_16x16x32_bf16 v[64:67], v[108:111], v[200:203], v[64:67]
s_waitcnt lgkmcnt(10)
s_waitcnt vmcnt(12)
v_mfma_f32_16x16x32_bf16 v[48:51], v[112:115], v[204:207], v[48:51]
ds_read_b64_tr_b16 v[92:93], v27 offset:5120
ds_read_b64_tr_b16 v[94:95], v28 offset:5120
ds_read_b64_tr_b16 v[96:97], v27 offset:5152
v_mfma_f32_16x16x32_bf16 v[52:55], v[116:119], v[204:207], v[52:55]
ds_read_b64_tr_b16 v[98:99], v28 offset:5152
ds_read_b64_tr_b16 v[100:101], v27 offset:5184
v_mfma_f32_16x16x32_bf16 v[56:59], v[120:123], v[204:207], v[56:59]
ds_read_b64_tr_b16 v[102:103], v28 offset:5184
ds_read_b64_tr_b16 v[104:105], v27 offset:5216
ds_read_b64_tr_b16 v[106:107], v28 offset:5216
v_mfma_f32_16x16x32_bf16 v[60:63], v[124:127], v[204:207], v[60:63]
ds_read_b64_tr_b16 v[108:109], v27 offset:5248
ds_read_b64_tr_b16 v[110:111], v28 offset:5248
v_mfma_f32_16x16x32_bf16 v[64:67], v[128:131], v[204:207], v[64:67]
s_waitcnt lgkmcnt(10)
s_waitcnt vmcnt(11)
v_mfma_f32_16x16x32_bf16 v[48:51], v[72:75], v[208:211], v[48:51]
ds_read_b64_tr_b16 v[112:113], v27 offset:10240
ds_read_b64_tr_b16 v[114:115], v28 offset:10240
ds_read_b64_tr_b16 v[116:117], v27 offset:10272
ds_read_b64_tr_b16 v[118:119], v28 offset:10272
v_mfma_f32_16x16x32_bf16 v[52:55], v[76:79], v[208:211], v[52:55]
ds_read_b64_tr_b16 v[120:121], v27 offset:10304
ds_read_b64_tr_b16 v[122:123], v28 offset:10304
ds_read_b64_tr_b16 v[124:125], v27 offset:10336
v_mfma_f32_16x16x32_bf16 v[56:59], v[80:83], v[208:211], v[56:59]
ds_read_b64_tr_b16 v[126:127], v28 offset:10336
ds_read_b64_tr_b16 v[128:129], v27 offset:10368
ds_read_b64_tr_b16 v[130:131], v28 offset:10368
s_mov_b32 s47, 24576
buffer_load_dwordx4 v[192:195], v26, s[32:35], s47 offen offset:0 sc1
v_mfma_f32_16x16x32_bf16 v[60:63], v[84:87], v[208:211], v[60:63]
s_mov_b32 s47, 24576
buffer_load_dwordx4 v[196:199], v26, s[32:35], s47 offen offset:1024 sc1
s_mov_b32 s47, 24576
buffer_load_dwordx4 v[200:203], v26, s[32:35], s47 offen offset:2048 sc1
s_mov_b32 s47, 24576
buffer_load_dwordx4 v[204:207], v26, s[32:35], s47 offen offset:3072 sc1
v_mfma_f32_16x16x32_bf16 v[64:67], v[88:91], v[208:211], v[64:67]
s_waitcnt lgkmcnt(10)
s_waitcnt vmcnt(14)
v_mfma_f32_16x16x32_bf16 v[48:51], v[92:95], v[212:215], v[48:51]
ds_read_b64_tr_b16 v[72:73], v27 offset:15360
ds_read_b64_tr_b16 v[74:75], v28 offset:15360
ds_read_b64_tr_b16 v[76:77], v27 offset:15392
v_mfma_f32_16x16x32_bf16 v[52:55], v[96:99], v[212:215], v[52:55]
ds_read_b64_tr_b16 v[78:79], v28 offset:15392
ds_read_b64_tr_b16 v[80:81], v27 offset:15424
v_mfma_f32_16x16x32_bf16 v[56:59], v[100:103], v[212:215], v[56:59]
ds_read_b64_tr_b16 v[82:83], v28 offset:15424
ds_read_b64_tr_b16 v[84:85], v27 offset:15456
ds_read_b64_tr_b16 v[86:87], v28 offset:15456
v_mfma_f32_16x16x32_bf16 v[60:63], v[104:107], v[212:215], v[60:63]
ds_read_b64_tr_b16 v[88:89], v27 offset:15488
ds_read_b64_tr_b16 v[90:91], v28 offset:15488
v_mfma_f32_16x16x32_bf16 v[64:67], v[108:111], v[212:215], v[64:67]
s_waitcnt lgkmcnt(0)
s_barrier
s_waitcnt vmcnt(13)
v_mfma_f32_16x16x32_bf16 v[48:51], v[112:115], v[216:219], v[48:51]
ds_read_b64_tr_b16 v[92:93], v24 offset:0
ds_read_b64_tr_b16 v[94:95], v25 offset:0
ds_read_b64_tr_b16 v[96:97], v24 offset:32
v_mfma_f32_16x16x32_bf16 v[52:55], v[116:119], v[216:219], v[52:55]
ds_read_b64_tr_b16 v[98:99], v25 offset:32
ds_read_b64_tr_b16 v[100:101], v24 offset:64
v_mfma_f32_16x16x32_bf16 v[56:59], v[120:123], v[216:219], v[56:59]
ds_read_b64_tr_b16 v[102:103], v25 offset:64
ds_read_b64_tr_b16 v[104:105], v24 offset:96
ds_read_b64_tr_b16 v[106:107], v25 offset:96
v_mfma_f32_16x16x32_bf16 v[60:63], v[124:127], v[216:219], v[60:63]
ds_read_b64_tr_b16 v[108:109], v24 offset:128
ds_read_b64_tr_b16 v[110:111], v25 offset:128
v_mfma_f32_16x16x32_bf16 v[64:67], v[128:131], v[216:219], v[64:67]
s_waitcnt lgkmcnt(10)
s_waitcnt vmcnt(12)
v_mfma_f32_16x16x32_bf16 v[48:51], v[72:75], v[220:223], v[48:51]
ds_read_b64_tr_b16 v[112:113], v24 offset:5120
ds_read_b64_tr_b16 v[114:115], v25 offset:5120
ds_read_b64_tr_b16 v[116:117], v24 offset:5152
v_mfma_f32_16x16x32_bf16 v[52:55], v[76:79], v[220:223], v[52:55]
ds_read_b64_tr_b16 v[118:119], v25 offset:5152
ds_read_b64_tr_b16 v[120:121], v24 offset:5184
v_mfma_f32_16x16x32_bf16 v[56:59], v[80:83], v[220:223], v[56:59]
ds_read_b64_tr_b16 v[122:123], v25 offset:5184
ds_read_b64_tr_b16 v[124:125], v24 offset:5216
ds_read_b64_tr_b16 v[126:127], v25 offset:5216
v_mfma_f32_16x16x32_bf16 v[60:63], v[84:87], v[220:223], v[60:63]
ds_read_b64_tr_b16 v[128:129], v24 offset:5248
ds_read_b64_tr_b16 v[130:131], v25 offset:5248
v_mfma_f32_16x16x32_bf16 v[64:67], v[88:91], v[220:223], v[64:67]
s_waitcnt lgkmcnt(10)
s_waitcnt vmcnt(11)
v_mfma_f32_16x16x32_bf16 v[48:51], v[92:95], v[160:163], v[48:51]
ds_read_b64_tr_b16 v[72:73], v24 offset:10240
ds_read_b64_tr_b16 v[74:75], v25 offset:10240
ds_read_b64_tr_b16 v[76:77], v24 offset:10272
ds_read_b64_tr_b16 v[78:79], v25 offset:10272
v_mfma_f32_16x16x32_bf16 v[52:55], v[96:99], v[160:163], v[52:55]
ds_read_b64_tr_b16 v[80:81], v24 offset:10304
ds_read_b64_tr_b16 v[82:83], v25 offset:10304
ds_read_b64_tr_b16 v[84:85], v24 offset:10336
v_mfma_f32_16x16x32_bf16 v[56:59], v[100:103], v[160:163], v[56:59]
ds_read_b64_tr_b16 v[86:87], v25 offset:10336
ds_read_b64_tr_b16 v[88:89], v24 offset:10368
ds_read_b64_tr_b16 v[90:91], v25 offset:10368
s_mov_b32 s47, 28672
buffer_load_dwordx4 v[208:211], v26, s[32:35], s47 offen offset:0 sc1
v_mfma_f32_16x16x32_bf16 v[60:63], v[104:107], v[160:163], v[60:63]
s_mov_b32 s47, 28672
buffer_load_dwordx4 v[212:215], v26, s[32:35], s47 offen offset:1024 sc1
s_mov_b32 s47, 28672
buffer_load_dwordx4 v[216:219], v26, s[32:35], s47 offen offset:2048 sc1
s_mov_b32 s47, 28672
buffer_load_dwordx4 v[220:223], v26, s[32:35], s47 offen offset:3072 sc1
v_mfma_f32_16x16x32_bf16 v[64:67], v[108:111], v[160:163], v[64:67]
s_waitcnt lgkmcnt(10)
s_waitcnt vmcnt(14)
v_mfma_f32_16x16x32_bf16 v[48:51], v[112:115], v[164:167], v[48:51]
ds_read_b64_tr_b16 v[92:93], v24 offset:15360
ds_read_b64_tr_b16 v[94:95], v25 offset:15360
ds_read_b64_tr_b16 v[96:97], v24 offset:15392
v_mfma_f32_16x16x32_bf16 v[52:55], v[116:119], v[164:167], v[52:55]
ds_read_b64_tr_b16 v[98:99], v25 offset:15392
ds_read_b64_tr_b16 v[100:101], v24 offset:15424
v_mfma_f32_16x16x32_bf16 v[56:59], v[120:123], v[164:167], v[56:59]
ds_read_b64_tr_b16 v[102:103], v25 offset:15424
ds_read_b64_tr_b16 v[104:105], v24 offset:15456
ds_read_b64_tr_b16 v[106:107], v25 offset:15456
v_mfma_f32_16x16x32_bf16 v[60:63], v[124:127], v[164:167], v[60:63]
ds_read_b64_tr_b16 v[108:109], v24 offset:15488
ds_read_b64_tr_b16 v[110:111], v25 offset:15488
v_mfma_f32_16x16x32_bf16 v[64:67], v[128:131], v[164:167], v[64:67]
s_waitcnt lgkmcnt(0)
s_barrier
s_waitcnt vmcnt(13)
v_mfma_f32_16x16x32_bf16 v[48:51], v[72:75], v[168:171], v[48:51]
ds_read_b64_tr_b16 v[112:113], v24 offset:20480
ds_read_b64_tr_b16 v[114:115], v25 offset:20480
ds_read_b64_tr_b16 v[116:117], v24 offset:20512
v_mfma_f32_16x16x32_bf16 v[52:55], v[76:79], v[168:171], v[52:55]
ds_read_b64_tr_b16 v[118:119], v25 offset:20512
ds_read_b64_tr_b16 v[120:121], v24 offset:20544
v_mfma_f32_16x16x32_bf16 v[56:59], v[80:83], v[168:171], v[56:59]
ds_read_b64_tr_b16 v[122:123], v25 offset:20544
ds_read_b64_tr_b16 v[124:125], v24 offset:20576
ds_read_b64_tr_b16 v[126:127], v25 offset:20576
v_mfma_f32_16x16x32_bf16 v[60:63], v[84:87], v[168:171], v[60:63]
ds_read_b64_tr_b16 v[128:129], v24 offset:20608
ds_read_b64_tr_b16 v[130:131], v25 offset:20608
v_mfma_f32_16x16x32_bf16 v[64:67], v[88:91], v[168:171], v[64:67]
s_waitcnt lgkmcnt(10)
s_waitcnt vmcnt(12)
v_mfma_f32_16x16x32_bf16 v[48:51], v[92:95], v[172:175], v[48:51]
ds_read_b64_tr_b16 v[72:73], v24 offset:25600
ds_read_b64_tr_b16 v[74:75], v25 offset:25600
ds_read_b64_tr_b16 v[76:77], v24 offset:25632
v_mfma_f32_16x16x32_bf16 v[52:55], v[96:99], v[172:175], v[52:55]
ds_read_b64_tr_b16 v[78:79], v25 offset:25632
ds_read_b64_tr_b16 v[80:81], v24 offset:25664
v_mfma_f32_16x16x32_bf16 v[56:59], v[100:103], v[172:175], v[56:59]
ds_read_b64_tr_b16 v[82:83], v25 offset:25664
ds_read_b64_tr_b16 v[84:85], v24 offset:25696
ds_read_b64_tr_b16 v[86:87], v25 offset:25696
v_mfma_f32_16x16x32_bf16 v[60:63], v[104:107], v[172:175], v[60:63]
ds_read_b64_tr_b16 v[88:89], v24 offset:25728
ds_read_b64_tr_b16 v[90:91], v25 offset:25728
v_mfma_f32_16x16x32_bf16 v[64:67], v[108:111], v[172:175], v[64:67]
s_waitcnt lgkmcnt(10)
s_waitcnt vmcnt(11)
v_mfma_f32_16x16x32_bf16 v[48:51], v[112:115], v[176:179], v[48:51]
ds_read_b64_tr_b16 v[92:93], v24 offset:30720
ds_read_b64_tr_b16 v[94:95], v25 offset:30720
ds_read_b64_tr_b16 v[96:97], v24 offset:30752
ds_read_b64_tr_b16 v[98:99], v25 offset:30752
v_mfma_f32_16x16x32_bf16 v[52:55], v[116:119], v[176:179], v[52:55]
ds_read_b64_tr_b16 v[100:101], v24 offset:30784
ds_read_b64_tr_b16 v[102:103], v25 offset:30784
ds_read_b64_tr_b16 v[104:105], v24 offset:30816
v_mfma_f32_16x16x32_bf16 v[56:59], v[120:123], v[176:179], v[56:59]
ds_read_b64_tr_b16 v[106:107], v25 offset:30816
ds_read_b64_tr_b16 v[108:109], v24 offset:30848
ds_read_b64_tr_b16 v[110:111], v25 offset:30848
s_mov_b32 s47, 32768
buffer_load_dwordx4 v[160:163], v26, s[32:35], s47 offen offset:0 sc1
v_mfma_f32_16x16x32_bf16 v[60:63], v[124:127], v[176:179], v[60:63]
s_mov_b32 s47, 32768
buffer_load_dwordx4 v[164:167], v26, s[32:35], s47 offen offset:1024 sc1
s_mov_b32 s47, 32768
buffer_load_dwordx4 v[168:171], v26, s[32:35], s47 offen offset:2048 sc1
s_mov_b32 s47, 32768
buffer_load_dwordx4 v[172:175], v26, s[32:35], s47 offen offset:3072 sc1
v_mfma_f32_16x16x32_bf16 v[64:67], v[128:131], v[176:179], v[64:67]
s_waitcnt lgkmcnt(10)
s_waitcnt vmcnt(14)
v_mfma_f32_16x16x32_bf16 v[48:51], v[72:75], v[180:183], v[48:51]
ds_read_b64_tr_b16 v[112:113], v24 offset:35840
ds_read_b64_tr_b16 v[114:115], v25 offset:35840
ds_read_b64_tr_b16 v[116:117], v24 offset:35872
v_mfma_f32_16x16x32_bf16 v[52:55], v[76:79], v[180:183], v[52:55]
ds_read_b64_tr_b16 v[118:119], v25 offset:35872
ds_read_b64_tr_b16 v[120:121], v24 offset:35904
v_mfma_f32_16x16x32_bf16 v[56:59], v[80:83], v[180:183], v[56:59]
ds_read_b64_tr_b16 v[122:123], v25 offset:35904
ds_read_b64_tr_b16 v[124:125], v24 offset:35936
ds_read_b64_tr_b16 v[126:127], v25 offset:35936
v_mfma_f32_16x16x32_bf16 v[60:63], v[84:87], v[180:183], v[60:63]
ds_read_b64_tr_b16 v[128:129], v24 offset:35968
ds_read_b64_tr_b16 v[130:131], v25 offset:35968
v_mfma_f32_16x16x32_bf16 v[64:67], v[88:91], v[180:183], v[64:67]
s_waitcnt lgkmcnt(0)
s_barrier
s_waitcnt vmcnt(13)
v_mfma_f32_16x16x32_bf16 v[48:51], v[92:95], v[184:187], v[48:51]
ds_read_b64_tr_b16 v[72:73], v24 offset:40960
ds_read_b64_tr_b16 v[74:75], v25 offset:40960
ds_read_b64_tr_b16 v[76:77], v24 offset:40992
v_mfma_f32_16x16x32_bf16 v[52:55], v[96:99], v[184:187], v[52:55]
ds_read_b64_tr_b16 v[78:79], v25 offset:40992
ds_read_b64_tr_b16 v[80:81], v24 offset:41024
v_mfma_f32_16x16x32_bf16 v[56:59], v[100:103], v[184:187], v[56:59]
ds_read_b64_tr_b16 v[82:83], v25 offset:41024
ds_read_b64_tr_b16 v[84:85], v24 offset:41056
ds_read_b64_tr_b16 v[86:87], v25 offset:41056
v_mfma_f32_16x16x32_bf16 v[60:63], v[104:107], v[184:187], v[60:63]
ds_read_b64_tr_b16 v[88:89], v24 offset:41088
ds_read_b64_tr_b16 v[90:91], v25 offset:41088
v_mfma_f32_16x16x32_bf16 v[64:67], v[108:111], v[184:187], v[64:67]
s_waitcnt lgkmcnt(10)
s_waitcnt vmcnt(12)
v_mfma_f32_16x16x32_bf16 v[48:51], v[112:115], v[188:191], v[48:51]
ds_read_b64_tr_b16 v[92:93], v24 offset:46080
ds_read_b64_tr_b16 v[94:95], v25 offset:46080
ds_read_b64_tr_b16 v[96:97], v24 offset:46112
v_mfma_f32_16x16x32_bf16 v[52:55], v[116:119], v[188:191], v[52:55]
ds_read_b64_tr_b16 v[98:99], v25 offset:46112
ds_read_b64_tr_b16 v[100:101], v24 offset:46144
v_mfma_f32_16x16x32_bf16 v[56:59], v[120:123], v[188:191], v[56:59]
ds_read_b64_tr_b16 v[102:103], v25 offset:46144
ds_read_b64_tr_b16 v[104:105], v24 offset:46176
ds_read_b64_tr_b16 v[106:107], v25 offset:46176
v_mfma_f32_16x16x32_bf16 v[60:63], v[124:127], v[188:191], v[60:63]
ds_read_b64_tr_b16 v[108:109], v24 offset:46208
ds_read_b64_tr_b16 v[110:111], v25 offset:46208
v_mfma_f32_16x16x32_bf16 v[64:67], v[128:131], v[188:191], v[64:67]
s_waitcnt lgkmcnt(10)
s_waitcnt vmcnt(11)
v_mfma_f32_16x16x32_bf16 v[48:51], v[72:75], v[192:195], v[48:51]
ds_read_b64_tr_b16 v[112:113], v24 offset:51200
ds_read_b64_tr_b16 v[114:115], v25 offset:51200
ds_read_b64_tr_b16 v[116:117], v24 offset:51232
ds_read_b64_tr_b16 v[118:119], v25 offset:51232
v_mfma_f32_16x16x32_bf16 v[52:55], v[76:79], v[192:195], v[52:55]
ds_read_b64_tr_b16 v[120:121], v24 offset:51264
ds_read_b64_tr_b16 v[122:123], v25 offset:51264
ds_read_b64_tr_b16 v[124:125], v24 offset:51296
v_mfma_f32_16x16x32_bf16 v[56:59], v[80:83], v[192:195], v[56:59]
ds_read_b64_tr_b16 v[126:127], v25 offset:51296
ds_read_b64_tr_b16 v[128:129], v24 offset:51328
ds_read_b64_tr_b16 v[130:131], v25 offset:51328
s_mov_b32 s47, 36864
buffer_load_dwordx4 v[176:179], v26, s[32:35], s47 offen offset:0 sc1
v_mfma_f32_16x16x32_bf16 v[60:63], v[84:87], v[192:195], v[60:63]
s_mov_b32 s47, 36864
buffer_load_dwordx4 v[180:183], v26, s[32:35], s47 offen offset:1024 sc1
s_mov_b32 s47, 36864
buffer_load_dwordx4 v[184:187], v26, s[32:35], s47 offen offset:2048 sc1
s_mov_b32 s47, 36864
buffer_load_dwordx4 v[188:191], v26, s[32:35], s47 offen offset:3072 sc1
v_mfma_f32_16x16x32_bf16 v[64:67], v[88:91], v[192:195], v[64:67]
s_waitcnt lgkmcnt(10)
s_waitcnt vmcnt(14)
v_mfma_f32_16x16x32_bf16 v[48:51], v[92:95], v[196:199], v[48:51]
ds_read_b64_tr_b16 v[72:73], v24 offset:56320
ds_read_b64_tr_b16 v[74:75], v25 offset:56320
ds_read_b64_tr_b16 v[76:77], v24 offset:56352
v_mfma_f32_16x16x32_bf16 v[52:55], v[96:99], v[196:199], v[52:55]
ds_read_b64_tr_b16 v[78:79], v25 offset:56352
ds_read_b64_tr_b16 v[80:81], v24 offset:56384
v_mfma_f32_16x16x32_bf16 v[56:59], v[100:103], v[196:199], v[56:59]
ds_read_b64_tr_b16 v[82:83], v25 offset:56384
ds_read_b64_tr_b16 v[84:85], v24 offset:56416
ds_read_b64_tr_b16 v[86:87], v25 offset:56416
v_mfma_f32_16x16x32_bf16 v[60:63], v[104:107], v[196:199], v[60:63]
ds_read_b64_tr_b16 v[88:89], v24 offset:56448
ds_read_b64_tr_b16 v[90:91], v25 offset:56448
v_mfma_f32_16x16x32_bf16 v[64:67], v[108:111], v[196:199], v[64:67]
s_waitcnt lgkmcnt(0)
s_barrier
s_waitcnt vmcnt(13)
v_mfma_f32_16x16x32_bf16 v[48:51], v[112:115], v[200:203], v[48:51]
ds_read_b64_tr_b16 v[92:93], v27 offset:0
ds_read_b64_tr_b16 v[94:95], v28 offset:0
ds_read_b64_tr_b16 v[96:97], v27 offset:32
v_mfma_f32_16x16x32_bf16 v[52:55], v[116:119], v[200:203], v[52:55]
ds_read_b64_tr_b16 v[98:99], v28 offset:32
ds_read_b64_tr_b16 v[100:101], v27 offset:64
v_mfma_f32_16x16x32_bf16 v[56:59], v[120:123], v[200:203], v[56:59]
ds_read_b64_tr_b16 v[102:103], v28 offset:64
ds_read_b64_tr_b16 v[104:105], v27 offset:96
ds_read_b64_tr_b16 v[106:107], v28 offset:96
v_mfma_f32_16x16x32_bf16 v[60:63], v[124:127], v[200:203], v[60:63]
ds_read_b64_tr_b16 v[108:109], v27 offset:128
ds_read_b64_tr_b16 v[110:111], v28 offset:128
v_mfma_f32_16x16x32_bf16 v[64:67], v[128:131], v[200:203], v[64:67]
s_waitcnt lgkmcnt(10)
s_waitcnt vmcnt(12)
v_mfma_f32_16x16x32_bf16 v[48:51], v[72:75], v[204:207], v[48:51]
ds_read_b64_tr_b16 v[112:113], v27 offset:5120
ds_read_b64_tr_b16 v[114:115], v28 offset:5120
ds_read_b64_tr_b16 v[116:117], v27 offset:5152
v_mfma_f32_16x16x32_bf16 v[52:55], v[76:79], v[204:207], v[52:55]
ds_read_b64_tr_b16 v[118:119], v28 offset:5152
ds_read_b64_tr_b16 v[120:121], v27 offset:5184
v_mfma_f32_16x16x32_bf16 v[56:59], v[80:83], v[204:207], v[56:59]
ds_read_b64_tr_b16 v[122:123], v28 offset:5184
ds_read_b64_tr_b16 v[124:125], v27 offset:5216
ds_read_b64_tr_b16 v[126:127], v28 offset:5216
v_mfma_f32_16x16x32_bf16 v[60:63], v[84:87], v[204:207], v[60:63]
ds_read_b64_tr_b16 v[128:129], v27 offset:5248
ds_read_b64_tr_b16 v[130:131], v28 offset:5248
v_mfma_f32_16x16x32_bf16 v[64:67], v[88:91], v[204:207], v[64:67]
s_waitcnt lgkmcnt(10)
s_waitcnt vmcnt(11)
v_mfma_f32_16x16x32_bf16 v[48:51], v[92:95], v[208:211], v[48:51]
ds_read_b64_tr_b16 v[72:73], v27 offset:10240
ds_read_b64_tr_b16 v[74:75], v28 offset:10240
ds_read_b64_tr_b16 v[76:77], v27 offset:10272
ds_read_b64_tr_b16 v[78:79], v28 offset:10272
v_mfma_f32_16x16x32_bf16 v[52:55], v[96:99], v[208:211], v[52:55]
ds_read_b64_tr_b16 v[80:81], v27 offset:10304
ds_read_b64_tr_b16 v[82:83], v28 offset:10304
ds_read_b64_tr_b16 v[84:85], v27 offset:10336
v_mfma_f32_16x16x32_bf16 v[56:59], v[100:103], v[208:211], v[56:59]
ds_read_b64_tr_b16 v[86:87], v28 offset:10336
ds_read_b64_tr_b16 v[88:89], v27 offset:10368
ds_read_b64_tr_b16 v[90:91], v28 offset:10368
s_mov_b32 s47, 40960
buffer_load_dwordx4 v[192:195], v26, s[32:35], s47 offen offset:0 sc1
v_mfma_f32_16x16x32_bf16 v[60:63], v[104:107], v[208:211], v[60:63]
s_mov_b32 s47, 40960
buffer_load_dwordx4 v[196:199], v26, s[32:35], s47 offen offset:1024 sc1
s_mov_b32 s47, 40960
buffer_load_dwordx4 v[200:203], v26, s[32:35], s47 offen offset:2048 sc1
s_mov_b32 s47, 40960
buffer_load_dwordx4 v[204:207], v26, s[32:35], s47 offen offset:3072 sc1
v_mfma_f32_16x16x32_bf16 v[64:67], v[108:111], v[208:211], v[64:67]
s_waitcnt lgkmcnt(10)
s_waitcnt vmcnt(14)
v_mfma_f32_16x16x32_bf16 v[48:51], v[112:115], v[212:215], v[48:51]
ds_read_b64_tr_b16 v[92:93], v27 offset:15360
ds_read_b64_tr_b16 v[94:95], v28 offset:15360
ds_read_b64_tr_b16 v[96:97], v27 offset:15392
v_mfma_f32_16x16x32_bf16 v[52:55], v[116:119], v[212:215], v[52:55]
ds_read_b64_tr_b16 v[98:99], v28 offset:15392
ds_read_b64_tr_b16 v[100:101], v27 offset:15424
v_mfma_f32_16x16x32_bf16 v[56:59], v[120:123], v[212:215], v[56:59]
ds_read_b64_tr_b16 v[102:103], v28 offset:15424
ds_read_b64_tr_b16 v[104:105], v27 offset:15456
ds_read_b64_tr_b16 v[106:107], v28 offset:15456
v_mfma_f32_16x16x32_bf16 v[60:63], v[124:127], v[212:215], v[60:63]
ds_read_b64_tr_b16 v[108:109], v27 offset:15488
ds_read_b64_tr_b16 v[110:111], v28 offset:15488
v_mfma_f32_16x16x32_bf16 v[64:67], v[128:131], v[212:215], v[64:67]
s_waitcnt lgkmcnt(0)
s_barrier
s_waitcnt vmcnt(13)
v_mfma_f32_16x16x32_bf16 v[48:51], v[72:75], v[216:219], v[48:51]
ds_read_b64_tr_b16 v[112:113], v24 offset:0
ds_read_b64_tr_b16 v[114:115], v25 offset:0
ds_read_b64_tr_b16 v[116:117], v24 offset:32
v_mfma_f32_16x16x32_bf16 v[52:55], v[76:79], v[216:219], v[52:55]
ds_read_b64_tr_b16 v[118:119], v25 offset:32
ds_read_b64_tr_b16 v[120:121], v24 offset:64
v_mfma_f32_16x16x32_bf16 v[56:59], v[80:83], v[216:219], v[56:59]
ds_read_b64_tr_b16 v[122:123], v25 offset:64
ds_read_b64_tr_b16 v[124:125], v24 offset:96
ds_read_b64_tr_b16 v[126:127], v25 offset:96
v_mfma_f32_16x16x32_bf16 v[60:63], v[84:87], v[216:219], v[60:63]
ds_read_b64_tr_b16 v[128:129], v24 offset:128
ds_read_b64_tr_b16 v[130:131], v25 offset:128
v_mfma_f32_16x16x32_bf16 v[64:67], v[88:91], v[216:219], v[64:67]
s_waitcnt lgkmcnt(10)
s_waitcnt vmcnt(12)
v_mfma_f32_16x16x32_bf16 v[48:51], v[92:95], v[220:223], v[48:51]
ds_read_b64_tr_b16 v[72:73], v24 offset:5120
ds_read_b64_tr_b16 v[74:75], v25 offset:5120
ds_read_b64_tr_b16 v[76:77], v24 offset:5152
v_mfma_f32_16x16x32_bf16 v[52:55], v[96:99], v[220:223], v[52:55]
ds_read_b64_tr_b16 v[78:79], v25 offset:5152
ds_read_b64_tr_b16 v[80:81], v24 offset:5184
v_mfma_f32_16x16x32_bf16 v[56:59], v[100:103], v[220:223], v[56:59]
ds_read_b64_tr_b16 v[82:83], v25 offset:5184
ds_read_b64_tr_b16 v[84:85], v24 offset:5216
ds_read_b64_tr_b16 v[86:87], v25 offset:5216
v_mfma_f32_16x16x32_bf16 v[60:63], v[104:107], v[220:223], v[60:63]
ds_read_b64_tr_b16 v[88:89], v24 offset:5248
ds_read_b64_tr_b16 v[90:91], v25 offset:5248
v_mfma_f32_16x16x32_bf16 v[64:67], v[108:111], v[220:223], v[64:67]
s_waitcnt lgkmcnt(10)
s_waitcnt vmcnt(11)
v_mfma_f32_16x16x32_bf16 v[48:51], v[112:115], v[160:163], v[48:51]
ds_read_b64_tr_b16 v[92:93], v24 offset:10240
ds_read_b64_tr_b16 v[94:95], v25 offset:10240
ds_read_b64_tr_b16 v[96:97], v24 offset:10272
ds_read_b64_tr_b16 v[98:99], v25 offset:10272
v_mfma_f32_16x16x32_bf16 v[52:55], v[116:119], v[160:163], v[52:55]
ds_read_b64_tr_b16 v[100:101], v24 offset:10304
ds_read_b64_tr_b16 v[102:103], v25 offset:10304
ds_read_b64_tr_b16 v[104:105], v24 offset:10336
v_mfma_f32_16x16x32_bf16 v[56:59], v[120:123], v[160:163], v[56:59]
ds_read_b64_tr_b16 v[106:107], v25 offset:10336
ds_read_b64_tr_b16 v[108:109], v24 offset:10368
ds_read_b64_tr_b16 v[110:111], v25 offset:10368
s_mov_b32 s47, 45056
buffer_load_dwordx4 v[208:211], v26, s[32:35], s47 offen offset:0 sc1
v_mfma_f32_16x16x32_bf16 v[60:63], v[124:127], v[160:163], v[60:63]
s_mov_b32 s47, 45056
buffer_load_dwordx4 v[212:215], v26, s[32:35], s47 offen offset:1024 sc1
s_mov_b32 s47, 45056
buffer_load_dwordx4 v[216:219], v26, s[32:35], s47 offen offset:2048 sc1
s_mov_b32 s47, 45056
buffer_load_dwordx4 v[220:223], v26, s[32:35], s47 offen offset:3072 sc1
v_mfma_f32_16x16x32_bf16 v[64:67], v[128:131], v[160:163], v[64:67]
s_waitcnt lgkmcnt(10)
s_waitcnt vmcnt(14)
v_mfma_f32_16x16x32_bf16 v[48:51], v[72:75], v[164:167], v[48:51]
ds_read_b64_tr_b16 v[112:113], v24 offset:15360
ds_read_b64_tr_b16 v[114:115], v25 offset:15360
ds_read_b64_tr_b16 v[116:117], v24 offset:15392
v_mfma_f32_16x16x32_bf16 v[52:55], v[76:79], v[164:167], v[52:55]
ds_read_b64_tr_b16 v[118:119], v25 offset:15392
ds_read_b64_tr_b16 v[120:121], v24 offset:15424
v_mfma_f32_16x16x32_bf16 v[56:59], v[80:83], v[164:167], v[56:59]
ds_read_b64_tr_b16 v[122:123], v25 offset:15424
ds_read_b64_tr_b16 v[124:125], v24 offset:15456
ds_read_b64_tr_b16 v[126:127], v25 offset:15456
v_mfma_f32_16x16x32_bf16 v[60:63], v[84:87], v[164:167], v[60:63]
ds_read_b64_tr_b16 v[128:129], v24 offset:15488
ds_read_b64_tr_b16 v[130:131], v25 offset:15488
v_mfma_f32_16x16x32_bf16 v[64:67], v[88:91], v[164:167], v[64:67]
s_waitcnt lgkmcnt(0)
s_barrier
s_waitcnt vmcnt(13)
v_mfma_f32_16x16x32_bf16 v[48:51], v[92:95], v[168:171], v[48:51]
ds_read_b64_tr_b16 v[72:73], v24 offset:20480
ds_read_b64_tr_b16 v[74:75], v25 offset:20480
ds_read_b64_tr_b16 v[76:77], v24 offset:20512
v_mfma_f32_16x16x32_bf16 v[52:55], v[96:99], v[168:171], v[52:55]
ds_read_b64_tr_b16 v[78:79], v25 offset:20512
ds_read_b64_tr_b16 v[80:81], v24 offset:20544
v_mfma_f32_16x16x32_bf16 v[56:59], v[100:103], v[168:171], v[56:59]
ds_read_b64_tr_b16 v[82:83], v25 offset:20544
ds_read_b64_tr_b16 v[84:85], v24 offset:20576
ds_read_b64_tr_b16 v[86:87], v25 offset:20576
v_mfma_f32_16x16x32_bf16 v[60:63], v[104:107], v[168:171], v[60:63]
ds_read_b64_tr_b16 v[88:89], v24 offset:20608
ds_read_b64_tr_b16 v[90:91], v25 offset:20608
v_mfma_f32_16x16x32_bf16 v[64:67], v[108:111], v[168:171], v[64:67]
s_waitcnt lgkmcnt(10)
s_waitcnt vmcnt(12)
v_mfma_f32_16x16x32_bf16 v[48:51], v[112:115], v[172:175], v[48:51]
ds_read_b64_tr_b16 v[92:93], v24 offset:25600
ds_read_b64_tr_b16 v[94:95], v25 offset:25600
ds_read_b64_tr_b16 v[96:97], v24 offset:25632
v_mfma_f32_16x16x32_bf16 v[52:55], v[116:119], v[172:175], v[52:55]
ds_read_b64_tr_b16 v[98:99], v25 offset:25632
ds_read_b64_tr_b16 v[100:101], v24 offset:25664
v_mfma_f32_16x16x32_bf16 v[56:59], v[120:123], v[172:175], v[56:59]
ds_read_b64_tr_b16 v[102:103], v25 offset:25664
ds_read_b64_tr_b16 v[104:105], v24 offset:25696
ds_read_b64_tr_b16 v[106:107], v25 offset:25696
v_mfma_f32_16x16x32_bf16 v[60:63], v[124:127], v[172:175], v[60:63]
ds_read_b64_tr_b16 v[108:109], v24 offset:25728
ds_read_b64_tr_b16 v[110:111], v25 offset:25728
v_mfma_f32_16x16x32_bf16 v[64:67], v[128:131], v[172:175], v[64:67]
s_waitcnt lgkmcnt(10)
s_waitcnt vmcnt(11)
v_mfma_f32_16x16x32_bf16 v[48:51], v[72:75], v[176:179], v[48:51]
ds_read_b64_tr_b16 v[112:113], v24 offset:30720
ds_read_b64_tr_b16 v[114:115], v25 offset:30720
ds_read_b64_tr_b16 v[116:117], v24 offset:30752
ds_read_b64_tr_b16 v[118:119], v25 offset:30752
v_mfma_f32_16x16x32_bf16 v[52:55], v[76:79], v[176:179], v[52:55]
ds_read_b64_tr_b16 v[120:121], v24 offset:30784
ds_read_b64_tr_b16 v[122:123], v25 offset:30784
ds_read_b64_tr_b16 v[124:125], v24 offset:30816
v_mfma_f32_16x16x32_bf16 v[56:59], v[80:83], v[176:179], v[56:59]
ds_read_b64_tr_b16 v[126:127], v25 offset:30816
ds_read_b64_tr_b16 v[128:129], v24 offset:30848
ds_read_b64_tr_b16 v[130:131], v25 offset:30848
s_mov_b32 s47, 49152
buffer_load_dwordx4 v[160:163], v26, s[32:35], s47 offen offset:0 sc1
v_mfma_f32_16x16x32_bf16 v[60:63], v[84:87], v[176:179], v[60:63]
s_mov_b32 s47, 49152
buffer_load_dwordx4 v[164:167], v26, s[32:35], s47 offen offset:1024 sc1
s_mov_b32 s47, 49152
buffer_load_dwordx4 v[168:171], v26, s[32:35], s47 offen offset:2048 sc1
s_mov_b32 s47, 49152
buffer_load_dwordx4 v[172:175], v26, s[32:35], s47 offen offset:3072 sc1
v_mfma_f32_16x16x32_bf16 v[64:67], v[88:91], v[176:179], v[64:67]
s_waitcnt lgkmcnt(10)
s_waitcnt vmcnt(14)
v_mfma_f32_16x16x32_bf16 v[48:51], v[92:95], v[180:183], v[48:51]
ds_read_b64_tr_b16 v[72:73], v24 offset:35840
ds_read_b64_tr_b16 v[74:75], v25 offset:35840
ds_read_b64_tr_b16 v[76:77], v24 offset:35872
v_mfma_f32_16x16x32_bf16 v[52:55], v[96:99], v[180:183], v[52:55]
ds_read_b64_tr_b16 v[78:79], v25 offset:35872
ds_read_b64_tr_b16 v[80:81], v24 offset:35904
v_mfma_f32_16x16x32_bf16 v[56:59], v[100:103], v[180:183], v[56:59]
ds_read_b64_tr_b16 v[82:83], v25 offset:35904
ds_read_b64_tr_b16 v[84:85], v24 offset:35936
ds_read_b64_tr_b16 v[86:87], v25 offset:35936
v_mfma_f32_16x16x32_bf16 v[60:63], v[104:107], v[180:183], v[60:63]
ds_read_b64_tr_b16 v[88:89], v24 offset:35968
ds_read_b64_tr_b16 v[90:91], v25 offset:35968
v_mfma_f32_16x16x32_bf16 v[64:67], v[108:111], v[180:183], v[64:67]
s_waitcnt lgkmcnt(0)
s_barrier
s_waitcnt vmcnt(13)
v_mfma_f32_16x16x32_bf16 v[48:51], v[112:115], v[184:187], v[48:51]
ds_read_b64_tr_b16 v[92:93], v24 offset:40960
ds_read_b64_tr_b16 v[94:95], v25 offset:40960
ds_read_b64_tr_b16 v[96:97], v24 offset:40992
v_mfma_f32_16x16x32_bf16 v[52:55], v[116:119], v[184:187], v[52:55]
ds_read_b64_tr_b16 v[98:99], v25 offset:40992
ds_read_b64_tr_b16 v[100:101], v24 offset:41024
v_mfma_f32_16x16x32_bf16 v[56:59], v[120:123], v[184:187], v[56:59]
ds_read_b64_tr_b16 v[102:103], v25 offset:41024
ds_read_b64_tr_b16 v[104:105], v24 offset:41056
ds_read_b64_tr_b16 v[106:107], v25 offset:41056
v_mfma_f32_16x16x32_bf16 v[60:63], v[124:127], v[184:187], v[60:63]
ds_read_b64_tr_b16 v[108:109], v24 offset:41088
ds_read_b64_tr_b16 v[110:111], v25 offset:41088
v_mfma_f32_16x16x32_bf16 v[64:67], v[128:131], v[184:187], v[64:67]
s_waitcnt lgkmcnt(10)
s_waitcnt vmcnt(12)
v_mfma_f32_16x16x32_bf16 v[48:51], v[72:75], v[188:191], v[48:51]
ds_read_b64_tr_b16 v[112:113], v24 offset:46080
ds_read_b64_tr_b16 v[114:115], v25 offset:46080
ds_read_b64_tr_b16 v[116:117], v24 offset:46112
v_mfma_f32_16x16x32_bf16 v[52:55], v[76:79], v[188:191], v[52:55]
ds_read_b64_tr_b16 v[118:119], v25 offset:46112
ds_read_b64_tr_b16 v[120:121], v24 offset:46144
v_mfma_f32_16x16x32_bf16 v[56:59], v[80:83], v[188:191], v[56:59]
ds_read_b64_tr_b16 v[122:123], v25 offset:46144
ds_read_b64_tr_b16 v[124:125], v24 offset:46176
ds_read_b64_tr_b16 v[126:127], v25 offset:46176
v_mfma_f32_16x16x32_bf16 v[60:63], v[84:87], v[188:191], v[60:63]
ds_read_b64_tr_b16 v[128:129], v24 offset:46208
ds_read_b64_tr_b16 v[130:131], v25 offset:46208
v_mfma_f32_16x16x32_bf16 v[64:67], v[88:91], v[188:191], v[64:67]
s_waitcnt lgkmcnt(10)
s_waitcnt vmcnt(11)
v_mfma_f32_16x16x32_bf16 v[48:51], v[92:95], v[192:195], v[48:51]
ds_read_b64_tr_b16 v[72:73], v24 offset:51200
ds_read_b64_tr_b16 v[74:75], v25 offset:51200
ds_read_b64_tr_b16 v[76:77], v24 offset:51232
v_mfma_f32_16x16x32_bf16 v[52:55], v[96:99], v[192:195], v[52:55]
ds_read_b64_tr_b16 v[78:79], v25 offset:51232
ds_read_b64_tr_b16 v[80:81], v24 offset:51264
ds_read_b64_tr_b16 v[82:83], v25 offset:51264
v_mfma_f32_16x16x32_bf16 v[56:59], v[100:103], v[192:195], v[56:59]
ds_read_b64_tr_b16 v[84:85], v24 offset:51296
ds_read_b64_tr_b16 v[86:87], v25 offset:51296
ds_read_b64_tr_b16 v[88:89], v24 offset:51328
v_mfma_f32_16x16x32_bf16 v[60:63], v[104:107], v[192:195], v[60:63]
ds_read_b64_tr_b16 v[90:91], v25 offset:51328
s_mov_b32 s47, 53248
buffer_load_dwordx4 v[176:179], v26, s[32:35], s47 offen offset:0 sc1
s_mov_b32 s47, 53248
buffer_load_dwordx4 v[180:183], v26, s[32:35], s47 offen offset:1024 sc1
v_mfma_f32_16x16x32_bf16 v[64:67], v[108:111], v[192:195], v[64:67]
s_waitcnt lgkmcnt(10)
s_waitcnt vmcnt(12)
v_mfma_f32_16x16x32_bf16 v[48:51], v[112:115], v[196:199], v[48:51]
ds_read_b64_tr_b16 v[92:93], v24 offset:56320
ds_read_b64_tr_b16 v[94:95], v25 offset:56320
ds_read_b64_tr_b16 v[96:97], v24 offset:56352
v_mfma_f32_16x16x32_bf16 v[52:55], v[116:119], v[196:199], v[52:55]
ds_read_b64_tr_b16 v[98:99], v25 offset:56352
ds_read_b64_tr_b16 v[100:101], v24 offset:56384
v_mfma_f32_16x16x32_bf16 v[56:59], v[120:123], v[196:199], v[56:59]
ds_read_b64_tr_b16 v[102:103], v25 offset:56384
ds_read_b64_tr_b16 v[104:105], v24 offset:56416
ds_read_b64_tr_b16 v[106:107], v25 offset:56416
v_mfma_f32_16x16x32_bf16 v[60:63], v[124:127], v[196:199], v[60:63]
ds_read_b64_tr_b16 v[108:109], v24 offset:56448
ds_read_b64_tr_b16 v[110:111], v25 offset:56448
v_mfma_f32_16x16x32_bf16 v[64:67], v[128:131], v[196:199], v[64:67]
s_waitcnt lgkmcnt(0)
s_barrier
s_waitcnt vmcnt(11)
v_mfma_f32_16x16x32_bf16 v[48:51], v[72:75], v[200:203], v[48:51]
ds_read_b64_tr_b16 v[112:113], v27 offset:0
ds_read_b64_tr_b16 v[114:115], v28 offset:0
ds_read_b64_tr_b16 v[116:117], v27 offset:32
v_mfma_f32_16x16x32_bf16 v[52:55], v[76:79], v[200:203], v[52:55]
ds_read_b64_tr_b16 v[118:119], v28 offset:32
ds_read_b64_tr_b16 v[120:121], v27 offset:64
v_mfma_f32_16x16x32_bf16 v[56:59], v[80:83], v[200:203], v[56:59]
ds_read_b64_tr_b16 v[122:123], v28 offset:64
ds_read_b64_tr_b16 v[124:125], v27 offset:96
ds_read_b64_tr_b16 v[126:127], v28 offset:96
v_mfma_f32_16x16x32_bf16 v[60:63], v[84:87], v[200:203], v[60:63]
ds_read_b64_tr_b16 v[128:129], v27 offset:128
ds_read_b64_tr_b16 v[130:131], v28 offset:128
v_mfma_f32_16x16x32_bf16 v[64:67], v[88:91], v[200:203], v[64:67]
s_waitcnt lgkmcnt(10)
s_waitcnt vmcnt(10)
v_mfma_f32_16x16x32_bf16 v[48:51], v[92:95], v[204:207], v[48:51]
ds_read_b64_tr_b16 v[72:73], v27 offset:5120
ds_read_b64_tr_b16 v[74:75], v28 offset:5120
ds_read_b64_tr_b16 v[76:77], v27 offset:5152
v_mfma_f32_16x16x32_bf16 v[52:55], v[96:99], v[204:207], v[52:55]
ds_read_b64_tr_b16 v[78:79], v28 offset:5152
ds_read_b64_tr_b16 v[80:81], v27 offset:5184
v_mfma_f32_16x16x32_bf16 v[56:59], v[100:103], v[204:207], v[56:59]
ds_read_b64_tr_b16 v[82:83], v28 offset:5184
ds_read_b64_tr_b16 v[84:85], v27 offset:5216
ds_read_b64_tr_b16 v[86:87], v28 offset:5216
v_mfma_f32_16x16x32_bf16 v[60:63], v[104:107], v[204:207], v[60:63]
ds_read_b64_tr_b16 v[88:89], v27 offset:5248
ds_read_b64_tr_b16 v[90:91], v28 offset:5248
v_mfma_f32_16x16x32_bf16 v[64:67], v[108:111], v[204:207], v[64:67]
s_waitcnt lgkmcnt(10)
s_waitcnt vmcnt(9)
v_mfma_f32_16x16x32_bf16 v[48:51], v[112:115], v[208:211], v[48:51]
ds_read_b64_tr_b16 v[92:93], v27 offset:10240
ds_read_b64_tr_b16 v[94:95], v28 offset:10240
ds_read_b64_tr_b16 v[96:97], v27 offset:10272
v_mfma_f32_16x16x32_bf16 v[52:55], v[116:119], v[208:211], v[52:55]
ds_read_b64_tr_b16 v[98:99], v28 offset:10272
ds_read_b64_tr_b16 v[100:101], v27 offset:10304
v_mfma_f32_16x16x32_bf16 v[56:59], v[120:123], v[208:211], v[56:59]
ds_read_b64_tr_b16 v[102:103], v28 offset:10304
ds_read_b64_tr_b16 v[104:105], v27 offset:10336
ds_read_b64_tr_b16 v[106:107], v28 offset:10336
v_mfma_f32_16x16x32_bf16 v[60:63], v[124:127], v[208:211], v[60:63]
ds_read_b64_tr_b16 v[108:109], v27 offset:10368
ds_read_b64_tr_b16 v[110:111], v28 offset:10368
v_mfma_f32_16x16x32_bf16 v[64:67], v[128:131], v[208:211], v[64:67]
s_waitcnt lgkmcnt(10)
s_waitcnt vmcnt(8)
v_mfma_f32_16x16x32_bf16 v[48:51], v[72:75], v[212:215], v[48:51]
ds_read_b64_tr_b16 v[112:113], v27 offset:15360
ds_read_b64_tr_b16 v[114:115], v28 offset:15360
ds_read_b64_tr_b16 v[116:117], v27 offset:15392
v_mfma_f32_16x16x32_bf16 v[52:55], v[76:79], v[212:215], v[52:55]
ds_read_b64_tr_b16 v[118:119], v28 offset:15392
ds_read_b64_tr_b16 v[120:121], v27 offset:15424
v_mfma_f32_16x16x32_bf16 v[56:59], v[80:83], v[212:215], v[56:59]
ds_read_b64_tr_b16 v[122:123], v28 offset:15424
ds_read_b64_tr_b16 v[124:125], v27 offset:15456
ds_read_b64_tr_b16 v[126:127], v28 offset:15456
v_mfma_f32_16x16x32_bf16 v[60:63], v[84:87], v[212:215], v[60:63]
ds_read_b64_tr_b16 v[128:129], v27 offset:15488
ds_read_b64_tr_b16 v[130:131], v28 offset:15488
v_mfma_f32_16x16x32_bf16 v[64:67], v[88:91], v[212:215], v[64:67]
s_waitcnt lgkmcnt(0)
s_barrier
s_waitcnt vmcnt(7)
v_mfma_f32_16x16x32_bf16 v[48:51], v[92:95], v[216:219], v[48:51]
ds_read_b64_tr_b16 v[72:73], v24 offset:0
ds_read_b64_tr_b16 v[74:75], v25 offset:0
ds_read_b64_tr_b16 v[76:77], v24 offset:32
v_mfma_f32_16x16x32_bf16 v[52:55], v[96:99], v[216:219], v[52:55]
ds_read_b64_tr_b16 v[78:79], v25 offset:32
ds_read_b64_tr_b16 v[80:81], v24 offset:64
v_mfma_f32_16x16x32_bf16 v[56:59], v[100:103], v[216:219], v[56:59]
ds_read_b64_tr_b16 v[82:83], v25 offset:64
ds_read_b64_tr_b16 v[84:85], v24 offset:96
ds_read_b64_tr_b16 v[86:87], v25 offset:96
v_mfma_f32_16x16x32_bf16 v[60:63], v[104:107], v[216:219], v[60:63]
ds_read_b64_tr_b16 v[88:89], v24 offset:128
ds_read_b64_tr_b16 v[90:91], v25 offset:128
v_mfma_f32_16x16x32_bf16 v[64:67], v[108:111], v[216:219], v[64:67]
s_waitcnt lgkmcnt(10)
s_waitcnt vmcnt(6)
v_mfma_f32_16x16x32_bf16 v[48:51], v[112:115], v[220:223], v[48:51]
ds_read_b64_tr_b16 v[92:93], v24 offset:5120
ds_read_b64_tr_b16 v[94:95], v25 offset:5120
ds_read_b64_tr_b16 v[96:97], v24 offset:5152
v_mfma_f32_16x16x32_bf16 v[52:55], v[116:119], v[220:223], v[52:55]
ds_read_b64_tr_b16 v[98:99], v25 offset:5152
ds_read_b64_tr_b16 v[100:101], v24 offset:5184
v_mfma_f32_16x16x32_bf16 v[56:59], v[120:123], v[220:223], v[56:59]
ds_read_b64_tr_b16 v[102:103], v25 offset:5184
ds_read_b64_tr_b16 v[104:105], v24 offset:5216
ds_read_b64_tr_b16 v[106:107], v25 offset:5216
v_mfma_f32_16x16x32_bf16 v[60:63], v[124:127], v[220:223], v[60:63]
ds_read_b64_tr_b16 v[108:109], v24 offset:5248
ds_read_b64_tr_b16 v[110:111], v25 offset:5248
v_mfma_f32_16x16x32_bf16 v[64:67], v[128:131], v[220:223], v[64:67]
s_waitcnt lgkmcnt(10)
s_waitcnt vmcnt(5)
v_mfma_f32_16x16x32_bf16 v[48:51], v[72:75], v[160:163], v[48:51]
ds_read_b64_tr_b16 v[112:113], v24 offset:10240
ds_read_b64_tr_b16 v[114:115], v25 offset:10240
ds_read_b64_tr_b16 v[116:117], v24 offset:10272
v_mfma_f32_16x16x32_bf16 v[52:55], v[76:79], v[160:163], v[52:55]
ds_read_b64_tr_b16 v[118:119], v25 offset:10272
ds_read_b64_tr_b16 v[120:121], v24 offset:10304
v_mfma_f32_16x16x32_bf16 v[56:59], v[80:83], v[160:163], v[56:59]
ds_read_b64_tr_b16 v[122:123], v25 offset:10304
ds_read_b64_tr_b16 v[124:125], v24 offset:10336
ds_read_b64_tr_b16 v[126:127], v25 offset:10336
v_mfma_f32_16x16x32_bf16 v[60:63], v[84:87], v[160:163], v[60:63]
ds_read_b64_tr_b16 v[128:129], v24 offset:10368
ds_read_b64_tr_b16 v[130:131], v25 offset:10368
v_mfma_f32_16x16x32_bf16 v[64:67], v[88:91], v[160:163], v[64:67]
s_waitcnt lgkmcnt(10)
s_waitcnt vmcnt(4)
v_mfma_f32_16x16x32_bf16 v[48:51], v[92:95], v[164:167], v[48:51]
ds_read_b64_tr_b16 v[72:73], v24 offset:15360
ds_read_b64_tr_b16 v[74:75], v25 offset:15360
ds_read_b64_tr_b16 v[76:77], v24 offset:15392
v_mfma_f32_16x16x32_bf16 v[52:55], v[96:99], v[164:167], v[52:55]
ds_read_b64_tr_b16 v[78:79], v25 offset:15392
ds_read_b64_tr_b16 v[80:81], v24 offset:15424
v_mfma_f32_16x16x32_bf16 v[56:59], v[100:103], v[164:167], v[56:59]
ds_read_b64_tr_b16 v[82:83], v25 offset:15424
ds_read_b64_tr_b16 v[84:85], v24 offset:15456
ds_read_b64_tr_b16 v[86:87], v25 offset:15456
v_mfma_f32_16x16x32_bf16 v[60:63], v[104:107], v[164:167], v[60:63]
ds_read_b64_tr_b16 v[88:89], v24 offset:15488
ds_read_b64_tr_b16 v[90:91], v25 offset:15488
v_mfma_f32_16x16x32_bf16 v[64:67], v[108:111], v[164:167], v[64:67]
s_waitcnt lgkmcnt(0)
s_barrier
s_waitcnt vmcnt(3)
v_mfma_f32_16x16x32_bf16 v[48:51], v[112:115], v[168:171], v[48:51]
ds_read_b64_tr_b16 v[92:93], v24 offset:20480
ds_read_b64_tr_b16 v[94:95], v25 offset:20480
ds_read_b64_tr_b16 v[96:97], v24 offset:20512
v_mfma_f32_16x16x32_bf16 v[52:55], v[116:119], v[168:171], v[52:55]
ds_read_b64_tr_b16 v[98:99], v25 offset:20512
ds_read_b64_tr_b16 v[100:101], v24 offset:20544
v_mfma_f32_16x16x32_bf16 v[56:59], v[120:123], v[168:171], v[56:59]
ds_read_b64_tr_b16 v[102:103], v25 offset:20544
ds_read_b64_tr_b16 v[104:105], v24 offset:20576
ds_read_b64_tr_b16 v[106:107], v25 offset:20576
v_mfma_f32_16x16x32_bf16 v[60:63], v[124:127], v[168:171], v[60:63]
ds_read_b64_tr_b16 v[108:109], v24 offset:20608
ds_read_b64_tr_b16 v[110:111], v25 offset:20608
v_mfma_f32_16x16x32_bf16 v[64:67], v[128:131], v[168:171], v[64:67]
s_waitcnt lgkmcnt(10)
s_waitcnt vmcnt(2)
v_mfma_f32_16x16x32_bf16 v[48:51], v[72:75], v[172:175], v[48:51]
ds_read_b64_tr_b16 v[112:113], v24 offset:25600
ds_read_b64_tr_b16 v[114:115], v25 offset:25600
ds_read_b64_tr_b16 v[116:117], v24 offset:25632
v_mfma_f32_16x16x32_bf16 v[52:55], v[76:79], v[172:175], v[52:55]
ds_read_b64_tr_b16 v[118:119], v25 offset:25632
ds_read_b64_tr_b16 v[120:121], v24 offset:25664
v_mfma_f32_16x16x32_bf16 v[56:59], v[80:83], v[172:175], v[56:59]
ds_read_b64_tr_b16 v[122:123], v25 offset:25664
ds_read_b64_tr_b16 v[124:125], v24 offset:25696
ds_read_b64_tr_b16 v[126:127], v25 offset:25696
v_mfma_f32_16x16x32_bf16 v[60:63], v[84:87], v[172:175], v[60:63]
ds_read_b64_tr_b16 v[128:129], v24 offset:25728
ds_read_b64_tr_b16 v[130:131], v25 offset:25728
v_mfma_f32_16x16x32_bf16 v[64:67], v[88:91], v[172:175], v[64:67]
s_waitcnt lgkmcnt(10)
s_waitcnt vmcnt(1)
v_mfma_f32_16x16x32_bf16 v[48:51], v[92:95], v[176:179], v[48:51]
v_mfma_f32_16x16x32_bf16 v[52:55], v[96:99], v[176:179], v[52:55]
v_mfma_f32_16x16x32_bf16 v[56:59], v[100:103], v[176:179], v[56:59]
v_mfma_f32_16x16x32_bf16 v[60:63], v[104:107], v[176:179], v[60:63]
v_mfma_f32_16x16x32_bf16 v[64:67], v[108:111], v[176:179], v[64:67]
s_waitcnt lgkmcnt(0)
s_waitcnt vmcnt(0)
v_mfma_f32_16x16x32_bf16 v[48:51], v[112:115], v[180:183], v[48:51]
v_mfma_f32_16x16x32_bf16 v[52:55], v[116:119], v[180:183], v[52:55]
v_mfma_f32_16x16x32_bf16 v[56:59], v[120:123], v[180:183], v[56:59]
v_mfma_f32_16x16x32_bf16 v[60:63], v[124:127], v[180:183], v[60:63]
v_mfma_f32_16x16x32_bf16 v[64:67], v[128:131], v[180:183], v[64:67]
s_barrier
s_nop 7
s_nop 7
v_cvt_pk_bf16_f32 v72, v48, v49
v_cvt_pk_bf16_f32 v73, v50, v51
v_lshlrev_b32 v74, 16, v72
v_and_b32 v75, 0xffff0000, v72
v_lshlrev_b32 v76, 16, v10
v_and_b32 v77, 0xffff0000, v10
v_add_f32 v74, v74, v76
v_add_f32 v75, v75, v77
v_cvt_pk_bf16_f32 v10, v74, v75
v_lshlrev_b32 v74, 16, v73
v_and_b32 v75, 0xffff0000, v73
v_lshlrev_b32 v76, 16, v11
v_and_b32 v77, 0xffff0000, v11
v_add_f32 v74, v74, v76
v_add_f32 v75, v75, v77
v_cvt_pk_bf16_f32 v11, v74, v75
v_cvt_pk_bf16_f32 v80, v52, v53
v_cvt_pk_bf16_f32 v81, v54, v55
v_lshlrev_b32 v82, 16, v80
v_and_b32 v83, 0xffff0000, v80
v_lshlrev_b32 v84, 16, v12
v_and_b32 v85, 0xffff0000, v12
v_add_f32 v82, v82, v84
v_add_f32 v83, v83, v85
v_cvt_pk_bf16_f32 v12, v82, v83
v_lshlrev_b32 v82, 16, v81
v_and_b32 v83, 0xffff0000, v81
v_lshlrev_b32 v84, 16, v13
v_and_b32 v85, 0xffff0000, v13
v_add_f32 v82, v82, v84
v_add_f32 v83, v83, v85
v_cvt_pk_bf16_f32 v13, v82, v83
v_cvt_pk_bf16_f32 v88, v56, v57
v_cvt_pk_bf16_f32 v89, v58, v59
v_lshlrev_b32 v90, 16, v88
v_and_b32 v91, 0xffff0000, v88
v_lshlrev_b32 v92, 16, v14
v_and_b32 v93, 0xffff0000, v14
v_add_f32 v90, v90, v92
v_add_f32 v91, v91, v93
v_cvt_pk_bf16_f32 v14, v90, v91
v_lshlrev_b32 v90, 16, v89
v_and_b32 v91, 0xffff0000, v89
v_lshlrev_b32 v92, 16, v15
v_and_b32 v93, 0xffff0000, v15
v_add_f32 v90, v90, v92
v_add_f32 v91, v91, v93
v_cvt_pk_bf16_f32 v15, v90, v91
v_cvt_pk_bf16_f32 v96, v60, v61
v_cvt_pk_bf16_f32 v97, v62, v63
v_lshlrev_b32 v98, 16, v96
v_and_b32 v99, 0xffff0000, v96
v_lshlrev_b32 v100, 16, v16
v_and_b32 v101, 0xffff0000, v16
v_add_f32 v98, v98, v100
v_add_f32 v99, v99, v101
v_cvt_pk_bf16_f32 v16, v98, v99
v_lshlrev_b32 v98, 16, v97
v_and_b32 v99, 0xffff0000, v97
v_lshlrev_b32 v100, 16, v17
v_and_b32 v101, 0xffff0000, v17
v_add_f32 v98, v98, v100
v_add_f32 v99, v99, v101
v_cvt_pk_bf16_f32 v17, v98, v99
v_cvt_pk_bf16_f32 v104, v64, v65
v_cvt_pk_bf16_f32 v105, v66, v67
v_lshlrev_b32 v106, 16, v104
v_and_b32 v107, 0xffff0000, v104
v_lshlrev_b32 v108, 16, v18
v_and_b32 v109, 0xffff0000, v18
v_add_f32 v106, v106, v108
v_add_f32 v107, v107, v109
v_cvt_pk_bf16_f32 v18, v106, v107
v_lshlrev_b32 v106, 16, v105
v_and_b32 v107, 0xffff0000, v105
v_lshlrev_b32 v108, 16, v19
v_and_b32 v109, 0xffff0000, v19
v_add_f32 v106, v106, v108
v_add_f32 v107, v107, v109
v_cvt_pk_bf16_f32 v19, v106, v107
s_cmp_eq_u32 s43, 0
s_cbranch_scc0 LB128
s_mov_b32 s48, 12320768
buffer_store_dwordx4 v[10:13], v22, s[32:35], s48 offen sc0 sc1
buffer_store_dwordx4 v[14:17], v22, s[32:35], s48 offen offset:1024 sc0 sc1
buffer_store_dwordx2 v[18:19], v23, s[32:35], s48 offen sc0 sc1
v_mov_b32 v114, 0x3f803f80
v_mov_b32 v112, 0
v_mov_b32 v113, 0
v_dot2_f32_bf16 v112, v10, v114, v112
v_dot2_f32_bf16 v113, v10, v10, v113
v_dot2_f32_bf16 v112, v11, v114, v112
v_dot2_f32_bf16 v113, v11, v11, v113
v_dot2_f32_bf16 v112, v12, v114, v112
v_dot2_f32_bf16 v113, v12, v12, v113
v_dot2_f32_bf16 v112, v13, v114, v112
v_dot2_f32_bf16 v113, v13, v13, v113
v_dot2_f32_bf16 v112, v14, v114, v112
v_dot2_f32_bf16 v113, v14, v14, v113
v_dot2_f32_bf16 v112, v15, v114, v112
v_dot2_f32_bf16 v113, v15, v15, v113
v_dot2_f32_bf16 v112, v16, v114, v112
v_dot2_f32_bf16 v113, v16, v16, v113
v_dot2_f32_bf16 v112, v17, v114, v112
v_dot2_f32_bf16 v113, v17, v17, v113
v_dot2_f32_bf16 v112, v18, v114, v112
v_dot2_f32_bf16 v113, v18, v18, v113
v_dot2_f32_bf16 v112, v19, v114, v112
v_dot2_f32_bf16 v113, v19, v19, v113
s_nop 2
v_mov_b32 v114, v112
s_nop 1
v_permlane32_swap_b32 v112, v114
s_nop 1
v_add_f32 v112, v112, v114
v_mov_b32 v114, v112
s_nop 1
v_permlane16_swap_b32 v112, v114
s_nop 1
v_add_f32 v112, v112, v114
v_mov_b32 v114, v113
s_nop 1
v_permlane32_swap_b32 v113, v114
s_nop 1
v_add_f32 v113, v113, v114
v_mov_b32 v114, v113
s_nop 1
v_permlane16_swap_b32 v113, v114
s_nop 1
v_add_f32 v113, v113, v114
s_lshr_b32 s48, s42, 3
s_lshl_b32 s48, s48, 2
s_lshl_b32 s55, s41, 3
s_add_u32 s55, s55, s48
s_add_u32 s55, s55, s40
s_lshl_b32 s55, s55, 10
s_lshr_b32 s48, s49, 1
s_lshl_b32 s48, s48, 8
s_add_u32 s55, s55, s48
s_lshl_b32 s48, s50, 3
s_add_u32 s55, s55, s48
s_add_u32 s55, s55, 27394048
v_lshlrev_b32 v114, 4, v1
s_mov_b64 exec, 0xffff
buffer_store_dwordx2 v[112:113], v114, s[32:35], s55 offen sc0 sc1
s_mov_b64 exec, -1
s_waitcnt vmcnt(0)
s_barrier
s_cmp_lg_u32 s40, 0
s_cbranch_scc1 LB130
s_lshl_b32 s48, s43, 2
s_add_u32 s48, s48, 3
s_add_u32 s55, s44, s48
s_add_u32 s55, s55, s81
s_lshl_b32 s48, s48, 11
s_add_u32 s48, s48, s57
s_lshl_b32 s56, s42, 2
s_add_u32 s48, s48, s56
v_mov_b32 v3, s48
v_mov_b32 v4, s55
s_mov_b64 s[58:59], exec
s_mov_b64 exec, 1
buffer_store_dword v4, v3, s[32:35], 0 offen sc0 sc1
s_mov_b64 exec, s[58:59]
LB130:
s_mov_b32 s43, 1
s_branch PAIRLOOP
LB128:
buffer_store_dwordx2 v[10:11], v20, s[28:31], 0 offen offset:0
buffer_store_dwordx2 v[12:13], v20, s[28:31], 0 offen offset:32
buffer_store_dwordx2 v[14:15], v20, s[28:31], 0 offen offset:64
buffer_store_dwordx2 v[16:17], v20, s[28:31], 0 offen offset:96
buffer_store_dwordx2 v[18:19], v21, s[28:31], 0 offen
s_waitcnt vmcnt(0)
END:
s_endpgm
LOADER:
s_lshr_b32 s48, s40, 1
s_xor_b32 s48, s48, s40
s_and_b32 s48, s48, 1
s_lshl_b32 s48, s48, 2
v_or_b32 v3, s48, v2
v_lshrrev_b32 v4, 1, v1
v_xor_b32 v4, v4, v3
v_lshlrev_b32 v4, 1, v4
v_and_b32 v5, 1, v1
v_or_b32 v4, v4, v5
v_min_u32 v4, 14, v4
v_mul_u32_u24 v5, 52, v4
v_lshrrev_b32 v5, 8, v5
v_mul_u32_u24 v5, 600, v5
v_lshlrev_b32 v4, 3, v4
v_add_u32 v4, v4, v5
s_mul_i32 s48, s42, 40
v_add_u32 v4, s48, v4
v_lshlrev_b32 v4, 1, v4
s_lshl_b32 s48, s40, 2
v_add_u32 v5, s48, v2
v_mul_u32_u24 v5, 3840, v5
v_add_u32 v40, v4, v5
s_mov_b32 s76, s12
s_mov_b32 s77, s13
s_mov_b32 s78, s14
s_mov_b32 s79, s15
s_mov_b32 s74, 0
s_mov_b32 s75, 61440
s_add_u32 m0, s45, 0
buffer_load_dwordx4 v40, s[76:79], s74 offen sc1 lds
s_add_u32 s74, s74, s75
s_add_u32 m0, s45, 4096
buffer_load_dwordx4 v40, s[76:79], s74 offen sc1 lds
s_add_u32 s74, s74, s75
s_add_u32 m0, s45, 8192
buffer_load_dwordx4 v40, s[76:79], s74 offen sc1 lds
s_add_u32 s74, s74, s75
s_add_u32 m0, s45, 12288
buffer_load_dwordx4 v40, s[76:79], s74 offen sc1 lds
s_add_u32 s74, s74, s75
s_add_u32 m0, s45, 16384
buffer_load_dwordx4 v40, s[76:79], s74 offen sc1 lds
s_add_u32 s74, s74, s75
s_add_u32 m0, s45, 20480
buffer_load_dwordx4 v40, s[76:79], s74 offen sc1 lds
s_add_u32 s74, s74, s75
s_add_u32 m0, s45, 24576
buffer_load_dwordx4 v40, s[76:79], s74 offen sc1 lds
s_add_u32 s74, s74, s75
s_add_u32 m0, s45, 28672
buffer_load_dwordx4 v40, s[76:79], s74 offen sc1 lds
s_add_u32 s74, s74, s75
s_add_u32 m0, s45, 32768
buffer_load_dwordx4 v40, s[76:79], s74 offen sc1 lds
s_add_u32 s74, s74, s75
s_add_u32 m0, s45, 36864
buffer_load_dwordx4 v40, s[76:79], s74 offen sc1 lds
s_add_u32 s74, s74, s75
s_add_u32 m0, s45, 40960
buffer_load_dwordx4 v40, s[76:79], s74 offen sc1 lds
s_add_u32 s74, s74, s75
s_add_u32 m0, s45, 45056
buffer_load_dwordx4 v40, s[76:79], s74 offen sc1 lds
s_add_u32 s74, s74, s75
s_add_u32 m0, s45, 49152
buffer_load_dwordx4 v40, s[76:79], s74 offen sc1 lds
s_add_u32 s74, s74, s75
s_add_u32 m0, s45, 53248
buffer_load_dwordx4 v40, s[76:79], s74 offen sc1 lds
s_add_u32 s74, s74, s75
s_add_u32 m0, s45, 57344
buffer_load_dwordx4 v40, s[76:79], s74 offen sc1 lds
s_add_u32 s74, s74, s75
s_add_u32 m0, s45, 61440
buffer_load_dwordx4 v40, s[76:79], s74 offen sc1 lds
s_add_u32 s74, s74, s75
PAIRLOOPL:
s_mul_i32 s51, s43, 14942208
s_add_u32 s52, s51, 2621440
s_add_u32 s53, s51, 5242880
s_lshl_b32 s64, s41, 3
s_lshl_b32 s48, s40, 1
s_add_u32 s65, s64, s48
s_sub_u32 s64, s64, 1
s_max_i32 s64, s64, 0
s_mul_i32 s65, s65, 20480
s_mul_i32 s64, s64, 20480
s_lshl_b32 s56, s40, 14
s_add_u32 s56, s56, 81920
s_cmp_eq_u32 s43, 0
s_cbranch_scc0 LB13
s_mov_b32 s36, s8
s_mov_b32 s37, s9
s_mov_b32 s38, s10
s_mov_b32 s39, s11
s_mov_b32 s46, 128
v_lshrrev_b32 v3, 3, v0
v_lshrrev_b32 v4, 1, v3
v_and_b32 v5, 7, v0
v_xor_b32 v4, v4, v5
v_and_b32 v4, 7, v4
v_lshlrev_b32 v4, 4, v4
v_mul_u32_u24 v3, 1280, v3
v_add_u32 v3, v3, v4
v_add_u32 v41, s65, v3
v_lshrrev_b32 v3, 3, v0
v_add_u32 v3, 8, v3
v_lshrrev_b32 v4, 1, v3
v_and_b32 v5, 7, v0
v_xor_b32 v4, v4, v5
v_and_b32 v4, 7, v4
v_lshlrev_b32 v4, 4, v4
v_mul_u32_u24 v3, 1280, v3
v_add_u32 v3, v3, v4
v_add_u32 v42, s65, v3
v_lshrrev_b32 v3, 3, v0
v_and_b32 v3, 3, v3
s_lshl_b32 s48, s40, 2
v_add_u32 v3, s48, v3
v_lshrrev_b32 v4, 1, v3
v_and_b32 v5, 7, v0
v_xor_b32 v4, v4, v5
v_and_b32 v4, 7, v4
v_lshlrev_b32 v4, 4, v4
v_mul_u32_u24 v3, 1280, v3
v_add_u32 v3, v3, v4
v_add_u32 v43, s64, v3
v_lshrrev_b32 v4, 1, v1
v_add_u32 v5, 0, v2
v_xor_b32 v4, v4, v5
v_lshlrev_b32 v4, 4, v4
v_lshlrev_b32 v3, 7, v1
v_add_u32 v44, v3, v4
v_lshrrev_b32 v4, 1, v1
v_add_u32 v5, 4, v2
v_xor_b32 v4, v4, v5
v_lshlrev_b32 v4, 4, v4
v_lshlrev_b32 v3, 7, v1
v_add_u32 v45, v3, v4
s_branch LB14
LB13:
s_add_u32 s36, s32, 12320768
s_addc_u32 s37, s33, 0
s_mov_b32 s38, 2621440
s_mov_b32 s39, 0x00020000
s_mov_b32 s46, 2048
v_lshlrev_b32 v3, 4, v0
v_add_u32 v41, s65, v3
v_add_u32 v42, 1024, v41
s_lshl_b32 s48, s40, 9
s_add_u32 s64, s64, s48
v_add_u32 v43, s64, v3
v_mov_b32 v44, v3
v_add_u32 v45, 1024, v3
LB14:
v_add_u32 v46, 147456, v44
v_add_u32 v47, 147456, v45
v_add_u32 v44, s56, v44
v_add_u32 v45, s56, v45
s_lshl_b32 s67, s40, 14
s_lshl_b32 s68, s40, 9
s_cmp_eq_u32 s43, 0
s_cbranch_scc1 LB16
s_barrier
LB16:
s_add_u32 m0, s67, 81920
s_mul_i32 s47, s46, 0
buffer_load_dwordx4 v41, s[36:39], s47 offen sc1 lds
s_add_u32 m0, s67, 82944
s_mul_i32 s47, s46, 0
buffer_load_dwordx4 v42, s[36:39], s47 offen sc1 lds
s_add_u32 m0, s67, 90112
s_mul_i32 s47, s46, 0
s_add_u32 s47, s47, 20480
buffer_load_dwordx4 v41, s[36:39], s47 offen sc1 lds
s_add_u32 m0, s67, 91136
s_mul_i32 s47, s46, 0
s_add_u32 s47, s47, 20480
buffer_load_dwordx4 v42, s[36:39], s47 offen sc1 lds
s_add_u32 m0, s68, 147456
s_mul_i32 s47, s46, 0
s_mov_b32 exec_hi, 0
buffer_load_dwordx4 v43, s[36:39], s47 offen sc1 lds
s_mov_b32 exec_hi, -1
s_add_u32 m0, s67, 83968
s_mul_i32 s47, s46, 1
buffer_load_dwordx4 v41, s[36:39], s47 offen sc1 lds
s_add_u32 m0, s67, 84992
s_mul_i32 s47, s46, 1
buffer_load_dwordx4 v42, s[36:39], s47 offen sc1 lds
s_add_u32 m0, s67, 92160
s_mul_i32 s47, s46, 1
s_add_u32 s47, s47, 20480
buffer_load_dwordx4 v41, s[36:39], s47 offen sc1 lds
s_add_u32 m0, s67, 93184
s_mul_i32 s47, s46, 1
s_add_u32 s47, s47, 20480
buffer_load_dwordx4 v42, s[36:39], s47 offen sc1 lds
s_add_u32 m0, s68, 149504
s_mul_i32 s47, s46, 1
s_mov_b32 exec_hi, 0
buffer_load_dwordx4 v43, s[36:39], s47 offen sc1 lds
s_mov_b32 exec_hi, -1
s_add_u32 m0, s67, 86016
s_mul_i32 s47, s46, 2
buffer_load_dwordx4 v41, s[36:39], s47 offen sc1 lds
s_add_u32 m0, s67, 87040
s_mul_i32 s47, s46, 2
buffer_load_dwordx4 v42, s[36:39], s47 offen sc1 lds
s_add_u32 m0, s67, 94208
s_mul_i32 s47, s46, 2
s_add_u32 s47, s47, 20480
buffer_load_dwordx4 v41, s[36:39], s47 offen sc1 lds
s_add_u32 m0, s67, 95232
s_mul_i32 s47, s46, 2
s_add_u32 s47, s47, 20480
buffer_load_dwordx4 v42, s[36:39], s47 offen sc1 lds
s_add_u32 m0, s68, 151552
s_mul_i32 s47, s46, 2
s_mov_b32 exec_hi, 0
buffer_load_dwordx4 v43, s[36:39], s47 offen sc1 lds
s_mov_b32 exec_hi, -1
s_add_u32 m0, s67, 88064
s_mul_i32 s47, s46, 3
buffer_load_dwordx4 v41, s[36:39], s47 offen sc1 lds
s_add_u32 m0, s67, 89088
s_mul_i32 s47, s46, 3
buffer_load_dwordx4 v42, s[36:39], s47 offen sc1 lds
s_add_u32 m0, s67, 96256
s_mul_i32 s47, s46, 3
s_add_u32 s47, s47, 20480
buffer_load_dwordx4 v41, s[36:39], s47 offen sc1 lds
s_add_u32 m0, s67, 97280
s_mul_i32 s47, s46, 3
s_add_u32 s47, s47, 20480
buffer_load_dwordx4 v42, s[36:39], s47 offen sc1 lds
s_add_u32 m0, s68, 153600
s_mul_i32 s47, s46, 3
s_mov_b32 exec_hi, 0
buffer_load_dwordx4 v43, s[36:39], s47 offen sc1 lds
s_mov_b32 exec_hi, -1
s_waitcnt vmcnt(32)
s_waitcnt vmcnt(15)
s_barrier
s_waitcnt vmcnt(10)
s_barrier
s_add_u32 m0, s67, 81920
s_mul_i32 s47, s46, 4
buffer_load_dwordx4 v41, s[36:39], s47 offen sc1 lds
s_add_u32 m0, s67, 82944
s_mul_i32 s47, s46, 4
buffer_load_dwordx4 v42, s[36:39], s47 offen sc1 lds
s_add_u32 m0, s67, 90112
s_mul_i32 s47, s46, 4
s_add_u32 s47, s47, 20480
buffer_load_dwordx4 v41, s[36:39], s47 offen sc1 lds
s_add_u32 m0, s67, 91136
s_mul_i32 s47, s46, 4
s_add_u32 s47, s47, 20480
buffer_load_dwordx4 v42, s[36:39], s47 offen sc1 lds
s_add_u32 m0, s68, 147456
s_mul_i32 s47, s46, 4
s_mov_b32 exec_hi, 0
buffer_load_dwordx4 v43, s[36:39], s47 offen sc1 lds
s_mov_b32 exec_hi, -1
s_add_u32 m0, s45, 0
buffer_load_dwordx4 v40, s[76:79], s74 offen sc1 lds
s_add_u32 s74, s74, s75
s_add_u32 m0, s45, 4096
buffer_load_dwordx4 v40, s[76:79], s74 offen sc1 lds
s_add_u32 s74, s74, s75
s_add_u32 m0, s45, 8192
buffer_load_dwordx4 v40, s[76:79], s74 offen sc1 lds
s_add_u32 s74, s74, s75
s_add_u32 m0, s45, 12288
buffer_load_dwordx4 v40, s[76:79], s74 offen sc1 lds
s_add_u32 s74, s74, s75
s_waitcnt vmcnt(14)
s_barrier
s_add_u32 m0, s67, 83968
s_mul_i32 s47, s46, 5
buffer_load_dwordx4 v41, s[36:39], s47 offen sc1 lds
s_add_u32 m0, s67, 84992
s_mul_i32 s47, s46, 5
buffer_load_dwordx4 v42, s[36:39], s47 offen sc1 lds
s_add_u32 m0, s67, 92160
s_mul_i32 s47, s46, 5
s_add_u32 s47, s47, 20480
buffer_load_dwordx4 v41, s[36:39], s47 offen sc1 lds
s_add_u32 m0, s67, 93184
s_mul_i32 s47, s46, 5
s_add_u32 s47, s47, 20480
buffer_load_dwordx4 v42, s[36:39], s47 offen sc1 lds
s_add_u32 m0, s68, 149504
s_mul_i32 s47, s46, 5
s_mov_b32 exec_hi, 0
buffer_load_dwordx4 v43, s[36:39], s47 offen sc1 lds
s_mov_b32 exec_hi, -1
s_add_u32 m0, s45, 16384
buffer_load_dwordx4 v40, s[76:79], s74 offen sc1 lds
s_add_u32 s74, s74, s75
s_add_u32 m0, s45, 20480
buffer_load_dwordx4 v40, s[76:79], s74 offen sc1 lds
s_add_u32 s74, s74, s75
s_add_u32 m0, s45, 24576
buffer_load_dwordx4 v40, s[76:79], s74 offen sc1 lds
s_add_u32 s74, s74, s75
s_add_u32 m0, s45, 28672
buffer_load_dwordx4 v40, s[76:79], s74 offen sc1 lds
s_add_u32 s74, s74, s75
s_waitcnt vmcnt(18)
s_barrier
s_add_u32 m0, s67, 86016
s_mul_i32 s47, s46, 6
buffer_load_dwordx4 v41, s[36:39], s47 offen sc1 lds
s_add_u32 m0, s67, 87040
s_mul_i32 s47, s46, 6
buffer_load_dwordx4 v42, s[36:39], s47 offen sc1 lds
s_add_u32 m0, s67, 94208
s_mul_i32 s47, s46, 6
s_add_u32 s47, s47, 20480
buffer_load_dwordx4 v41, s[36:39], s47 offen sc1 lds
s_add_u32 m0, s67, 95232
s_mul_i32 s47, s46, 6
s_add_u32 s47, s47, 20480
buffer_load_dwordx4 v42, s[36:39], s47 offen sc1 lds
s_add_u32 m0, s68, 151552
s_mul_i32 s47, s46, 6
s_mov_b32 exec_hi, 0
buffer_load_dwordx4 v43, s[36:39], s47 offen sc1 lds
s_mov_b32 exec_hi, -1
s_add_u32 m0, s45, 32768
buffer_load_dwordx4 v40, s[76:79], s74 offen sc1 lds
s_add_u32 s74, s74, s75
s_add_u32 m0, s45, 36864
buffer_load_dwordx4 v40, s[76:79], s74 offen sc1 lds
s_add_u32 s74, s74, s75
s_add_u32 m0, s45, 40960
buffer_load_dwordx4 v40, s[76:79], s74 offen sc1 lds
s_add_u32 s74, s74, s75
s_add_u32 m0, s45, 45056
buffer_load_dwordx4 v40, s[76:79], s74 offen sc1 lds
s_add_u32 s74, s74, s75
s_waitcnt vmcnt(18)
s_barrier
s_add_u32 m0, s67, 88064
s_mul_i32 s47, s46, 7
buffer_load_dwordx4 v41, s[36:39], s47 offen sc1 lds
s_add_u32 m0, s67, 89088
s_mul_i32 s47, s46, 7
buffer_load_dwordx4 v42, s[36:39], s47 offen sc1 lds
s_add_u32 m0, s67, 96256
s_mul_i32 s47, s46, 7
s_add_u32 s47, s47, 20480
buffer_load_dwordx4 v41, s[36:39], s47 offen sc1 lds
s_add_u32 m0, s67, 97280
s_mul_i32 s47, s46, 7
s_add_u32 s47, s47, 20480
buffer_load_dwordx4 v42, s[36:39], s47 offen sc1 lds
s_add_u32 m0, s68, 153600
s_mul_i32 s47, s46, 7
s_mov_b32 exec_hi, 0
buffer_load_dwordx4 v43, s[36:39], s47 offen sc1 lds
s_mov_b32 exec_hi, -1
s_add_u32 m0, s45, 49152
buffer_load_dwordx4 v40, s[76:79], s74 offen sc1 lds
s_add_u32 s74, s74, s75
s_add_u32 m0, s45, 53248
buffer_load_dwordx4 v40, s[76:79], s74 offen sc1 lds
s_add_u32 s74, s74, s75
s_add_u32 m0, s45, 57344
buffer_load_dwordx4 v40, s[76:79], s74 offen sc1 lds
s_add_u32 s74, s74, s75
s_add_u32 m0, s45, 61440
buffer_load_dwordx4 v40, s[76:79], s74 offen sc1 lds
s_add_u32 s74, s74, s75
s_waitcnt vmcnt(18)
s_barrier
s_add_u32 m0, s67, 81920
s_mul_i32 s47, s46, 8
buffer_load_dwordx4 v41, s[36:39], s47 offen sc1 lds
s_add_u32 m0, s67, 82944
s_mul_i32 s47, s46, 8
buffer_load_dwordx4 v42, s[36:39], s47 offen sc1 lds
s_add_u32 m0, s67, 90112
s_mul_i32 s47, s46, 8
s_add_u32 s47, s47, 20480
buffer_load_dwordx4 v41, s[36:39], s47 offen sc1 lds
s_add_u32 m0, s67, 91136
s_mul_i32 s47, s46, 8
s_add_u32 s47, s47, 20480
buffer_load_dwordx4 v42, s[36:39], s47 offen sc1 lds
s_add_u32 m0, s68, 147456
s_mul_i32 s47, s46, 8
s_mov_b32 exec_hi, 0
buffer_load_dwordx4 v43, s[36:39], s47 offen sc1 lds
s_mov_b32 exec_hi, -1
s_add_u32 m0, s45, 0
buffer_load_dwordx4 v40, s[76:79], s74 offen sc1 lds
s_add_u32 s74, s74, s75
s_add_u32 m0, s45, 4096
buffer_load_dwordx4 v40, s[76:79], s74 offen sc1 lds
s_add_u32 s74, s74, s75
s_add_u32 m0, s45, 8192
buffer_load_dwordx4 v40, s[76:79], s74 offen sc1 lds
s_add_u32 s74, s74, s75
s_add_u32 m0, s45, 12288
buffer_load_dwordx4 v40, s[76:79], s74 offen sc1 lds
s_add_u32 s74, s74, s75
s_waitcnt vmcnt(18)
s_barrier
s_add_u32 m0, s67, 83968
s_mul_i32 s47, s46, 9
buffer_load_dwordx4 v41, s[36:39], s47 offen sc1 lds
s_add_u32 m0, s67, 84992
s_mul_i32 s47, s46, 9
buffer_load_dwordx4 v42, s[36:39], s47 offen sc1 lds
s_add_u32 m0, s67, 92160
s_mul_i32 s47, s46, 9
s_add_u32 s47, s47, 20480
buffer_load_dwordx4 v41, s[36:39], s47 offen sc1 lds
s_add_u32 m0, s67, 93184
s_mul_i32 s47, s46, 9
s_add_u32 s47, s47, 20480
buffer_load_dwordx4 v42, s[36:39], s47 offen sc1 lds
s_add_u32 m0, s68, 149504
s_mul_i32 s47, s46, 9
s_mov_b32 exec_hi, 0
buffer_load_dwordx4 v43, s[36:39], s47 offen sc1 lds
s_mov_b32 exec_hi, -1
s_add_u32 m0, s45, 16384
buffer_load_dwordx4 v40, s[76:79], s74 offen sc1 lds
s_add_u32 s74, s74, s75
s_add_u32 m0, s45, 20480
buffer_load_dwordx4 v40, s[76:79], s74 offen sc1 lds
s_add_u32 s74, s74, s75
s_add_u32 m0, s45, 24576
buffer_load_dwordx4 v40, s[76:79], s74 offen sc1 lds
s_add_u32 s74, s74, s75
s_add_u32 m0, s45, 28672
buffer_load_dwordx4 v40, s[76:79], s74 offen sc1 lds
s_add_u32 s74, s74, s75
s_waitcnt vmcnt(18)
s_barrier
s_waitcnt vmcnt(9)
s_barrier
s_waitcnt vmcnt(0)
s_barrier
s_barrier
s_cmp_eq_u32 s43, 0
s_cbranch_scc0 LB49
s_barrier
LB49:
s_cmp_eq_u32 s43, 0
s_cbranch_scc0 LB50
v_and_b32 v3, 31, v0
v_lshlrev_b32 v3, 2, v3
v_add_u32 v3, 128, v3
s_mov_b32 s56, 0
LB51:
buffer_load_dword v4, v3, s[60:63], 0 offen sc0 sc1
s_waitcnt vmcnt(0)
v_cmp_ne_u32 vcc, 8, v4
s_cbranch_vccz LB50
s_add_u32 s56, s56, 1
s_cmp_lt_u32 s56, 20000
s_cbranch_scc1 LB51
LB50:
s_add_u32 m0, s45, 49152
s_add_u32 s47, s72, 0
buffer_load_dwordx4 v55, s[32:35], s47 offen sc1 lds
s_add_u32 m0, s45, 53248
s_add_u32 s47, s72, 4096
buffer_load_dwordx4 v55, s[32:35], s47 offen sc1 lds
s_add_u32 m0, s45, 57344
s_add_u32 s47, s72, 8192
buffer_load_dwordx4 v55, s[32:35], s47 offen sc1 lds
s_add_u32 m0, s45, 61440
s_add_u32 s47, s72, 12288
buffer_load_dwordx4 v55, s[32:35], s47 offen sc1 lds
s_add_u32 m0, s45, 65536
s_add_u32 s47, s72, 16384
buffer_load_dwordx4 v55, s[32:35], s47 offen sc1 lds
s_add_u32 m0, s45, 69632
s_add_u32 s47, s72, 20480
buffer_load_dwordx4 v55, s[32:35], s47 offen sc1 lds
s_add_u32 m0, s45, 73728
s_add_u32 s47, s72, 24576
buffer_load_dwordx4 v55, s[32:35], s47 offen sc1 lds
s_add_u32 m0, s45, 77824
s_add_u32 s47, s72, 28672
buffer_load_dwordx4 v55, s[32:35], s47 offen sc1 lds
s_add_u32 m0, s45, 81920
s_add_u32 s47, s72, 32768
buffer_load_dwordx4 v55, s[32:35], s47 offen sc1 lds
s_add_u32 m0, s45, 86016
s_add_u32 s47, s72, 36864
buffer_load_dwordx4 v55, s[32:35], s47 offen sc1 lds
s_add_u32 m0, s45, 90112
s_add_u32 s47, s72, 40960
buffer_load_dwordx4 v55, s[32:35], s47 offen sc1 lds
s_add_u32 m0, s45, 94208
s_add_u32 s47, s72, 45056
buffer_load_dwordx4 v55, s[32:35], s47 offen sc1 lds
s_add_u32 m0, s45, 98304
s_add_u32 s47, s72, 49152
buffer_load_dwordx4 v55, s[32:35], s47 offen sc1 lds
s_add_u32 m0, s45, 102400
s_add_u32 s47, s72, 53248
buffer_load_dwordx4 v55, s[32:35], s47 offen sc1 lds
s_add_u32 m0, s45, 106496
s_add_u32 s47, s72, 57344
buffer_load_dwordx4 v55, s[32:35], s47 offen sc1 lds
s_add_u32 m0, s45, 110592
s_add_u32 s47, s72, 61440
buffer_load_dwordx4 v55, s[32:35], s47 offen sc1 lds
s_add_u32 m0, s45, 114688
s_add_u32 s47, s72, 65536
buffer_load_dwordx4 v55, s[32:35], s47 offen sc1 lds
s_add_u32 m0, s45, 118784
s_add_u32 s47, s72, 69632
buffer_load_dwordx4 v55, s[32:35], s47 offen sc1 lds
s_add_u32 m0, s45, 122880
s_add_u32 s47, s72, 73728
buffer_load_dwordx4 v55, s[32:35], s47 offen sc1 lds
s_add_u32 m0, s45, 126976
s_add_u32 s47, s72, 77824
buffer_load_dwordx4 v55, s[32:35], s47 offen sc1 lds
s_add_u32 m0, s45, 131072
s_add_u32 s47, s72, 81920
buffer_load_dwordx4 v55, s[32:35], s47 offen sc1 lds
s_add_u32 m0, s45, 135168
s_add_u32 s47, s72, 86016
buffer_load_dwordx4 v55, s[32:35], s47 offen sc1 lds
s_add_u32 m0, s45, 139264
s_add_u32 s47, s72, 90112
buffer_load_dwordx4 v55, s[32:35], s47 offen sc1 lds
s_add_u32 m0, s45, 143360
s_add_u32 s47, s72, 94208
buffer_load_dwordx4 v55, s[32:35], s47 offen sc1 lds
s_add_u32 m0, s45, 147456
s_add_u32 s47, s72, 98304
buffer_load_dwordx4 v55, s[32:35], s47 offen sc1 lds
s_barrier
s_barrier
s_barrier
s_waitcnt vmcnt(20)
s_barrier
s_waitcnt vmcnt(15)
s_barrier
s_waitcnt vmcnt(10)
s_barrier
s_waitcnt vmcnt(5)
s_barrier
s_waitcnt vmcnt(0)
s_barrier
s_barrier
s_add_u32 m0, s45, 0
s_add_u32 s47, s71, 0
buffer_load_dwordx4 v55, s[32:35], s47 offen sc1 lds
s_add_u32 m0, s45, 4096
s_add_u32 s47, s71, 4096
buffer_load_dwordx4 v55, s[32:35], s47 offen sc1 lds
s_add_u32 m0, s45, 8192
s_add_u32 s47, s71, 8192
buffer_load_dwordx4 v55, s[32:35], s47 offen sc1 lds
s_add_u32 m0, s45, 12288
s_add_u32 s47, s71, 12288
buffer_load_dwordx4 v55, s[32:35], s47 offen sc1 lds
s_add_u32 m0, s45, 16384
s_add_u32 s47, s71, 16384
buffer_load_dwordx4 v55, s[32:35], s47 offen sc1 lds
s_add_u32 m0, s45, 20480
s_add_u32 s47, s71, 20480
buffer_load_dwordx4 v55, s[32:35], s47 offen sc1 lds
s_add_u32 m0, s45, 24576
s_add_u32 s47, s71, 24576
buffer_load_dwordx4 v55, s[32:35], s47 offen sc1 lds
s_add_u32 m0, s45, 28672
s_add_u32 s47, s71, 28672
buffer_load_dwordx4 v55, s[32:35], s47 offen sc1 lds
s_add_u32 m0, s45, 32768
s_add_u32 s47, s71, 32768
buffer_load_dwordx4 v55, s[32:35], s47 offen sc1 lds
s_add_u32 m0, s45, 36864
s_add_u32 s47, s71, 36864
buffer_load_dwordx4 v55, s[32:35], s47 offen sc1 lds
s_add_u32 m0, s45, 40960
s_add_u32 s47, s71, 40960
buffer_load_dwordx4 v55, s[32:35], s47 offen sc1 lds
s_add_u32 m0, s45, 45056
s_add_u32 s47, s71, 45056
buffer_load_dwordx4 v55, s[32:35], s47 offen sc1 lds
s_add_u32 m0, s45, 49152
s_add_u32 s47, s71, 49152
buffer_load_dwordx4 v55, s[32:35], s47 offen sc1 lds
s_add_u32 m0, s45, 53248
s_add_u32 s47, s71, 53248
buffer_load_dwordx4 v55, s[32:35], s47 offen sc1 lds
s_add_u32 m0, s45, 57344
s_add_u32 s47, s71, 57344
buffer_load_dwordx4 v55, s[32:35], s47 offen sc1 lds
s_add_u32 m0, s45, 61440
s_add_u32 s47, s71, 61440
buffer_load_dwordx4 v55, s[32:35], s47 offen sc1 lds
s_barrier
s_barrier
s_waitcnt vmcnt(12)
s_barrier
s_waitcnt vmcnt(8)
s_barrier
s_add_u32 m0, s45, 0
s_add_u32 s47, s71, 65536
buffer_load_dwordx4 v55, s[32:35], s47 offen sc1 lds
s_add_u32 m0, s45, 4096
s_add_u32 s47, s71, 69632
buffer_load_dwordx4 v55, s[32:35], s47 offen sc1 lds
s_add_u32 m0, s45, 8192
s_add_u32 s47, s71, 73728
buffer_load_dwordx4 v55, s[32:35], s47 offen sc1 lds
s_add_u32 m0, s45, 12288
s_add_u32 s47, s71, 77824
buffer_load_dwordx4 v55, s[32:35], s47 offen sc1 lds
s_waitcnt vmcnt(8)
s_barrier
s_add_u32 m0, s45, 16384
s_add_u32 s47, s71, 81920
buffer_load_dwordx4 v55, s[32:35], s47 offen sc1 lds
s_add_u32 m0, s45, 20480
s_add_u32 s47, s71, 86016
buffer_load_dwordx4 v55, s[32:35], s47 offen sc1 lds
s_add_u32 m0, s45, 24576
s_add_u32 s47, s71, 90112
buffer_load_dwordx4 v55, s[32:35], s47 offen sc1 lds
s_add_u32 m0, s45, 28672
s_add_u32 s47, s71, 94208
buffer_load_dwordx4 v55, s[32:35], s47 offen sc1 lds
s_waitcnt vmcnt(8)
s_barrier
s_add_u32 m0, s45, 32768
s_add_u32 s47, s71, 98304
buffer_load_dwordx4 v55, s[32:35], s47 offen sc1 lds
s_add_u32 m0, s45, 36864
s_add_u32 s47, s71, 102400
buffer_load_dwordx4 v55, s[32:35], s47 offen sc1 lds
s_add_u32 m0, s45, 40960
s_add_u32 s47, s71, 106496
buffer_load_dwordx4 v55, s[32:35], s47 offen sc1 lds
s_add_u32 m0, s45, 45056
s_add_u32 s47, s71, 110592
buffer_load_dwordx4 v55, s[32:35], s47 offen sc1 lds
s_waitcnt vmcnt(8)
s_barrier
s_add_u32 m0, s45, 49152
s_add_u32 s47, s71, 114688
buffer_load_dwordx4 v55, s[32:35], s47 offen sc1 lds
s_add_u32 m0, s45, 53248
s_add_u32 s47, s71, 118784
buffer_load_dwordx4 v55, s[32:35], s47 offen sc1 lds
s_add_u32 m0, s45, 57344
s_add_u32 s47, s71, 122880
buffer_load_dwordx4 v55, s[32:35], s47 offen sc1 lds
s_add_u32 m0, s45, 61440
s_add_u32 s47, s71, 126976
buffer_load_dwordx4 v55, s[32:35], s47 offen sc1 lds
s_waitcnt vmcnt(8)
s_barrier
s_add_u32 m0, s45, 0
s_add_u32 s47, s71, 131072
buffer_load_dwordx4 v55, s[32:35], s47 offen sc1 lds
s_add_u32 m0, s45, 4096
s_add_u32 s47, s71, 135168
buffer_load_dwordx4 v55, s[32:35], s47 offen sc1 lds
s_add_u32 m0, s45, 8192
s_add_u32 s47, s71, 139264
buffer_load_dwordx4 v55, s[32:35], s47 offen sc1 lds
s_add_u32 m0, s45, 12288
s_add_u32 s47, s71, 143360
buffer_load_dwordx4 v55, s[32:35], s47 offen sc1 lds
s_waitcnt vmcnt(8)
s_barrier
s_add_u32 m0, s45, 16384
s_add_u32 s47, s71, 147456
buffer_load_dwordx4 v55, s[32:35], s47 offen sc1 lds
s_add_u32 m0, s45, 20480
s_add_u32 s47, s71, 151552
buffer_load_dwordx4 v55, s[32:35], s47 offen sc1 lds
s_add_u32 m0, s45, 24576
s_add_u32 s47, s71, 155648
buffer_load_dwordx4 v55, s[32:35], s47 offen sc1 lds
s_add_u32 m0, s45, 28672
s_add_u32 s47, s71, 159744
buffer_load_dwordx4 v55, s[32:35], s47 offen sc1 lds
s_waitcnt vmcnt(8)
s_barrier
s_waitcnt vmcnt(4)
s_barrier
s_waitcnt vmcnt(0)
s_barrier
s_barrier
s_cmp_eq_u32 s43, 0
s_cbranch_scc0 LB98
s_barrier
LB98:
s_add_u32 m0, s45, 0
s_add_u32 s47, s73, 0
buffer_load_dwordx4 v55, s[32:35], s47 offen sc1 lds
s_add_u32 m0, s45, 4096
s_add_u32 s47, s73, 4096
buffer_load_dwordx4 v55, s[32:35], s47 offen sc1 lds
s_add_u32 m0, s45, 8192
s_add_u32 s47, s73, 8192
buffer_load_dwordx4 v55, s[32:35], s47 offen sc1 lds
s_add_u32 m0, s45, 12288
s_add_u32 s47, s73, 12288
buffer_load_dwordx4 v55, s[32:35], s47 offen sc1 lds
s_add_u32 m0, s45, 16384
s_add_u32 s47, s73, 16384
buffer_load_dwordx4 v55, s[32:35], s47 offen sc1 lds
s_add_u32 m0, s45, 20480
s_add_u32 s47, s73, 20480
buffer_load_dwordx4 v55, s[32:35], s47 offen sc1 lds
s_add_u32 m0, s45, 24576
s_add_u32 s47, s73, 24576
buffer_load_dwordx4 v55, s[32:35], s47 offen sc1 lds
s_add_u32 m0, s45, 28672
s_add_u32 s47, s73, 28672
buffer_load_dwordx4 v55, s[32:35], s47 offen sc1 lds
s_add_u32 m0, s45, 32768
s_add_u32 s47, s73, 32768
buffer_load_dwordx4 v55, s[32:35], s47 offen sc1 lds
s_add_u32 m0, s45, 36864
s_add_u32 s47, s73, 36864
buffer_load_dwordx4 v55, s[32:35], s47 offen sc1 lds
s_add_u32 m0, s45, 40960
s_add_u32 s47, s73, 40960
buffer_load_dwordx4 v55, s[32:35], s47 offen sc1 lds
s_add_u32 m0, s45, 45056
s_add_u32 s47, s73, 45056
buffer_load_dwordx4 v55, s[32:35], s47 offen sc1 lds
s_add_u32 m0, s45, 49152
s_add_u32 s47, s73, 49152
buffer_load_dwordx4 v55, s[32:35], s47 offen sc1 lds
s_add_u32 m0, s45, 53248
s_add_u32 s47, s73, 53248
buffer_load_dwordx4 v55, s[32:35], s47 offen sc1 lds
s_add_u32 m0, s45, 57344
s_add_u32 s47, s73, 57344
buffer_load_dwordx4 v55, s[32:35], s47 offen sc1 lds
s_add_u32 m0, s45, 61440
s_add_u32 s47, s73, 61440
buffer_load_dwordx4 v55, s[32:35], s47 offen sc1 lds
s_add_u32 m0, s45, 65536
s_add_u32 s47, s73, 65536
buffer_load_dwordx4 v55, s[32:35], s47 offen sc1 lds
s_add_u32 m0, s45, 69632
s_add_u32 s47, s73, 69632
buffer_load_dwordx4 v55, s[32:35], s47 offen sc1 lds
s_add_u32 m0, s45, 73728
s_add_u32 s47, s73, 73728
buffer_load_dwordx4 v55, s[32:35], s47 offen sc1 lds
s_add_u32 m0, s45, 77824
s_add_u32 s47, s73, 77824
buffer_load_dwordx4 v55, s[32:35], s47 offen sc1 lds
s_barrier
s_barrier
s_waitcnt vmcnt(15)
s_barrier
s_waitcnt vmcnt(10)
s_barrier
s_add_u32 m0, s45, 0
s_add_u32 s47, s73, 81920
buffer_load_dwordx4 v55, s[32:35], s47 offen sc1 lds
s_add_u32 m0, s45, 4096
s_add_u32 s47, s73, 86016
buffer_load_dwordx4 v55, s[32:35], s47 offen sc1 lds
s_add_u32 m0, s45, 8192
s_add_u32 s47, s73, 90112
buffer_load_dwordx4 v55, s[32:35], s47 offen sc1 lds
s_add_u32 m0, s45, 12288
s_add_u32 s47, s73, 94208
buffer_load_dwordx4 v55, s[32:35], s47 offen sc1 lds
s_add_u32 m0, s45, 16384
s_add_u32 s47, s73, 98304
buffer_load_dwordx4 v55, s[32:35], s47 offen sc1 lds
s_waitcnt vmcnt(10)
s_barrier
s_add_u32 m0, s45, 20480
s_add_u32 s47, s73, 102400
buffer_load_dwordx4 v55, s[32:35], s47 offen sc1 lds
s_add_u32 m0, s45, 24576
s_add_u32 s47, s73, 106496
buffer_load_dwordx4 v55, s[32:35], s47 offen sc1 lds
s_add_u32 m0, s45, 28672
s_add_u32 s47, s73, 110592
buffer_load_dwordx4 v55, s[32:35], s47 offen sc1 lds
s_add_u32 m0, s45, 32768
s_add_u32 s47, s73, 114688
buffer_load_dwordx4 v55, s[32:35], s47 offen sc1 lds
s_add_u32 m0, s45, 36864
s_add_u32 s47, s73, 118784
buffer_load_dwordx4 v55, s[32:35], s47 offen sc1 lds
s_waitcnt vmcnt(10)
s_barrier
s_add_u32 m0, s45, 40960
s_add_u32 s47, s73, 122880
buffer_load_dwordx4 v55, s[32:35], s47 offen sc1 lds
s_add_u32 m0, s45, 45056
s_add_u32 s47, s73, 126976
buffer_load_dwordx4 v55, s[32:35], s47 offen sc1 lds
s_add_u32 m0, s45, 49152
s_add_u32 s47, s73, 131072
buffer_load_dwordx4 v55, s[32:35], s47 offen sc1 lds
s_add_u32 m0, s45, 53248
s_add_u32 s47, s73, 135168
buffer_load_dwordx4 v55, s[32:35], s47 offen sc1 lds
s_add_u32 m0, s45, 57344
s_add_u32 s47, s73, 139264
buffer_load_dwordx4 v55, s[32:35], s47 offen sc1 lds
s_waitcnt vmcnt(10)
s_barrier
s_add_u32 m0, s45, 61440
s_add_u32 s47, s73, 143360
buffer_load_dwordx4 v55, s[32:35], s47 offen sc1 lds
s_add_u32 m0, s45, 65536
s_add_u32 s47, s73, 147456
buffer_load_dwordx4 v55, s[32:35], s47 offen sc1 lds
s_add_u32 m0, s45, 69632
s_add_u32 s47, s73, 151552
buffer_load_dwordx4 v55, s[32:35], s47 offen sc1 lds
s_add_u32 m0, s45, 73728
s_add_u32 s47, s73, 155648
buffer_load_dwordx4 v55, s[32:35], s47 offen sc1 lds
s_add_u32 m0, s45, 77824
s_add_u32 s47, s73, 159744
buffer_load_dwordx4 v55, s[32:35], s47 offen sc1 lds
s_waitcnt vmcnt(10)
s_barrier
s_add_u32 m0, s45, 0
s_add_u32 s47, s73, 163840
buffer_load_dwordx4 v55, s[32:35], s47 offen sc1 lds
s_add_u32 m0, s45, 4096
s_add_u32 s47, s73, 167936
buffer_load_dwordx4 v55, s[32:35], s47 offen sc1 lds
s_add_u32 m0, s45, 8192
s_add_u32 s47, s73, 172032
buffer_load_dwordx4 v55, s[32:35], s47 offen sc1 lds
s_add_u32 m0, s45, 12288
s_add_u32 s47, s73, 176128
buffer_load_dwordx4 v55, s[32:35], s47 offen sc1 lds
s_add_u32 m0, s45, 16384
s_add_u32 s47, s73, 180224
buffer_load_dwordx4 v55, s[32:35], s47 offen sc1 lds
s_waitcnt vmcnt(10)
s_barrier
s_add_u32 m0, s45, 20480
s_add_u32 s47, s73, 184320
buffer_load_dwordx4 v55, s[32:35], s47 offen sc1 lds
s_add_u32 m0, s45, 24576
s_add_u32 s47, s73, 188416
buffer_load_dwordx4 v55, s[32:35], s47 offen sc1 lds
s_add_u32 m0, s45, 28672
s_add_u32 s47, s73, 192512
buffer_load_dwordx4 v55, s[32:35], s47 offen sc1 lds
s_add_u32 m0, s45, 32768
s_add_u32 s47, s73, 196608
buffer_load_dwordx4 v55, s[32:35], s47 offen sc1 lds
s_add_u32 m0, s45, 36864
s_add_u32 s47, s73, 200704
buffer_load_dwordx4 v55, s[32:35], s47 offen sc1 lds
s_waitcnt vmcnt(10)
s_barrier
s_add_u32 m0, s45, 40960
s_add_u32 s47, s73, 204800
buffer_load_dwordx4 v55, s[32:35], s47 offen sc1 lds
s_add_u32 m0, s45, 45056
s_add_u32 s47, s73, 208896
buffer_load_dwordx4 v55, s[32:35], s47 offen sc1 lds
s_add_u32 m0, s45, 49152
s_add_u32 s47, s73, 212992
buffer_load_dwordx4 v55, s[32:35], s47 offen sc1 lds
s_add_u32 m0, s45, 53248
s_add_u32 s47, s73, 217088
buffer_load_dwordx4 v55, s[32:35], s47 offen sc1 lds
s_add_u32 m0, s45, 57344
s_add_u32 s47, s73, 221184
buffer_load_dwordx4 v55, s[32:35], s47 offen sc1 lds
s_waitcnt vmcnt(10)
s_barrier
s_add_u32 m0, s45, 61440
s_add_u32 s47, s73, 225280
buffer_load_dwordx4 v55, s[32:35], s47 offen sc1 lds
s_add_u32 m0, s45, 65536
s_add_u32 s47, s73, 229376
buffer_load_dwordx4 v55, s[32:35], s47 offen sc1 lds
s_add_u32 m0, s45, 69632
s_add_u32 s47, s73, 233472
buffer_load_dwordx4 v55, s[32:35], s47 offen sc1 lds
s_add_u32 m0, s45, 73728
s_add_u32 s47, s73, 237568
buffer_load_dwordx4 v55, s[32:35], s47 offen sc1 lds
s_add_u32 m0, s45, 77824
s_add_u32 s47, s73, 241664
buffer_load_dwordx4 v55, s[32:35], s47 offen sc1 lds
s_waitcnt vmcnt(10)
s_barrier
s_add_u32 m0, s45, 0
s_add_u32 s47, s73, 245760
buffer_load_dwordx4 v55, s[32:35], s47 offen sc1 lds
s_add_u32 m0, s45, 4096
s_add_u32 s47, s73, 249856
buffer_load_dwordx4 v55, s[32:35], s47 offen sc1 lds
s_add_u32 m0, s45, 8192
s_add_u32 s47, s73, 253952
buffer_load_dwordx4 v55, s[32:35], s47 offen sc1 lds
s_add_u32 m0, s45, 12288
s_add_u32 s47, s73, 258048
buffer_load_dwordx4 v55, s[32:35], s47 offen sc1 lds
s_add_u32 m0, s45, 16384
s_add_u32 s47, s73, 262144
buffer_load_dwordx4 v55, s[32:35], s47 offen sc1 lds
s_waitcnt vmcnt(10)
s_barrier
s_add_u32 m0, s45, 20480
s_add_u32 s47, s73, 266240
buffer_load_dwordx4 v55, s[32:35], s47 offen sc1 lds
s_add_u32 m0, s45, 24576
s_add_u32 s47, s73, 270336
buffer_load_dwordx4 v55, s[32:35], s47 offen sc1 lds
s_cmp_ge_u32 s40, 2
s_cbranch_scc1 LB127
s_add_u32 m0, s45, 28672
s_add_u32 s47, s73, 274432
buffer_load_dwordx4 v55, s[32:35], s47 offen sc1 lds
LB127:
s_waitcnt vmcnt(7)
s_barrier
s_waitcnt vmcnt(2)
s_barrier
s_waitcnt vmcnt(0)
s_barrier
s_barrier
s_cmp_eq_u32 s43, 0
s_cbranch_scc0 LEND
s_mov_b32 s76, s32
s_mov_b32 s77, s33
s_mov_b32 s78, s34
s_mov_b32 s79, s35
v_mov_b32 v40, v55
s_mov_b32 s74, s70
s_mov_b32 s75, 4096
s_add_u32 m0, s45, 0
buffer_load_dwordx4 v40, s[76:79], s74 offen sc1 lds
s_add_u32 s74, s74, s75
s_add_u32 m0, s45, 4096
buffer_load_dwordx4 v40, s[76:79], s74 offen sc1 lds
s_add_u32 s74, s74, s75
s_add_u32 m0, s45, 8192
buffer_load_dwordx4 v40, s[76:79], s74 offen sc1 lds
s_add_u32 s74, s74, s75
s_add_u32 m0, s45, 12288
buffer_load_dwordx4 v40, s[76:79], s74 offen sc1 lds
s_add_u32 s74, s74, s75
s_add_u32 m0, s45, 16384
buffer_load_dwordx4 v40, s[76:79], s74 offen sc1 lds
s_add_u32 s74, s74, s75
s_add_u32 m0, s45, 20480
buffer_load_dwordx4 v40, s[76:79], s74 offen sc1 lds
s_add_u32 s74, s74, s75
s_add_u32 m0, s45, 24576
buffer_load_dwordx4 v40, s[76:79], s74 offen sc1 lds
s_add_u32 s74, s74, s75
s_add_u32 m0, s45, 28672
buffer_load_dwordx4 v40, s[76:79], s74 offen sc1 lds
s_add_u32 s74, s74, s75
s_add_u32 m0, s45, 32768
buffer_load_dwordx4 v40, s[76:79], s74 offen sc1 lds
s_add_u32 s74, s74, s75
s_add_u32 m0, s45, 36864
buffer_load_dwordx4 v40, s[76:79], s74 offen sc1 lds
s_add_u32 s74, s74, s75
s_add_u32 m0, s45, 40960
buffer_load_dwordx4 v40, s[76:79], s74 offen sc1 lds
s_add_u32 s74, s74, s75
s_add_u32 m0, s45, 45056
buffer_load_dwordx4 v40, s[76:79], s74 offen sc1 lds
s_add_u32 s74, s74, s75
s_add_u32 m0, s45, 49152
buffer_load_dwordx4 v40, s[76:79], s74 offen sc1 lds
s_add_u32 s74, s74, s75
s_add_u32 m0, s45, 53248
buffer_load_dwordx4 v40, s[76:79], s74 offen sc1 lds
s_add_u32 s74, s74, s75
s_add_u32 m0, s45, 57344
buffer_load_dwordx4 v40, s[76:79], s74 offen sc1 lds
s_add_u32 s74, s74, s75
s_add_u32 m0, s45, 61440
buffer_load_dwordx4 v40, s[76:79], s74 offen sc1 lds
s_add_u32 s74, s74, s75
s_barrier
s_mov_b32 s43, 1
s_branch PAIRLOOPL
LEND:
s_waitcnt vmcnt(0)
s_endpgm
.section .rodata,"a"
.p2align 6
.amdhsa_kernel interleave_layers__sliding_local_dilated__dense_activation_relu__prompt_kernel
  .amdhsa_next_free_vgpr 256
  .amdhsa_next_free_sgpr 102
  .amdhsa_accum_offset 248
  .amdhsa_group_segment_fixed_size 0
  .amdhsa_kernarg_size 72
  .amdhsa_user_sgpr_count 2
  .amdhsa_user_sgpr_kernarg_segment_ptr 1
  .amdhsa_system_sgpr_workgroup_id_x 1
.end_amdhsa_kernel
```
